```python
import torch

def _softmax(x, axis=-1):
    return torch.softmax(x, dim=axis)
def _gelu(x):
    return torch.nn.functional.gelu(x, approximate="tanh")
def _silu(x):
    return torch.nn.functional.silu(x)
def _sigmoid(x):
    return torch.sigmoid(x)
def _layernorm(x, axis=-1, eps=1e-5):
    m = x.mean(dim=axis, keepdim=True)
    v = x.var(dim=axis, keepdim=True, unbiased=False)
    return (x - m) / torch.sqrt(v + eps)
def _scatter_add(tgt, idx, src, axis=0):
    return tgt.clone().index_add_(axis, idx, src)
def _segment_sum(src, seg, n):
    out = torch.zeros((n,) + src.shape[1:], dtype=src.dtype)
    return out.index_add_(0, seg, src)
def _pad(x, pw):
    flat = tuple(v for pair in reversed(pw) for v in pair)
    return torch.nn.functional.pad(x, flat)

kernel_name = 'gated_mix__linear_attn_block__geglu_ffn__prompt'

def setup_inputs():

    _w = (lambda a: (lambda t: t.to(torch.bfloat16) if t.is_floating_point() else t)(torch.as_tensor(a)))
    def _A_setup():
        B, S, D = 1, 2048, 576
        return {
            "x": _w((lambda *s: torch.randn(*s, dtype=torch.bfloat16) * 0.05)(B, S, D)),
            "wqkv": _w((lambda *s: torch.randn(*s, dtype=torch.bfloat16) * 0.8)(D, 3 * D)),
            "wo": _w((lambda *s: torch.randn(*s, dtype=torch.bfloat16) * 0.05)(D, D)),
        }
    _A_in = _A_setup()

    def _B_setup():
        B, S, D, F = 1, 2048, 576, 4608
        return {
            "x": _w((lambda *s: torch.randn(*s, dtype=torch.bfloat16) * 0.05)(B, S, D)),
            "w_gate": _w((lambda *s: torch.randn(*s, dtype=torch.bfloat16) * 0.05)(D, F)),
            "w_up": _w((lambda *s: torch.randn(*s, dtype=torch.bfloat16) * 0.05)(D, F)),
            "w_down": _w((lambda *s: torch.randn(*s, dtype=torch.bfloat16) * 0.05)(F, D)),
        }
    _B_in = _B_setup()

    return {
        "A_x": _A_in["x"],
        "A_wqkv": _A_in["wqkv"],
        "A_wo": _A_in["wo"],
        "B_x": _B_in["x"],
        "B_w_gate": _B_in["w_gate"],
        "B_w_up": _B_in["w_up"],
        "B_w_down": _B_in["w_down"],
        "gate_w": _w((lambda *s: torch.randn(*s, dtype=torch.bfloat16) * 0.05)(576) * 16.0),
    }

def reference(A_x, A_wqkv, A_wo, B_x, B_w_gate, B_w_up, B_w_down, gate_w):
    def _A_ref(x, wqkv, wo):
        B, S, D = x.shape
        H = 32; Dh = D // H
        qkv = (lambda x, *d: x.permute(*d))((x @ wqkv).reshape(B, S, 3, H, Dh), 2, 0, 3, 1, 4)
        q, k, v = qkv[0], qkv[1], qkv[2]
        phi = lambda t: torch.where(t > 0, t + 1, torch.exp(t)) + 1e-6
        pq, pk = phi(q), phi(k)
        kv = torch.einsum("bhsd,bhse->bhde", pk, v)
        z = torch.einsum("bhsd->bhd", pk)
        num = torch.einsum("bhqd,bhde->bhqe", pq, kv)
        den = torch.einsum("bhqd,bhd->bhq", pq, z)[..., None] + 1e-6
        o = num / den
        return (lambda x, *d: x.permute(*d))(o, 0, 2, 1, 3).reshape(B, S, D) @ wo

    def _B_ref(x, w_gate, w_up, w_down):
        return (_gelu(x @ w_gate) * (x @ w_up)) @ w_down

    x = A_x
    g = _sigmoid((x * gate_w).sum(-1, keepdims=True))
    a = _A_ref(x, A_wqkv, A_wo)
    b = _B_ref(x, B_w_gate, B_w_up, B_w_down)
    return g * a + (1 - g) * b
```

```asm
; @launch grid=(256,1,1) block=(512,1,1) lds=163840
.amdgcn_target "amdgcn-amd-amdhsa--gfx950"
.text
.globl gated_mix__linear_attn_block__geglu_ffn__prompt_kernel
.p2align 8
.type gated_mix__linear_attn_block__geglu_ffn__prompt_kernel,@function
gated_mix__linear_attn_block__geglu_ffn__prompt_kernel:
    s_cmp_ge_u32 s2, 256
    s_cbranch_scc1 L_k1_end
    s_load_dwordx4 s[4:7], s[0:1], 0
    s_load_dwordx4 s[8:11], s[0:1], 32
    s_load_dwordx4 s[12:15], s[0:1], 48
    s_load_dwordx4 s[16:19], s[0:1], 72
    s_load_dwordx2 s[26:27], s[0:1], 16
    v_and_b32 v1, 63, v0
    v_lshrrev_b32 v11, 6, v0
    s_nop 0
    v_readfirstlane_b32 s22, v11
    s_and_b32 s25, s2, 7
    s_lshr_b32 s78, s2, 3
    s_and_b32 s79, s78, 3
    s_lshl_b32 s21, s25, 2
    s_add_u32 s21, s21, s79
    s_lshr_b32 s20, s78, 2
    s_and_b32 s23, s22, 3
    s_lshr_b32 s24, s22, 2
    s_getpc_b64 s[44:45]
L_ipf:
    s_mov_b32 s46, L_k1_end-L_ipf
    s_mov_b32 s47, 0x20000
    s_lshr_b32 s78, s2, 3
    s_lshl_b32 s78, s78, 3
    s_add_u32 s78, s78, s22
    s_lshl_b32 s78, s78, 9
    v_lshlrev_b32 v11, 7, v1
    v_mov_b32 v12, 0x10000000
    v_cmp_gt_u32 vcc, 4, v1
    s_nop 1
    v_cndmask_b32 v11, v12, v11, vcc
    buffer_load_dword v79, v11, s[44:47], s78 offen
    v_lshrrev_b32 v11, 2, v1
    v_lshrrev_b32 v12, 2, v11
    v_sub_u32 v12, 4, v12
    v_and_b32 v12, 3, v12
    v_and_b32 v13, 3, v1
    v_xor_b32 v13, v13, v12
    v_lshlrev_b32 v13, 4, v13
    s_lshl_b32 s78, s20, 8
    s_lshl_b32 s79, s22, 5
    s_add_u32 s78, s78, s79
    v_add_u32 v11, s78, v11
    v_mul_u32_u24 v11, 1152, v11
    v_add_u32 v2, v11, v13
    v_add_u32 v3, 18432, v2
    s_lshl_b32 s59, s22, 11
    s_add_u32 s60, s59, 1024
    s_mov_b32 s52, 0
    s_mov_b32 s64, 0
    s_mov_b32 s30, 2359296
    s_mov_b32 s31, 0x20000
    s_waitcnt lgkmcnt(0)
    s_mov_b32 s28, s4
    s_mov_b32 s29, s5
    s_add_u32 m0, s64, s59
    s_nop 0
    buffer_load_dwordx4 v2, s[28:31], s52 offen lds
    s_add_u32 m0, s64, s60
    s_nop 0
    buffer_load_dwordx4 v3, s[28:31], s52 offen lds
    s_add_u32 s52, s52, 64
    s_mul_i32 s72, s22, 3
    s_add_u32 s72, s72, 0
    s_sub_u32 s73, s72, 9
    s_cmp_ge_u32 s72, 9
    s_cselect_b32 s32, s10, s8
    s_cselect_b32 s33, s11, s9
    s_cselect_b32 s74, s73, s72
    s_mov_b32 s75, 16384
    s_cselect_b32 s75, 25600, s75
    s_sub_u32 s73, s72, 18
    s_min_u32 s73, s73, 4
    s_mul_i32 s76, s21, 288
    s_mul_i32 s77, s21, 36
    s_cmp_ge_u32 s72, 18
    s_cselect_b32 s32, s6, s32
    s_cselect_b32 s33, s7, s33
    s_cselect_b32 s74, s73, s74
    s_cselect_b32 s75, 34816, s75
    s_mov_b32 s34, 5308416
    s_cselect_b32 s34, 1990656, s34
    s_mov_b32 s56, 294912
    s_cselect_b32 s56, 110592, s56
    s_mov_b32 s78, 3641
    s_cselect_b32 s78, 6554, s78
    s_cselect_b32 s79, 10, 18
    s_mov_b32 s80, 9216
    s_cselect_b32 s80, 3456, s80
    s_cselect_b32 s81, 1104, 0
    s_cselect_b32 s82, 8, 17
    s_cselect_b32 s76, s77, s76
    s_mov_b32 s35, 0x20000
    s_lshl_b32 s73, s74, 10
    s_add_u32 s61, s75, s73
    s_lshl_b32 s73, s74, 6
    s_mov_b32 s53, 0
    v_add_u32 v11, s73, v1
    v_mul_u32_u24 v12, s78, v11
    v_lshrrev_b32 v12, 16, v12
    v_mul_u32_u24 v13, s79, v12
    v_sub_u32 v13, v11, v13
    v_min_u32 v13, s82, v13
    v_mul_u32_u24 v14, 11, v13
    v_lshrrev_b32 v14, 5, v14
    v_mul_u32_u24 v14, s81, v14
    v_lshl_add_u32 v14, v13, 4, v14
    v_and_b32 v15, 0x13, v12
    v_and_b32 v13, 4, v12
    v_lshl_or_b32 v15, v13, 1, v15
    v_and_b32 v13, 8, v12
    v_lshrrev_b32 v13, 1, v13
    v_or_b32 v15, v15, v13
    v_mul_u32_u24 v15, s80, v15
    v_add3_u32 v4, v15, v14, s76
    s_add_u32 m0, s64, s61
    s_nop 0
    buffer_load_dwordx4 v4, s[32:35], s53 offen lds
    s_add_u32 s53, s53, s56
    s_mul_i32 s72, s22, 3
    s_add_u32 s72, s72, 1
    s_sub_u32 s73, s72, 9
    s_cmp_ge_u32 s72, 9
    s_cselect_b32 s36, s10, s8
    s_cselect_b32 s37, s11, s9
    s_cselect_b32 s74, s73, s72
    s_mov_b32 s75, 16384
    s_cselect_b32 s75, 25600, s75
    s_sub_u32 s73, s72, 18
    s_min_u32 s73, s73, 4
    s_mul_i32 s76, s21, 288
    s_mul_i32 s77, s21, 36
    s_cmp_ge_u32 s72, 18
    s_cselect_b32 s36, s6, s36
    s_cselect_b32 s37, s7, s37
    s_cselect_b32 s74, s73, s74
    s_cselect_b32 s75, 34816, s75
    s_mov_b32 s38, 5308416
    s_cselect_b32 s38, 1990656, s38
    s_mov_b32 s57, 294912
    s_cselect_b32 s57, 110592, s57
    s_mov_b32 s78, 3641
    s_cselect_b32 s78, 6554, s78
    s_cselect_b32 s79, 10, 18
    s_mov_b32 s80, 9216
    s_cselect_b32 s80, 3456, s80
    s_cselect_b32 s81, 1104, 0
    s_cselect_b32 s82, 8, 17
    s_cselect_b32 s76, s77, s76
    s_mov_b32 s39, 0x20000
    s_lshl_b32 s73, s74, 10
    s_add_u32 s62, s75, s73
    s_lshl_b32 s73, s74, 6
    s_mov_b32 s54, 0
    v_add_u32 v11, s73, v1
    v_mul_u32_u24 v12, s78, v11
    v_lshrrev_b32 v12, 16, v12
    v_mul_u32_u24 v13, s79, v12
    v_sub_u32 v13, v11, v13
    v_min_u32 v13, s82, v13
    v_mul_u32_u24 v14, 11, v13
    v_lshrrev_b32 v14, 5, v14
    v_mul_u32_u24 v14, s81, v14
    v_lshl_add_u32 v14, v13, 4, v14
    v_and_b32 v15, 0x13, v12
    v_and_b32 v13, 4, v12
    v_lshl_or_b32 v15, v13, 1, v15
    v_and_b32 v13, 8, v12
    v_lshrrev_b32 v13, 1, v13
    v_or_b32 v15, v15, v13
    v_mul_u32_u24 v15, s80, v15
    v_add3_u32 v5, v15, v14, s76
    s_add_u32 m0, s64, s62
    s_nop 0
    buffer_load_dwordx4 v5, s[36:39], s54 offen lds
    s_add_u32 s54, s54, s57
    s_mul_i32 s72, s22, 3
    s_add_u32 s72, s72, 2
    s_sub_u32 s73, s72, 9
    s_cmp_ge_u32 s72, 9
    s_cselect_b32 s40, s10, s8
    s_cselect_b32 s41, s11, s9
    s_cselect_b32 s74, s73, s72
    s_mov_b32 s75, 16384
    s_cselect_b32 s75, 25600, s75
    s_sub_u32 s73, s72, 18
    s_min_u32 s73, s73, 4
    s_mul_i32 s76, s21, 288
    s_mul_i32 s77, s21, 36
    s_cmp_ge_u32 s72, 18
    s_cselect_b32 s40, s6, s40
    s_cselect_b32 s41, s7, s41
    s_cselect_b32 s74, s73, s74
    s_cselect_b32 s75, 34816, s75
    s_mov_b32 s42, 5308416
    s_cselect_b32 s42, 1990656, s42
    s_mov_b32 s58, 294912
    s_cselect_b32 s58, 110592, s58
    s_mov_b32 s78, 3641
    s_cselect_b32 s78, 6554, s78
    s_cselect_b32 s79, 10, 18
    s_mov_b32 s80, 9216
    s_cselect_b32 s80, 3456, s80
    s_cselect_b32 s81, 1104, 0
    s_cselect_b32 s82, 8, 17
    s_cselect_b32 s76, s77, s76
    s_mov_b32 s43, 0x20000
    s_lshl_b32 s73, s74, 10
    s_add_u32 s63, s75, s73
    s_lshl_b32 s73, s74, 6
    s_mov_b32 s55, 0
    v_add_u32 v11, s73, v1
    v_mul_u32_u24 v12, s78, v11
    v_lshrrev_b32 v12, 16, v12
    v_mul_u32_u24 v13, s79, v12
    v_sub_u32 v13, v11, v13
    v_min_u32 v13, s82, v13
    v_mul_u32_u24 v14, 11, v13
    v_lshrrev_b32 v14, 5, v14
    v_mul_u32_u24 v14, s81, v14
    v_lshl_add_u32 v14, v13, 4, v14
    v_and_b32 v15, 0x13, v12
    v_and_b32 v13, 4, v12
    v_lshl_or_b32 v15, v13, 1, v15
    v_and_b32 v13, 8, v12
    v_lshrrev_b32 v13, 1, v13
    v_or_b32 v15, v15, v13
    v_mul_u32_u24 v15, s80, v15
    v_add3_u32 v6, v15, v14, s76
    s_add_u32 m0, s64, s63
    s_nop 0
    buffer_load_dwordx4 v6, s[40:43], s55 offen lds
    s_add_u32 s55, s55, s58
    s_add_u32 s64, s64, 39936
    s_cmp_eq_u32 s64, 159744
    s_cselect_b32 s64, 0, s64
    s_mul_i32 s78, s2, 9216
    s_mul_i32 s79, s22, 1152
    s_add_u32 s78, s78, s79
    v_lshlrev_b32 v11, 7, v1
    v_mov_b32 v12, 0x10000000
    v_cmp_gt_u32 vcc, 9, v1
    s_nop 1
    v_cndmask_b32 v13, v12, v11, vcc
    buffer_load_dword v79, v13, s[28:31], s78 offen
    s_mov_b32 s48, s16
    s_mov_b32 s49, s17
    s_mov_b32 s50, 256
    s_mov_b32 s51, 0x20000
    s_or_b32 s78, s22, s2
    s_cmp_lg_u32 s78, 0
    s_cbranch_scc1 L_k1_notag
    s_memrealtime s[78:79]
    s_waitcnt lgkmcnt(0)
    s_or_b32 s78, s78, 1
    v_mov_b32 v16, s78
    v_mov_b32 v11, 252
    s_mov_b64 exec, 1
    buffer_store_dword v16, v11, s[48:51], 0 offen sc1
    s_mov_b64 exec, -1
L_k1_notag:
    v_and_b32 v11, 15, v1
    v_lshrrev_b32 v12, 4, v1
    v_lshrrev_b32 v13, 2, v11
    v_sub_u32 v13, 4, v13
    v_and_b32 v13, 3, v13
    v_xor_b32 v13, v13, v12
    v_lshlrev_b32 v13, 4, v13
    v_lshl_add_u32 v7, v11, 6, v13
    s_lshl_b32 s78, s23, 12
    v_add_u32 v7, s78, v7
    v_lshrrev_b32 v13, 1, v12
    v_lshlrev_b32 v13, 4, v13
    v_and_b32 v14, 1, v12
    v_lshl_add_u32 v13, v14, 2, v13
    v_bfe_u32 v14, v1, 2, 2
    v_add_u32 v13, v13, v14
    v_and_b32 v14, 3, v1
    v_mul_u32_u24 v15, 288, v13
    v_lshl_add_u32 v15, v14, 3, v15
    v_mul_u32_u24 v11, 160, v13
    s_and_b32 s78, s21, 1
    s_cmp_eq_u32 s78, 0
    s_cselect_b32 s79, 4, 1
    s_cselect_b32 s80, 0, 5
    s_cselect_b32 s69, 8, 0
    s_cmp_eq_u32 s24, 0
    s_cselect_b32 s68, s79, s80
    s_lshl_b32 s79, s68, 5
    s_add_u32 s79, s79, 16384
    v_add_u32 v8, s79, v15
    s_lshl_b32 s79, s69, 5
    s_add_u32 s79, s79, 16384
    v_add_u32 v9, s79, v15
    v_lshl_add_u32 v10, v14, 3, v11
    v_add_u32 v10, 34816, v10
    v_lshlrev_b32 v12, 3, v14
    s_mov_b32 s79, 0x90208050
    v_lshrrev_b32 v12, v12, s79
    v_and_b32 v12, 0xff, v12
    v_add3_u32 v12, v12, v11, 0
    v_add_u32 v12, 34816, v12
    s_cmp_eq_u32 s24, 0
    s_cselect_b64 s[78:79], -1, 0
    v_cndmask_b32 v9, v10, v9, s[78:79]
    v_cndmask_b32 v10, v12, v10, s[78:79]
    s_lshl_b32 s70, s20, 8
    s_lshl_b32 s71, s21, 3
    s_add_u32 s70, s70, s71
    s_add_u32 s70, s70, s22
    s_mul_i32 s71, s70, 1152
    v_lshlrev_b32 v14, 5, v1
    s_mov_b32 s67, 0
    s_mov_b32 s84, 0x3fb8aa3b
    s_mov_b32 s85, 0x358637bd
    v_mov_b32 v16, 0
    v_mov_b32 v17, 0
    s_lshl_b32 s78, s22, 9
    s_add_u32 s78, s78, 159744
    v_lshl_add_u32 v11, v1, 3, s78
    ds_write_b64 v11, v[16:17]
    s_barrier
    s_add_u32 m0, s64, s59
    s_nop 0
    buffer_load_dwordx4 v2, s[28:31], s52 offen lds
    s_add_u32 m0, s64, s60
    s_nop 0
    buffer_load_dwordx4 v3, s[28:31], s52 offen lds
    s_add_u32 s52, s52, 64
    s_add_u32 m0, s64, s61
    s_nop 0
    buffer_load_dwordx4 v4, s[32:35], s53 offen lds
    s_add_u32 s53, s53, s56
    s_add_u32 m0, s64, s62
    s_nop 0
    buffer_load_dwordx4 v5, s[36:39], s54 offen lds
    s_add_u32 s54, s54, s57
    s_add_u32 m0, s64, s63
    s_nop 0
    buffer_load_dwordx4 v6, s[40:43], s55 offen lds
    s_add_u32 s55, s55, s58
    s_add_u32 s64, s64, 39936
    s_cmp_eq_u32 s64, 159744
    s_cselect_b32 s64, 0, s64
    s_mov_b32 s44, s18
    s_mov_b32 s45, s19
    s_mov_b32 s46, 268435456
    s_mov_b32 s47, 0x20000
    s_mov_b32 s48, s14
    s_mov_b32 s49, s15
    s_mov_b32 s50, 1152
    s_mov_b32 s51, 0x20000
    s_waitcnt vmcnt(6)
    s_waitcnt lgkmcnt(0)
    s_barrier
    s_cmp_eq_u32 s24, 0
    s_cbranch_scc0 L_k1_ch1
    ds_read_b128 v[16:19], v7 offset:0
    ds_read_b128 v[20:23], v7 offset:1024
    ds_read_b64_tr_b16 v[48:49], v9 offset:0
    ds_read_b64_tr_b16 v[50:51], v9 offset:2304
    ds_read_b128 v[24:27], v7 offset:2048
    ds_read_b128 v[28:31], v7 offset:3072
    ds_read_b64_tr_b16 v[52:53], v9 offset:9216
    ds_read_b64_tr_b16 v[54:55], v9 offset:11520
    ds_read_b64_tr_b16 v[56:57], v10 offset:0
    ds_read_b64_tr_b16 v[58:59], v10 offset:1280
    ds_read_b64_tr_b16 v[60:61], v8 offset:0
    ds_read_b64_tr_b16 v[62:63], v8 offset:2304
    s_waitcnt lgkmcnt(6)
    v_mfma_f32_16x16x32_bf16 v[80:83], v[48:51], v[16:19], 0
    s_lshr_b32 s83, s2, 3
    v_mul_u32_u24 v64, 7282, v1
    v_lshrrev_b32 v64, 16, v64
    v_mul_u32_u24 v65, 9, v64
    v_sub_u32 v65, v1, v65
    v_lshlrev_b32 v64, 5, v64
    v_add_u32 v64, s83, v64
    v_mul_u32_u24 v66, 9216, v64
    v_lshl_add_u32 v66, v65, 7, v66
    s_mul_i32 s82, s25, 1152
    v_add_u32 v66, s82, v66
    v_cmp_gt_u32 vcc, 18, v1
    v_mov_b32 v67, 0x10000000
    s_nop 0
    v_cndmask_b32 v66, v67, v66, vcc
    v_mul_u32_u24 v64, 10923, v1
    v_lshrrev_b32 v64, 16, v64
    v_mul_u32_u24 v65, 6, v64
    v_sub_u32 v65, v1, v65
    v_lshlrev_b32 v64, 5, v64
    v_add_u32 v64, s83, v64
    v_mul_u32_u24 v64, 3456, v64
    v_lshrrev_b32 v68, 1, v65
    v_mul_u32_u24 v68, 1152, v68
    v_and_b32 v65, 1, v65
    v_lshl_add_u32 v65, v65, 7, v68
    v_add_u32 v64, v64, v65
    s_mul_i32 s82, s25, 144
    s_andn2_b32 s82, s82, 127
    v_add_u32 v64, s82, v64
    v_mfma_f32_16x16x32_bf16 v[84:87], v[48:51], v[20:23], 0
    s_add_u32 m0, s64, s59
    s_nop 0
    buffer_load_dwordx4 v2, s[28:31], s52 offen lds
    v_cmp_gt_u32 vcc, 12, v1
    s_nop 1
    v_cndmask_b32 v64, v67, v64, vcc
    s_lshl_b32 s82, s83, 6
    v_add_u32 v65, s82, v1
    v_mul_u32_u24 v65, 1152, v65
    v_lshlrev_b32 v68, 7, v1
    s_cmp_eq_u32 s22, 2
    s_cselect_b64 vcc, -1, 0
    v_cndmask_b32 v66, v66, v64, vcc
    v_mfma_f32_16x16x32_bf16 v[88:91], v[48:51], v[24:27], 0
    s_cmp_eq_u32 s22, 3
    s_cselect_b64 vcc, -1, 0
    v_cndmask_b32 v66, v66, v65, vcc
    s_cmp_ge_u32 s22, 4
    s_cselect_b64 vcc, -1, 0
    v_cndmask_b32 v0, v66, v68, vcc
    s_mov_b32 s72, s8
    s_mov_b32 s73, s9
    s_mov_b32 s74, 5308416
    s_mov_b32 s77, 589824
    v_mfma_f32_16x16x32_bf16 v[92:95], v[48:51], v[28:31], 0
    s_cmp_eq_u32 s22, 1
    s_cselect_b32 s72, s10, s72
    s_cselect_b32 s73, s11, s73
    s_cmp_eq_u32 s22, 2
    s_cselect_b32 s72, s6, s72
    s_cselect_b32 s73, s7, s73
    s_cselect_b32 s74, 1990656, s74
    s_cselect_b32 s77, 221184, s77
    ds_read_b64_tr_b16 v[48:49], v8 offset:32
    ds_read_b64_tr_b16 v[50:51], v8 offset:2336
    s_waitcnt lgkmcnt(6)
    v_mfma_f32_16x16x32_bf16 v[96:99], v[52:55], v[16:19], 0
    s_cmp_eq_u32 s22, 3
    s_cselect_b32 s72, s4, s72
    s_cselect_b32 s73, s5, s73
    s_cselect_b32 s74, 2359296, s74
    s_cselect_b32 s77, 128, s77
    s_mov_b32 s76, s77
    s_lshl_b32 s82, s2, 2
    s_add_u32 s82, s82, s23
    s_mul_i32 s82, s82, 8192
    s_cmp_ge_u32 s22, 4
    s_cselect_b32 s72, s12, s72
    s_cselect_b32 s73, s13, s73
    s_cselect_b32 s77, 0x10000000, s77
    s_cselect_b32 s76, s82, s76
    s_sub_u32 s83, s82, 5308416
    v_mfma_f32_16x16x32_bf16 v[100:103], v[52:55], v[20:23], 0
    s_add_u32 m0, s64, s60
    s_nop 0
    buffer_load_dwordx4 v3, s[28:31], s52 offen lds
    s_add_u32 s52, s52, 64
    s_cmp_ge_u32 s82, 5308416
    s_cselect_b32 s86, 1, 0
    s_cmp_ge_u32 s22, 4
    s_cselect_b32 s86, s86, 0
    v_mfma_f32_16x16x32_bf16 v[104:107], v[52:55], v[24:27], 0
    s_cmp_eq_u32 s86, 1
    s_cselect_b32 s72, s26, s72
    s_cselect_b32 s73, s27, s73
    s_cselect_b32 s74, 663552, s74
    s_cselect_b32 s76, s83, s76
    s_sub_u32 s83, s76, 1073741824
    s_cmp_ge_u32 s22, 4
    s_cselect_b32 s76, s83, s76
    s_mov_b32 s75, 0x20000
    v_mfma_f32_16x16x32_bf16 v[108:111], v[52:55], v[28:31], 0
    ds_read_b64_tr_b16 v[52:53], v8 offset:9216
    ds_read_b64_tr_b16 v[54:55], v8 offset:11520
    s_waitcnt lgkmcnt(6)
    v_mfma_f32_16x16x32_bf16 v[112:115], v[56:59], v[16:19], 0
    v_mfma_f32_16x16x32_bf16 v[116:119], v[56:59], v[20:23], 0
    s_add_u32 m0, s64, s61
    s_nop 0
    buffer_load_dwordx4 v4, s[32:35], s53 offen lds
    s_add_u32 s53, s53, s56
    v_mfma_f32_16x16x32_bf16 v[120:123], v[56:59], v[24:27], 0
    v_mfma_f32_16x16x32_bf16 v[124:127], v[56:59], v[28:31], 0
    ds_read_b64_tr_b16 v[56:57], v8 offset:9248
    ds_read_b64_tr_b16 v[58:59], v8 offset:11552
    s_waitcnt lgkmcnt(6)
    v_mfma_f32_16x16x32_bf16 v[128:131], v[60:63], v[16:19], 0
    v_mfma_f32_16x16x32_bf16 v[132:135], v[60:63], v[20:23], 0
    s_add_u32 m0, s64, s62
    s_nop 0
    buffer_load_dwordx4 v5, s[36:39], s54 offen lds
    s_add_u32 s54, s54, s57
    v_mfma_f32_16x16x32_bf16 v[136:139], v[60:63], v[24:27], 0
    v_mfma_f32_16x16x32_bf16 v[140:143], v[60:63], v[28:31], 0
    ds_read_b64_tr_b16 v[60:61], v8 offset:64
    ds_read_b64_tr_b16 v[62:63], v8 offset:2368
    s_waitcnt lgkmcnt(6)
    v_mfma_f32_16x16x32_bf16 v[144:147], v[48:51], v[16:19], 0
    v_mfma_f32_16x16x32_bf16 v[148:151], v[48:51], v[20:23], 0
    s_add_u32 m0, s64, s63
    s_nop 0
    buffer_load_dwordx4 v6, s[40:43], s55 offen lds
    s_add_u32 s55, s55, s58
    s_add_u32 s64, s64, 39936
    s_cmp_eq_u32 s64, 159744
    s_cselect_b32 s64, 0, s64
    v_mfma_f32_16x16x32_bf16 v[152:155], v[48:51], v[24:27], 0
    v_mfma_f32_16x16x32_bf16 v[156:159], v[48:51], v[28:31], 0
    buffer_load_dword v79, v0, s[72:75], s76 offen
    s_add_u32 s76, s76, s77
    ds_read_b64_tr_b16 v[48:49], v8 offset:96
    ds_read_b64_tr_b16 v[50:51], v8 offset:2400
    s_waitcnt lgkmcnt(6)
    v_mfma_f32_16x16x32_bf16 v[160:163], v[52:55], v[16:19], 0
    v_mfma_f32_16x16x32_bf16 v[164:167], v[52:55], v[20:23], 0
    v_mfma_f32_16x16x32_bf16 v[168:171], v[52:55], v[24:27], 0
    v_mfma_f32_16x16x32_bf16 v[172:175], v[52:55], v[28:31], 0
    buffer_load_dword v79, v0, s[72:75], s76 offen
    s_add_u32 s76, s76, s77
    ds_read_b64_tr_b16 v[52:53], v8 offset:9280
    ds_read_b64_tr_b16 v[54:55], v8 offset:11584
    s_waitcnt lgkmcnt(6)
    v_mfma_f32_16x16x32_bf16 v[176:179], v[56:59], v[16:19], 0
    v_mfma_f32_16x16x32_bf16 v[180:183], v[56:59], v[20:23], 0
    v_mfma_f32_16x16x32_bf16 v[184:187], v[56:59], v[24:27], 0
    v_mfma_f32_16x16x32_bf16 v[188:191], v[56:59], v[28:31], 0
    ds_read_b64_tr_b16 v[56:57], v8 offset:9312
    ds_read_b64_tr_b16 v[58:59], v8 offset:11616
    s_waitcnt lgkmcnt(6)
    v_mfma_f32_16x16x32_bf16 v[192:195], v[60:63], v[16:19], 0
    v_mfma_f32_16x16x32_bf16 v[196:199], v[60:63], v[20:23], 0
    v_mfma_f32_16x16x32_bf16 v[200:203], v[60:63], v[24:27], 0
    v_mfma_f32_16x16x32_bf16 v[204:207], v[60:63], v[28:31], 0
    s_add_u32 s67, s67, 1
    s_and_b32 s67, s67, 3
    s_cmp_eq_u32 s67, 0
    s_mov_b32 s66, 39936
    s_cselect_b32 s66, -119808, s66
    v_add_u32 v7, s66, v7
    v_add_u32 v8, s66, v8
    v_add_u32 v9, s66, v9
    v_add_u32 v10, s66, v10
    s_waitcnt vmcnt(7)
    s_waitcnt lgkmcnt(0)
    s_barrier
    ds_read_b128 v[32:35], v7 offset:0
    ds_read_b128 v[36:39], v7 offset:1024
    v_mfma_f32_16x16x32_bf16 v[208:211], v[48:51], v[16:19], 0
    v_mfma_f32_16x16x32_bf16 v[212:215], v[48:51], v[20:23], 0
    s_add_u32 m0, s64, s59
    s_nop 0
    buffer_load_dwordx4 v2, s[28:31], s52 offen lds
    v_mfma_f32_16x16x32_bf16 v[216:219], v[48:51], v[24:27], 0
    v_mfma_f32_16x16x32_bf16 v[220:223], v[48:51], v[28:31], 0
    ds_read_b64_tr_b16 v[48:49], v9 offset:0
    ds_read_b64_tr_b16 v[50:51], v9 offset:2304
    ds_read_b128 v[40:43], v7 offset:2048
    ds_read_b128 v[44:47], v7 offset:3072
    v_mfma_f32_16x16x32_bf16 v[224:227], v[52:55], v[16:19], 0
    v_mfma_f32_16x16x32_bf16 v[228:231], v[52:55], v[20:23], 0
    s_add_u32 m0, s64, s60
    s_nop 0
    buffer_load_dwordx4 v3, s[28:31], s52 offen lds
    s_add_u32 s52, s52, 64
    v_mfma_f32_16x16x32_bf16 v[232:235], v[52:55], v[24:27], 0
    v_mfma_f32_16x16x32_bf16 v[236:239], v[52:55], v[28:31], 0
    ds_read_b64_tr_b16 v[52:53], v9 offset:9216
    ds_read_b64_tr_b16 v[54:55], v9 offset:11520
    v_mfma_f32_16x16x32_bf16 v[240:243], v[56:59], v[16:19], 0
    v_mfma_f32_16x16x32_bf16 v[244:247], v[56:59], v[20:23], 0
    s_add_u32 m0, s64, s61
    s_nop 0
    buffer_load_dwordx4 v4, s[32:35], s53 offen lds
    s_add_u32 s53, s53, s56
    v_mfma_f32_16x16x32_bf16 v[248:251], v[56:59], v[24:27], 0
    v_mfma_f32_16x16x32_bf16 v[252:255], v[56:59], v[28:31], 0
    ds_read_b64_tr_b16 v[56:57], v10 offset:0
    ds_read_b64_tr_b16 v[58:59], v10 offset:1280
    ds_read_b64_tr_b16 v[60:61], v8 offset:0
    ds_read_b64_tr_b16 v[62:63], v8 offset:2304
    s_waitcnt lgkmcnt(6)
    v_mfma_f32_16x16x32_bf16 v[80:83], v[48:51], v[32:35], v[80:83]
    v_mfma_f32_16x16x32_bf16 v[84:87], v[48:51], v[36:39], v[84:87]
    s_add_u32 m0, s64, s62
    s_nop 0
    buffer_load_dwordx4 v5, s[36:39], s54 offen lds
    s_add_u32 s54, s54, s57
    v_mfma_f32_16x16x32_bf16 v[88:91], v[48:51], v[40:43], v[88:91]
    v_mfma_f32_16x16x32_bf16 v[92:95], v[48:51], v[44:47], v[92:95]
    ds_read_b64_tr_b16 v[48:49], v8 offset:32
    ds_read_b64_tr_b16 v[50:51], v8 offset:2336
    s_waitcnt lgkmcnt(6)
    v_mfma_f32_16x16x32_bf16 v[96:99], v[52:55], v[32:35], v[96:99]
    v_mfma_f32_16x16x32_bf16 v[100:103], v[52:55], v[36:39], v[100:103]
    s_add_u32 m0, s64, s63
    s_nop 0
    buffer_load_dwordx4 v6, s[40:43], s55 offen lds
    s_add_u32 s55, s55, s58
    s_add_u32 s64, s64, 39936
    s_cmp_eq_u32 s64, 159744
    s_cselect_b32 s64, 0, s64
    v_mfma_f32_16x16x32_bf16 v[104:107], v[52:55], v[40:43], v[104:107]
    v_mfma_f32_16x16x32_bf16 v[108:111], v[52:55], v[44:47], v[108:111]
    ds_read_b64_tr_b16 v[52:53], v8 offset:9216
    ds_read_b64_tr_b16 v[54:55], v8 offset:11520
    s_waitcnt lgkmcnt(6)
    v_mfma_f32_16x16x32_bf16 v[112:115], v[56:59], v[32:35], v[112:115]
    v_mfma_f32_16x16x32_bf16 v[116:119], v[56:59], v[36:39], v[116:119]
    v_mfma_f32_16x16x32_bf16 v[120:123], v[56:59], v[40:43], v[120:123]
    v_mfma_f32_16x16x32_bf16 v[124:127], v[56:59], v[44:47], v[124:127]
    ds_read_b64_tr_b16 v[56:57], v8 offset:9248
    ds_read_b64_tr_b16 v[58:59], v8 offset:11552
    s_waitcnt lgkmcnt(6)
    v_mfma_f32_16x16x32_bf16 v[128:131], v[60:63], v[32:35], v[128:131]
    v_mfma_f32_16x16x32_bf16 v[132:135], v[60:63], v[36:39], v[132:135]
    v_mfma_f32_16x16x32_bf16 v[136:139], v[60:63], v[40:43], v[136:139]
    v_mfma_f32_16x16x32_bf16 v[140:143], v[60:63], v[44:47], v[140:143]
    buffer_load_dword v79, v0, s[72:75], s76 offen
    s_add_u32 s76, s76, s77
    ds_read_b64_tr_b16 v[60:61], v8 offset:64
    ds_read_b64_tr_b16 v[62:63], v8 offset:2368
    s_waitcnt lgkmcnt(6)
    v_mfma_f32_16x16x32_bf16 v[144:147], v[48:51], v[32:35], v[144:147]
    v_mfma_f32_16x16x32_bf16 v[148:151], v[48:51], v[36:39], v[148:151]
    v_mfma_f32_16x16x32_bf16 v[152:155], v[48:51], v[40:43], v[152:155]
    v_mfma_f32_16x16x32_bf16 v[156:159], v[48:51], v[44:47], v[156:159]
    ds_read_b64_tr_b16 v[48:49], v8 offset:96
    ds_read_b64_tr_b16 v[50:51], v8 offset:2400
    s_waitcnt lgkmcnt(6)
    v_mfma_f32_16x16x32_bf16 v[160:163], v[52:55], v[32:35], v[160:163]
    v_mfma_f32_16x16x32_bf16 v[164:167], v[52:55], v[36:39], v[164:167]
    v_mfma_f32_16x16x32_bf16 v[168:171], v[52:55], v[40:43], v[168:171]
    v_mfma_f32_16x16x32_bf16 v[172:175], v[52:55], v[44:47], v[172:175]
    ds_read_b64_tr_b16 v[52:53], v8 offset:9280
    ds_read_b64_tr_b16 v[54:55], v8 offset:11584
    s_waitcnt lgkmcnt(6)
    v_mfma_f32_16x16x32_bf16 v[176:179], v[56:59], v[32:35], v[176:179]
    v_mfma_f32_16x16x32_bf16 v[180:183], v[56:59], v[36:39], v[180:183]
    v_mfma_f32_16x16x32_bf16 v[184:187], v[56:59], v[40:43], v[184:187]
    v_mfma_f32_16x16x32_bf16 v[188:191], v[56:59], v[44:47], v[188:191]
    ds_read_b64_tr_b16 v[56:57], v8 offset:9312
    ds_read_b64_tr_b16 v[58:59], v8 offset:11616
    s_waitcnt lgkmcnt(6)
    v_mfma_f32_16x16x32_bf16 v[192:195], v[60:63], v[32:35], v[192:195]
    v_mfma_f32_16x16x32_bf16 v[196:199], v[60:63], v[36:39], v[196:199]
    v_mfma_f32_16x16x32_bf16 v[200:203], v[60:63], v[40:43], v[200:203]
    v_mfma_f32_16x16x32_bf16 v[204:207], v[60:63], v[44:47], v[204:207]
    s_add_u32 s67, s67, 1
    s_and_b32 s67, s67, 3
    s_cmp_eq_u32 s67, 0
    s_mov_b32 s66, 39936
    s_cselect_b32 s66, -119808, s66
    v_add_u32 v7, s66, v7
    v_add_u32 v8, s66, v8
    v_add_u32 v9, s66, v9
    v_add_u32 v10, s66, v10
    s_waitcnt vmcnt(8)
    s_waitcnt lgkmcnt(0)
    s_barrier
    ds_read_b128 v[16:19], v7 offset:0
    ds_read_b128 v[20:23], v7 offset:1024
    v_mfma_f32_16x16x32_bf16 v[208:211], v[48:51], v[32:35], v[208:211]
    v_mfma_f32_16x16x32_bf16 v[212:215], v[48:51], v[36:39], v[212:215]
    s_add_u32 m0, s64, s59
    s_nop 0
    buffer_load_dwordx4 v2, s[28:31], s52 offen lds
    v_mfma_f32_16x16x32_bf16 v[216:219], v[48:51], v[40:43], v[216:219]
    v_mfma_f32_16x16x32_bf16 v[220:223], v[48:51], v[44:47], v[220:223]
    ds_read_b64_tr_b16 v[48:49], v9 offset:0
    ds_read_b64_tr_b16 v[50:51], v9 offset:2304
    ds_read_b128 v[24:27], v7 offset:2048
    ds_read_b128 v[28:31], v7 offset:3072
    v_mfma_f32_16x16x32_bf16 v[224:227], v[52:55], v[32:35], v[224:227]
    v_mfma_f32_16x16x32_bf16 v[228:231], v[52:55], v[36:39], v[228:231]
    s_add_u32 m0, s64, s60
    s_nop 0
    buffer_load_dwordx4 v3, s[28:31], s52 offen lds
    s_add_u32 s52, s52, 64
    v_mfma_f32_16x16x32_bf16 v[232:235], v[52:55], v[40:43], v[232:235]
    v_mfma_f32_16x16x32_bf16 v[236:239], v[52:55], v[44:47], v[236:239]
    ds_read_b64_tr_b16 v[52:53], v9 offset:9216
    ds_read_b64_tr_b16 v[54:55], v9 offset:11520
    v_mfma_f32_16x16x32_bf16 v[240:243], v[56:59], v[32:35], v[240:243]
    v_mfma_f32_16x16x32_bf16 v[244:247], v[56:59], v[36:39], v[244:247]
    s_add_u32 m0, s64, s61
    s_nop 0
    buffer_load_dwordx4 v4, s[32:35], s53 offen lds
    s_add_u32 s53, s53, s56
    v_mfma_f32_16x16x32_bf16 v[248:251], v[56:59], v[40:43], v[248:251]
    v_mfma_f32_16x16x32_bf16 v[252:255], v[56:59], v[44:47], v[252:255]
    ds_read_b64_tr_b16 v[56:57], v10 offset:0
    ds_read_b64_tr_b16 v[58:59], v10 offset:1280
    s_mov_b32 s65, 5
L_k1_loop0:
    ds_read_b64_tr_b16 v[60:61], v8 offset:0
    ds_read_b64_tr_b16 v[62:63], v8 offset:2304
    s_waitcnt lgkmcnt(6)
    v_mfma_f32_16x16x32_bf16 v[80:83], v[48:51], v[16:19], v[80:83]
    v_mfma_f32_16x16x32_bf16 v[84:87], v[48:51], v[20:23], v[84:87]
    s_add_u32 m0, s64, s62
    s_nop 0
    buffer_load_dwordx4 v5, s[36:39], s54 offen lds
    s_add_u32 s54, s54, s57
    v_mfma_f32_16x16x32_bf16 v[88:91], v[48:51], v[24:27], v[88:91]
    v_mfma_f32_16x16x32_bf16 v[92:95], v[48:51], v[28:31], v[92:95]
    ds_read_b64_tr_b16 v[48:49], v8 offset:32
    ds_read_b64_tr_b16 v[50:51], v8 offset:2336
    s_waitcnt lgkmcnt(6)
    v_mfma_f32_16x16x32_bf16 v[96:99], v[52:55], v[16:19], v[96:99]
    v_mfma_f32_16x16x32_bf16 v[100:103], v[52:55], v[20:23], v[100:103]
    s_add_u32 m0, s64, s63
    s_nop 0
    buffer_load_dwordx4 v6, s[40:43], s55 offen lds
    s_add_u32 s55, s55, s58
    s_add_u32 s64, s64, 39936
    s_cmp_eq_u32 s64, 159744
    s_cselect_b32 s64, 0, s64
    v_mfma_f32_16x16x32_bf16 v[104:107], v[52:55], v[24:27], v[104:107]
    v_mfma_f32_16x16x32_bf16 v[108:111], v[52:55], v[28:31], v[108:111]
    ds_read_b64_tr_b16 v[52:53], v8 offset:9216
    ds_read_b64_tr_b16 v[54:55], v8 offset:11520
    s_waitcnt lgkmcnt(6)
    v_mfma_f32_16x16x32_bf16 v[112:115], v[56:59], v[16:19], v[112:115]
    v_mfma_f32_16x16x32_bf16 v[116:119], v[56:59], v[20:23], v[116:119]
    v_mfma_f32_16x16x32_bf16 v[120:123], v[56:59], v[24:27], v[120:123]
    v_mfma_f32_16x16x32_bf16 v[124:127], v[56:59], v[28:31], v[124:127]
    ds_read_b64_tr_b16 v[56:57], v8 offset:9248
    ds_read_b64_tr_b16 v[58:59], v8 offset:11552
    s_waitcnt lgkmcnt(6)
    v_mfma_f32_16x16x32_bf16 v[128:131], v[60:63], v[16:19], v[128:131]
    v_mfma_f32_16x16x32_bf16 v[132:135], v[60:63], v[20:23], v[132:135]
    v_mfma_f32_16x16x32_bf16 v[136:139], v[60:63], v[24:27], v[136:139]
    v_mfma_f32_16x16x32_bf16 v[140:143], v[60:63], v[28:31], v[140:143]
    ds_read_b64_tr_b16 v[60:61], v8 offset:64
    ds_read_b64_tr_b16 v[62:63], v8 offset:2368
    s_waitcnt lgkmcnt(6)
    v_mfma_f32_16x16x32_bf16 v[144:147], v[48:51], v[16:19], v[144:147]
    v_mfma_f32_16x16x32_bf16 v[148:151], v[48:51], v[20:23], v[148:151]
    v_mfma_f32_16x16x32_bf16 v[152:155], v[48:51], v[24:27], v[152:155]
    v_mfma_f32_16x16x32_bf16 v[156:159], v[48:51], v[28:31], v[156:159]
    ds_read_b64_tr_b16 v[48:49], v8 offset:96
    ds_read_b64_tr_b16 v[50:51], v8 offset:2400
    s_waitcnt lgkmcnt(6)
    v_mfma_f32_16x16x32_bf16 v[160:163], v[52:55], v[16:19], v[160:163]
    v_mfma_f32_16x16x32_bf16 v[164:167], v[52:55], v[20:23], v[164:167]
    v_mfma_f32_16x16x32_bf16 v[168:171], v[52:55], v[24:27], v[168:171]
    v_mfma_f32_16x16x32_bf16 v[172:175], v[52:55], v[28:31], v[172:175]
    ds_read_b64_tr_b16 v[52:53], v8 offset:9280
    ds_read_b64_tr_b16 v[54:55], v8 offset:11584
    s_waitcnt lgkmcnt(6)
    v_mfma_f32_16x16x32_bf16 v[176:179], v[56:59], v[16:19], v[176:179]
    v_mfma_f32_16x16x32_bf16 v[180:183], v[56:59], v[20:23], v[180:183]
    v_mfma_f32_16x16x32_bf16 v[184:187], v[56:59], v[24:27], v[184:187]
    v_mfma_f32_16x16x32_bf16 v[188:191], v[56:59], v[28:31], v[188:191]
    buffer_load_dword v79, v0, s[72:75], s76 offen
    s_add_u32 s76, s76, s77
    ds_read_b64_tr_b16 v[56:57], v8 offset:9312
    ds_read_b64_tr_b16 v[58:59], v8 offset:11616
    s_waitcnt lgkmcnt(6)
    v_mfma_f32_16x16x32_bf16 v[192:195], v[60:63], v[16:19], v[192:195]
    v_mfma_f32_16x16x32_bf16 v[196:199], v[60:63], v[20:23], v[196:199]
    v_mfma_f32_16x16x32_bf16 v[200:203], v[60:63], v[24:27], v[200:203]
    v_mfma_f32_16x16x32_bf16 v[204:207], v[60:63], v[28:31], v[204:207]
    s_add_u32 s67, s67, 1
    s_and_b32 s67, s67, 3
    s_cmp_eq_u32 s67, 0
    s_mov_b32 s66, 39936
    s_cselect_b32 s66, -119808, s66
    v_add_u32 v7, s66, v7
    v_add_u32 v8, s66, v8
    v_add_u32 v9, s66, v9
    v_add_u32 v10, s66, v10
    s_waitcnt vmcnt(6)
    s_waitcnt lgkmcnt(0)
    s_barrier
    ds_read_b128 v[32:35], v7 offset:0
    ds_read_b128 v[36:39], v7 offset:1024
    v_mfma_f32_16x16x32_bf16 v[208:211], v[48:51], v[16:19], v[208:211]
    v_mfma_f32_16x16x32_bf16 v[212:215], v[48:51], v[20:23], v[212:215]
    s_add_u32 m0, s64, s59
    s_nop 0
    buffer_load_dwordx4 v2, s[28:31], s52 offen lds
    v_mfma_f32_16x16x32_bf16 v[216:219], v[48:51], v[24:27], v[216:219]
    v_mfma_f32_16x16x32_bf16 v[220:223], v[48:51], v[28:31], v[220:223]
    ds_read_b64_tr_b16 v[48:49], v9 offset:0
    ds_read_b64_tr_b16 v[50:51], v9 offset:2304
    ds_read_b128 v[40:43], v7 offset:2048
    ds_read_b128 v[44:47], v7 offset:3072
    v_mfma_f32_16x16x32_bf16 v[224:227], v[52:55], v[16:19], v[224:227]
    v_mfma_f32_16x16x32_bf16 v[228:231], v[52:55], v[20:23], v[228:231]
    s_add_u32 m0, s64, s60
    s_nop 0
    buffer_load_dwordx4 v3, s[28:31], s52 offen lds
    s_add_u32 s52, s52, 64
    v_mfma_f32_16x16x32_bf16 v[232:235], v[52:55], v[24:27], v[232:235]
    v_mfma_f32_16x16x32_bf16 v[236:239], v[52:55], v[28:31], v[236:239]
    ds_read_b64_tr_b16 v[52:53], v9 offset:9216
    ds_read_b64_tr_b16 v[54:55], v9 offset:11520
    v_mfma_f32_16x16x32_bf16 v[240:243], v[56:59], v[16:19], v[240:243]
    v_mfma_f32_16x16x32_bf16 v[244:247], v[56:59], v[20:23], v[244:247]
    s_add_u32 m0, s64, s61
    s_nop 0
    buffer_load_dwordx4 v4, s[32:35], s53 offen lds
    s_add_u32 s53, s53, s56
    v_mfma_f32_16x16x32_bf16 v[248:251], v[56:59], v[24:27], v[248:251]
    v_mfma_f32_16x16x32_bf16 v[252:255], v[56:59], v[28:31], v[252:255]
    ds_read_b64_tr_b16 v[56:57], v10 offset:0
    ds_read_b64_tr_b16 v[58:59], v10 offset:1280
    ds_read_b64_tr_b16 v[60:61], v8 offset:0
    ds_read_b64_tr_b16 v[62:63], v8 offset:2304
    s_waitcnt lgkmcnt(6)
    v_mfma_f32_16x16x32_bf16 v[80:83], v[48:51], v[32:35], v[80:83]
    v_mfma_f32_16x16x32_bf16 v[84:87], v[48:51], v[36:39], v[84:87]
    s_add_u32 m0, s64, s62
    s_nop 0
    buffer_load_dwordx4 v5, s[36:39], s54 offen lds
    s_add_u32 s54, s54, s57
    v_mfma_f32_16x16x32_bf16 v[88:91], v[48:51], v[40:43], v[88:91]
    v_mfma_f32_16x16x32_bf16 v[92:95], v[48:51], v[44:47], v[92:95]
    ds_read_b64_tr_b16 v[48:49], v8 offset:32
    ds_read_b64_tr_b16 v[50:51], v8 offset:2336
    s_waitcnt lgkmcnt(6)
    v_mfma_f32_16x16x32_bf16 v[96:99], v[52:55], v[32:35], v[96:99]
    v_mfma_f32_16x16x32_bf16 v[100:103], v[52:55], v[36:39], v[100:103]
    s_add_u32 m0, s64, s63
    s_nop 0
    buffer_load_dwordx4 v6, s[40:43], s55 offen lds
    s_add_u32 s55, s55, s58
    s_add_u32 s64, s64, 39936
    s_cmp_eq_u32 s64, 159744
    s_cselect_b32 s64, 0, s64
    v_mfma_f32_16x16x32_bf16 v[104:107], v[52:55], v[40:43], v[104:107]
    v_mfma_f32_16x16x32_bf16 v[108:111], v[52:55], v[44:47], v[108:111]
    ds_read_b64_tr_b16 v[52:53], v8 offset:9216
    ds_read_b64_tr_b16 v[54:55], v8 offset:11520
    s_waitcnt lgkmcnt(6)
    v_mfma_f32_16x16x32_bf16 v[112:115], v[56:59], v[32:35], v[112:115]
    v_mfma_f32_16x16x32_bf16 v[116:119], v[56:59], v[36:39], v[116:119]
    v_mfma_f32_16x16x32_bf16 v[120:123], v[56:59], v[40:43], v[120:123]
    v_mfma_f32_16x16x32_bf16 v[124:127], v[56:59], v[44:47], v[124:127]
    ds_read_b64_tr_b16 v[56:57], v8 offset:9248
    ds_read_b64_tr_b16 v[58:59], v8 offset:11552
    s_waitcnt lgkmcnt(6)
    v_mfma_f32_16x16x32_bf16 v[128:131], v[60:63], v[32:35], v[128:131]
    v_mfma_f32_16x16x32_bf16 v[132:135], v[60:63], v[36:39], v[132:135]
    v_mfma_f32_16x16x32_bf16 v[136:139], v[60:63], v[40:43], v[136:139]
    v_mfma_f32_16x16x32_bf16 v[140:143], v[60:63], v[44:47], v[140:143]
    ds_read_b64_tr_b16 v[60:61], v8 offset:64
    ds_read_b64_tr_b16 v[62:63], v8 offset:2368
    s_waitcnt lgkmcnt(6)
    v_mfma_f32_16x16x32_bf16 v[144:147], v[48:51], v[32:35], v[144:147]
    v_mfma_f32_16x16x32_bf16 v[148:151], v[48:51], v[36:39], v[148:151]
    v_mfma_f32_16x16x32_bf16 v[152:155], v[48:51], v[40:43], v[152:155]
    v_mfma_f32_16x16x32_bf16 v[156:159], v[48:51], v[44:47], v[156:159]
    ds_read_b64_tr_b16 v[48:49], v8 offset:96
    ds_read_b64_tr_b16 v[50:51], v8 offset:2400
    s_waitcnt lgkmcnt(6)
    v_mfma_f32_16x16x32_bf16 v[160:163], v[52:55], v[32:35], v[160:163]
    v_mfma_f32_16x16x32_bf16 v[164:167], v[52:55], v[36:39], v[164:167]
    v_mfma_f32_16x16x32_bf16 v[168:171], v[52:55], v[40:43], v[168:171]
    v_mfma_f32_16x16x32_bf16 v[172:175], v[52:55], v[44:47], v[172:175]
    ds_read_b64_tr_b16 v[52:53], v8 offset:9280
    ds_read_b64_tr_b16 v[54:55], v8 offset:11584
    s_waitcnt lgkmcnt(6)
    v_mfma_f32_16x16x32_bf16 v[176:179], v[56:59], v[32:35], v[176:179]
    v_mfma_f32_16x16x32_bf16 v[180:183], v[56:59], v[36:39], v[180:183]
    v_mfma_f32_16x16x32_bf16 v[184:187], v[56:59], v[40:43], v[184:187]
    v_mfma_f32_16x16x32_bf16 v[188:191], v[56:59], v[44:47], v[188:191]
    ds_read_b64_tr_b16 v[56:57], v8 offset:9312
    ds_read_b64_tr_b16 v[58:59], v8 offset:11616
    s_waitcnt lgkmcnt(6)
    v_mfma_f32_16x16x32_bf16 v[192:195], v[60:63], v[32:35], v[192:195]
    v_mfma_f32_16x16x32_bf16 v[196:199], v[60:63], v[36:39], v[196:199]
    v_mfma_f32_16x16x32_bf16 v[200:203], v[60:63], v[40:43], v[200:203]
    v_mfma_f32_16x16x32_bf16 v[204:207], v[60:63], v[44:47], v[204:207]
    s_add_u32 s67, s67, 1
    s_and_b32 s67, s67, 3
    s_cmp_eq_u32 s67, 0
    s_mov_b32 s66, 39936
    s_cselect_b32 s66, -119808, s66
    v_add_u32 v7, s66, v7
    v_add_u32 v8, s66, v8
    v_add_u32 v9, s66, v9
    v_add_u32 v10, s66, v10
    s_waitcnt vmcnt(6)
    s_waitcnt lgkmcnt(0)
    s_barrier
    ds_read_b128 v[16:19], v7 offset:0
    ds_read_b128 v[20:23], v7 offset:1024
    v_mfma_f32_16x16x32_bf16 v[208:211], v[48:51], v[32:35], v[208:211]
    v_mfma_f32_16x16x32_bf16 v[212:215], v[48:51], v[36:39], v[212:215]
    s_add_u32 m0, s64, s59
    s_nop 0
    buffer_load_dwordx4 v2, s[28:31], s52 offen lds
    v_mfma_f32_16x16x32_bf16 v[216:219], v[48:51], v[40:43], v[216:219]
    v_mfma_f32_16x16x32_bf16 v[220:223], v[48:51], v[44:47], v[220:223]
    ds_read_b64_tr_b16 v[48:49], v9 offset:0
    ds_read_b64_tr_b16 v[50:51], v9 offset:2304
    ds_read_b128 v[24:27], v7 offset:2048
    ds_read_b128 v[28:31], v7 offset:3072
    v_mfma_f32_16x16x32_bf16 v[224:227], v[52:55], v[32:35], v[224:227]
    v_mfma_f32_16x16x32_bf16 v[228:231], v[52:55], v[36:39], v[228:231]
    s_add_u32 m0, s64, s60
    s_nop 0
    buffer_load_dwordx4 v3, s[28:31], s52 offen lds
    s_add_u32 s52, s52, 64
    v_mfma_f32_16x16x32_bf16 v[232:235], v[52:55], v[40:43], v[232:235]
    v_mfma_f32_16x16x32_bf16 v[236:239], v[52:55], v[44:47], v[236:239]
    ds_read_b64_tr_b16 v[52:53], v9 offset:9216
    ds_read_b64_tr_b16 v[54:55], v9 offset:11520
    v_mfma_f32_16x16x32_bf16 v[240:243], v[56:59], v[32:35], v[240:243]
    v_mfma_f32_16x16x32_bf16 v[244:247], v[56:59], v[36:39], v[244:247]
    s_add_u32 m0, s64, s61
    s_nop 0
    buffer_load_dwordx4 v4, s[32:35], s53 offen lds
    s_add_u32 s53, s53, s56
    v_mfma_f32_16x16x32_bf16 v[248:251], v[56:59], v[40:43], v[248:251]
    v_mfma_f32_16x16x32_bf16 v[252:255], v[56:59], v[44:47], v[252:255]
    ds_read_b64_tr_b16 v[56:57], v10 offset:0
    ds_read_b64_tr_b16 v[58:59], v10 offset:1280
    s_sub_u32 s65, s65, 1
    s_cmp_lg_u32 s65, 0
    s_cbranch_scc1 L_k1_loop0
    ds_read_b64_tr_b16 v[60:61], v8 offset:0
    ds_read_b64_tr_b16 v[62:63], v8 offset:2304
    s_waitcnt lgkmcnt(6)
    v_mfma_f32_16x16x32_bf16 v[80:83], v[48:51], v[16:19], v[80:83]
    v_mfma_f32_16x16x32_bf16 v[84:87], v[48:51], v[20:23], v[84:87]
    s_add_u32 m0, s64, s62
    s_nop 0
    buffer_load_dwordx4 v5, s[36:39], s54 offen lds
    s_add_u32 s54, s54, s57
    v_mfma_f32_16x16x32_bf16 v[88:91], v[48:51], v[24:27], v[88:91]
    v_mfma_f32_16x16x32_bf16 v[92:95], v[48:51], v[28:31], v[92:95]
    ds_read_b64_tr_b16 v[48:49], v8 offset:32
    ds_read_b64_tr_b16 v[50:51], v8 offset:2336
    s_waitcnt lgkmcnt(6)
    v_mfma_f32_16x16x32_bf16 v[96:99], v[52:55], v[16:19], v[96:99]
    v_mfma_f32_16x16x32_bf16 v[100:103], v[52:55], v[20:23], v[100:103]
    s_add_u32 m0, s64, s63
    s_nop 0
    buffer_load_dwordx4 v6, s[40:43], s55 offen lds
    s_add_u32 s55, s55, s58
    s_add_u32 s64, s64, 39936
    s_cmp_eq_u32 s64, 159744
    s_cselect_b32 s64, 0, s64
    v_mfma_f32_16x16x32_bf16 v[104:107], v[52:55], v[24:27], v[104:107]
    v_mfma_f32_16x16x32_bf16 v[108:111], v[52:55], v[28:31], v[108:111]
    ds_read_b64_tr_b16 v[52:53], v8 offset:9216
    ds_read_b64_tr_b16 v[54:55], v8 offset:11520
    s_waitcnt lgkmcnt(6)
    v_mfma_f32_16x16x32_bf16 v[112:115], v[56:59], v[16:19], v[112:115]
    v_mfma_f32_16x16x32_bf16 v[116:119], v[56:59], v[20:23], v[116:119]
    v_mfma_f32_16x16x32_bf16 v[120:123], v[56:59], v[24:27], v[120:123]
    v_mfma_f32_16x16x32_bf16 v[124:127], v[56:59], v[28:31], v[124:127]
    ds_read_b64_tr_b16 v[56:57], v8 offset:9248
    ds_read_b64_tr_b16 v[58:59], v8 offset:11552
    s_waitcnt lgkmcnt(6)
    v_mfma_f32_16x16x32_bf16 v[128:131], v[60:63], v[16:19], v[128:131]
    v_mfma_f32_16x16x32_bf16 v[132:135], v[60:63], v[20:23], v[132:135]
    v_mfma_f32_16x16x32_bf16 v[136:139], v[60:63], v[24:27], v[136:139]
    v_mfma_f32_16x16x32_bf16 v[140:143], v[60:63], v[28:31], v[140:143]
    buffer_load_dwordx4 v[64:67], v14, s[28:31], s71 offen
    ds_read_b64_tr_b16 v[60:61], v8 offset:64
    ds_read_b64_tr_b16 v[62:63], v8 offset:2368
    s_waitcnt lgkmcnt(6)
    v_mfma_f32_16x16x32_bf16 v[144:147], v[48:51], v[16:19], v[144:147]
    v_mfma_f32_16x16x32_bf16 v[148:151], v[48:51], v[20:23], v[148:151]
    v_mfma_f32_16x16x32_bf16 v[152:155], v[48:51], v[24:27], v[152:155]
    v_mfma_f32_16x16x32_bf16 v[156:159], v[48:51], v[28:31], v[156:159]
    buffer_load_dwordx4 v[68:71], v14, s[28:31], s71 offen offset:16
    ds_read_b64_tr_b16 v[48:49], v8 offset:96
    ds_read_b64_tr_b16 v[50:51], v8 offset:2400
    s_waitcnt lgkmcnt(6)
    v_mfma_f32_16x16x32_bf16 v[160:163], v[52:55], v[16:19], v[160:163]
    v_mfma_f32_16x16x32_bf16 v[164:167], v[52:55], v[20:23], v[164:167]
    v_mfma_f32_16x16x32_bf16 v[168:171], v[52:55], v[24:27], v[168:171]
    v_mfma_f32_16x16x32_bf16 v[172:175], v[52:55], v[28:31], v[172:175]
    buffer_load_dwordx4 v[72:75], v14, s[48:51], 0 offen
    ds_read_b64_tr_b16 v[52:53], v8 offset:9280
    ds_read_b64_tr_b16 v[54:55], v8 offset:11584
    s_waitcnt lgkmcnt(6)
    v_mfma_f32_16x16x32_bf16 v[176:179], v[56:59], v[16:19], v[176:179]
    v_mfma_f32_16x16x32_bf16 v[180:183], v[56:59], v[20:23], v[180:183]
    v_mfma_f32_16x16x32_bf16 v[184:187], v[56:59], v[24:27], v[184:187]
    v_mfma_f32_16x16x32_bf16 v[188:191], v[56:59], v[28:31], v[188:191]
    buffer_load_dwordx4 v[76:79], v14, s[48:51], 0 offen offset:16
    ds_read_b64_tr_b16 v[56:57], v8 offset:9312
    ds_read_b64_tr_b16 v[58:59], v8 offset:11616
    s_waitcnt lgkmcnt(6)
    v_mfma_f32_16x16x32_bf16 v[192:195], v[60:63], v[16:19], v[192:195]
    v_mfma_f32_16x16x32_bf16 v[196:199], v[60:63], v[20:23], v[196:199]
    v_mfma_f32_16x16x32_bf16 v[200:203], v[60:63], v[24:27], v[200:203]
    v_mfma_f32_16x16x32_bf16 v[204:207], v[60:63], v[28:31], v[204:207]
    s_add_u32 s67, s67, 1
    s_and_b32 s67, s67, 3
    s_cmp_eq_u32 s67, 0
    s_mov_b32 s66, 39936
    s_cselect_b32 s66, -119808, s66
    v_add_u32 v7, s66, v7
    v_add_u32 v8, s66, v8
    v_add_u32 v9, s66, v9
    v_add_u32 v10, s66, v10
    s_waitcnt vmcnt(9)
    s_waitcnt lgkmcnt(0)
    s_barrier
    ds_read_b128 v[32:35], v7 offset:0
    ds_read_b128 v[36:39], v7 offset:1024
    v_mfma_f32_16x16x32_bf16 v[208:211], v[48:51], v[16:19], v[208:211]
    v_mfma_f32_16x16x32_bf16 v[212:215], v[48:51], v[20:23], v[212:215]
    s_add_u32 m0, s64, s59
    s_nop 0
    buffer_load_dwordx4 v2, s[28:31], s52 offen lds
    v_mfma_f32_16x16x32_bf16 v[216:219], v[48:51], v[24:27], v[216:219]
    v_mfma_f32_16x16x32_bf16 v[220:223], v[48:51], v[28:31], v[220:223]
    ds_read_b64_tr_b16 v[48:49], v9 offset:0
    ds_read_b64_tr_b16 v[50:51], v9 offset:2304
    ds_read_b128 v[40:43], v7 offset:2048
    ds_read_b128 v[44:47], v7 offset:3072
    v_mfma_f32_16x16x32_bf16 v[224:227], v[52:55], v[16:19], v[224:227]
    v_mfma_f32_16x16x32_bf16 v[228:231], v[52:55], v[20:23], v[228:231]
    s_add_u32 m0, s64, s60
    s_nop 0
    buffer_load_dwordx4 v3, s[28:31], s52 offen lds
    s_add_u32 s52, s52, 64
    v_mfma_f32_16x16x32_bf16 v[232:235], v[52:55], v[24:27], v[232:235]
    v_mfma_f32_16x16x32_bf16 v[236:239], v[52:55], v[28:31], v[236:239]
    ds_read_b64_tr_b16 v[52:53], v9 offset:9216
    ds_read_b64_tr_b16 v[54:55], v9 offset:11520
    v_mfma_f32_16x16x32_bf16 v[240:243], v[56:59], v[16:19], v[240:243]
    v_mfma_f32_16x16x32_bf16 v[244:247], v[56:59], v[20:23], v[244:247]
    s_add_u32 m0, s64, s61
    s_nop 0
    buffer_load_dwordx4 v4, s[32:35], s53 offen lds
    s_add_u32 s53, s53, s56
    v_mfma_f32_16x16x32_bf16 v[248:251], v[56:59], v[24:27], v[248:251]
    v_mfma_f32_16x16x32_bf16 v[252:255], v[56:59], v[28:31], v[252:255]
    ds_read_b64_tr_b16 v[56:57], v10 offset:0
    ds_read_b64_tr_b16 v[58:59], v10 offset:1280
    s_waitcnt vmcnt(3)
    ds_read_b64_tr_b16 v[60:61], v8 offset:0
    ds_read_b64_tr_b16 v[62:63], v8 offset:2304
    s_waitcnt lgkmcnt(6)
    v_mfma_f32_16x16x32_bf16 v[80:83], v[48:51], v[32:35], v[80:83]
    v_mov_b32 v11, 0
    v_dot2_f32_bf16 v11, v64, v72, v11
    v_mfma_f32_16x16x32_bf16 v[84:87], v[48:51], v[36:39], v[84:87]
    s_add_u32 m0, s64, s62
    s_nop 0
    buffer_load_dwordx4 v5, s[36:39], s54 offen lds
    s_add_u32 s54, s54, s57
    v_dot2_f32_bf16 v11, v65, v73, v11
    v_dot2_f32_bf16 v11, v66, v74, v11
    v_mfma_f32_16x16x32_bf16 v[88:91], v[48:51], v[40:43], v[88:91]
    v_dot2_f32_bf16 v11, v67, v75, v11
    v_dot2_f32_bf16 v11, v68, v76, v11
    v_mfma_f32_16x16x32_bf16 v[92:95], v[48:51], v[44:47], v[92:95]
    v_dot2_f32_bf16 v11, v69, v77, v11
    v_dot2_f32_bf16 v11, v70, v78, v11
    ds_read_b64_tr_b16 v[48:49], v8 offset:32
    ds_read_b64_tr_b16 v[50:51], v8 offset:2336
    s_waitcnt lgkmcnt(6)
    v_mfma_f32_16x16x32_bf16 v[96:99], v[52:55], v[32:35], v[96:99]
    v_dot2_f32_bf16 v11, v71, v79, v11
    s_nop 2
    v_add_f32_dpp v11, v11, v11 row_shr:1 row_mask:0xf bank_mask:0xf bound_ctrl:0
    v_mfma_f32_16x16x32_bf16 v[100:103], v[52:55], v[36:39], v[100:103]
    s_add_u32 m0, s64, s63
    s_nop 0
    buffer_load_dwordx4 v6, s[40:43], s55 offen lds
    s_add_u32 s55, s55, s58
    s_add_u32 s64, s64, 39936
    s_cmp_eq_u32 s64, 159744
    s_cselect_b32 s64, 0, s64
    v_add_f32_dpp v11, v11, v11 row_shr:2 row_mask:0xf bank_mask:0xf bound_ctrl:0
    s_nop 1
    v_add_f32_dpp v11, v11, v11 row_shr:4 row_mask:0xf bank_mask:0xf bound_ctrl:0
    v_mfma_f32_16x16x32_bf16 v[104:107], v[52:55], v[40:43], v[104:107]
    s_nop 0
    v_add_f32_dpp v11, v11, v11 row_shr:8 row_mask:0xf bank_mask:0xf bound_ctrl:0
    s_nop 0
    v_readlane_b32 s78, v11, 15
    v_mfma_f32_16x16x32_bf16 v[108:111], v[52:55], v[44:47], v[108:111]
    v_readlane_b32 s79, v11, 31
    v_readlane_b32 s80, v11, 47
    ds_read_b64_tr_b16 v[52:53], v8 offset:9216
    ds_read_b64_tr_b16 v[54:55], v8 offset:11520
    s_waitcnt lgkmcnt(6)
    v_mfma_f32_16x16x32_bf16 v[112:115], v[56:59], v[32:35], v[112:115]
    v_mov_b32 v11, s78
    v_add_f32 v11, s79, v11
    v_mfma_f32_16x16x32_bf16 v[116:119], v[56:59], v[36:39], v[116:119]
    v_add_f32 v11, s80, v11
    v_cvt_pk_bf16_f32 v11, v11, v11
    v_mfma_f32_16x16x32_bf16 v[120:123], v[56:59], v[40:43], v[120:123]
    v_lshlrev_b32 v11, 16, v11
    v_mul_f32 v11, 0xbfb8aa3b, v11
    v_mfma_f32_16x16x32_bf16 v[124:127], v[56:59], v[44:47], v[124:127]
    v_exp_f32 v11, v11
    s_nop 0
    v_add_f32 v11, 1.0, v11
    ds_read_b64_tr_b16 v[56:57], v8 offset:9248
    ds_read_b64_tr_b16 v[58:59], v8 offset:11552
    s_waitcnt lgkmcnt(6)
    v_mfma_f32_16x16x32_bf16 v[128:131], v[60:63], v[32:35], v[128:131]
    v_rcp_f32 v11, v11
    s_nop 0
    v_cvt_pk_bf16_f32 v11, v11, v11
    v_mfma_f32_16x16x32_bf16 v[132:135], v[60:63], v[36:39], v[132:135]
    v_lshlrev_b32 v11, 16, v11
    v_sub_f32 v12, 1.0, v11
    v_mfma_f32_16x16x32_bf16 v[136:139], v[60:63], v[40:43], v[136:139]
    v_cvt_pk_bf16_f32 v12, v12, v12
    v_lshlrev_b32 v12, 16, v12
    v_mfma_f32_16x16x32_bf16 v[140:143], v[60:63], v[44:47], v[140:143]
    s_lshl_b32 s78, s70, 2
    s_add_u32 s78, s78, 22347776
    ds_read_b64_tr_b16 v[60:61], v8 offset:64
    ds_read_b64_tr_b16 v[62:63], v8 offset:2368
    s_waitcnt lgkmcnt(6)
    v_mfma_f32_16x16x32_bf16 v[144:147], v[48:51], v[32:35], v[144:147]
    s_add_u32 s79, s78, 8192
    v_mov_b32 v13, 0
    v_mfma_f32_16x16x32_bf16 v[148:151], v[48:51], v[36:39], v[148:151]
    s_mov_b64 exec, 1
    buffer_store_dword v11, v13, s[44:47], s78 offen sc1
    buffer_store_dword v12, v13, s[44:47], s79 offen sc1
    s_mov_b64 exec, -1
    v_mfma_f32_16x16x32_bf16 v[152:155], v[48:51], v[40:43], v[152:155]
    v_mfma_f32_16x16x32_bf16 v[156:159], v[48:51], v[44:47], v[156:159]
    ds_read_b64_tr_b16 v[48:49], v8 offset:96
    ds_read_b64_tr_b16 v[50:51], v8 offset:2400
    s_waitcnt lgkmcnt(6)
    v_mfma_f32_16x16x32_bf16 v[160:163], v[52:55], v[32:35], v[160:163]
    v_mfma_f32_16x16x32_bf16 v[164:167], v[52:55], v[36:39], v[164:167]
    v_mfma_f32_16x16x32_bf16 v[168:171], v[52:55], v[40:43], v[168:171]
    v_mfma_f32_16x16x32_bf16 v[172:175], v[52:55], v[44:47], v[172:175]
    ds_read_b64_tr_b16 v[52:53], v8 offset:9280
    ds_read_b64_tr_b16 v[54:55], v8 offset:11584
    s_waitcnt lgkmcnt(6)
    v_mfma_f32_16x16x32_bf16 v[176:179], v[56:59], v[32:35], v[176:179]
    v_mfma_f32_16x16x32_bf16 v[180:183], v[56:59], v[36:39], v[180:183]
    v_mfma_f32_16x16x32_bf16 v[184:187], v[56:59], v[40:43], v[184:187]
    v_mfma_f32_16x16x32_bf16 v[188:191], v[56:59], v[44:47], v[188:191]
    ds_read_b64_tr_b16 v[56:57], v8 offset:9312
    ds_read_b64_tr_b16 v[58:59], v8 offset:11616
    s_waitcnt lgkmcnt(6)
    v_mfma_f32_16x16x32_bf16 v[192:195], v[60:63], v[32:35], v[192:195]
    v_mfma_f32_16x16x32_bf16 v[196:199], v[60:63], v[36:39], v[196:199]
    v_mfma_f32_16x16x32_bf16 v[200:203], v[60:63], v[40:43], v[200:203]
    v_mfma_f32_16x16x32_bf16 v[204:207], v[60:63], v[44:47], v[204:207]
    s_add_u32 s67, s67, 1
    s_and_b32 s67, s67, 3
    s_cmp_eq_u32 s67, 0
    s_mov_b32 s66, 39936
    s_cselect_b32 s66, -119808, s66
    v_add_u32 v7, s66, v7
    v_add_u32 v8, s66, v8
    v_add_u32 v9, s66, v9
    v_add_u32 v10, s66, v10
    s_waitcnt vmcnt(0)
    s_waitcnt lgkmcnt(0)
    s_barrier
    ds_read_b128 v[16:19], v7 offset:0
    ds_read_b128 v[20:23], v7 offset:1024
    v_mfma_f32_16x16x32_bf16 v[208:211], v[48:51], v[32:35], v[208:211]
    v_mfma_f32_16x16x32_bf16 v[212:215], v[48:51], v[36:39], v[212:215]
    s_add_u32 m0, s64, s59
    s_nop 0
    buffer_load_dwordx4 v2, s[28:31], s52 offen lds
    v_mfma_f32_16x16x32_bf16 v[216:219], v[48:51], v[40:43], v[216:219]
    v_mfma_f32_16x16x32_bf16 v[220:223], v[48:51], v[44:47], v[220:223]
    ds_read_b64_tr_b16 v[48:49], v9 offset:0
    ds_read_b64_tr_b16 v[50:51], v9 offset:2304
    ds_read_b128 v[24:27], v7 offset:2048
    ds_read_b128 v[28:31], v7 offset:3072
    v_mfma_f32_16x16x32_bf16 v[224:227], v[52:55], v[32:35], v[224:227]
    v_mfma_f32_16x16x32_bf16 v[228:231], v[52:55], v[36:39], v[228:231]
    s_add_u32 m0, s64, s60
    s_nop 0
    buffer_load_dwordx4 v3, s[28:31], s52 offen lds
    s_add_u32 s52, s52, 64
    v_mfma_f32_16x16x32_bf16 v[232:235], v[52:55], v[40:43], v[232:235]
    v_mfma_f32_16x16x32_bf16 v[236:239], v[52:55], v[44:47], v[236:239]
    ds_read_b64_tr_b16 v[52:53], v9 offset:9216
    ds_read_b64_tr_b16 v[54:55], v9 offset:11520
    v_mfma_f32_16x16x32_bf16 v[240:243], v[56:59], v[32:35], v[240:243]
    v_mfma_f32_16x16x32_bf16 v[244:247], v[56:59], v[36:39], v[244:247]
    s_add_u32 m0, s64, s61
    s_nop 0
    buffer_load_dwordx4 v4, s[32:35], s53 offen lds
    s_add_u32 s53, s53, s56
    v_mfma_f32_16x16x32_bf16 v[248:251], v[56:59], v[40:43], v[248:251]
    v_mfma_f32_16x16x32_bf16 v[252:255], v[56:59], v[44:47], v[252:255]
    ds_read_b64_tr_b16 v[56:57], v10 offset:0
    ds_read_b64_tr_b16 v[58:59], v10 offset:1280
    s_mov_b32 s48, s16
    s_mov_b32 s49, s17
    s_mov_b32 s50, 256
    s_mov_b32 s51, 0x20000
    v_mov_b32 v11, 252
    buffer_load_dword v79, v11, s[48:51], 0 offen sc1
    v_add_u32 v68, 39936, v7
    v_add_u32 v70, 39936, v9
    v_add_u32 v71, 39936, v10
    ds_read_b128 v[32:35], v68 offset:0
    ds_read_b128 v[36:39], v68 offset:1024
    ds_read_b128 v[40:43], v68 offset:2048
    ds_read_b128 v[44:47], v68 offset:3072
    ds_read_b64_tr_b16 v[60:61], v70 offset:0
    ds_read_b64_tr_b16 v[62:63], v70 offset:2304
    s_waitcnt lgkmcnt(10)
    v_mfma_f32_16x16x32_bf16 v[80:83], v[48:51], v[16:19], v[80:83]
    v_mfma_f32_16x16x32_bf16 v[84:87], v[48:51], v[20:23], v[84:87]
    s_add_u32 m0, s64, s62
    s_nop 0
    buffer_load_dwordx4 v5, s[36:39], s54 offen lds
    s_add_u32 s54, s54, s57
    v_mfma_f32_16x16x32_bf16 v[88:91], v[48:51], v[24:27], v[88:91]
    v_mfma_f32_16x16x32_bf16 v[92:95], v[48:51], v[28:31], v[92:95]
    s_add_u32 m0, s64, s63
    s_nop 0
    buffer_load_dwordx4 v6, s[40:43], s55 offen lds
    s_add_u32 s55, s55, s58
    s_add_u32 s64, s64, 39936
    s_cmp_eq_u32 s64, 159744
    s_cselect_b32 s64, 0, s64
    ds_read_b64_tr_b16 v[48:49], v70 offset:9216
    ds_read_b64_tr_b16 v[50:51], v70 offset:11520
    s_waitcnt lgkmcnt(10)
    v_mfma_f32_16x16x32_bf16 v[96:99], v[52:55], v[16:19], v[96:99]
    v_mfma_f32_16x16x32_bf16 v[100:103], v[52:55], v[20:23], v[100:103]
    s_add_u32 m0, s64, s59
    s_nop 0
    buffer_load_dwordx4 v2, s[28:31], s52 offen lds
    v_mfma_f32_16x16x32_bf16 v[104:107], v[52:55], v[24:27], v[104:107]
    v_mfma_f32_16x16x32_bf16 v[108:111], v[52:55], v[28:31], v[108:111]
    s_add_u32 m0, s64, s60
    s_nop 0
    buffer_load_dwordx4 v3, s[28:31], s52 offen lds
    s_add_u32 s52, s52, 64
    ds_read_b64_tr_b16 v[52:53], v71 offset:0
    ds_read_b64_tr_b16 v[54:55], v71 offset:1280
    s_waitcnt lgkmcnt(10)
    v_mfma_f32_16x16x32_bf16 v[112:115], v[56:59], v[16:19], v[112:115]
    v_mfma_f32_16x16x32_bf16 v[116:119], v[56:59], v[20:23], v[116:119]
    s_add_u32 m0, s64, s61
    s_nop 0
    buffer_load_dwordx4 v4, s[32:35], s53 offen lds
    s_add_u32 s53, s53, s56
    v_mfma_f32_16x16x32_bf16 v[120:123], v[56:59], v[24:27], v[120:123]
    v_mfma_f32_16x16x32_bf16 v[124:127], v[56:59], v[28:31], v[124:127]
    s_add_u32 m0, s64, s62
    s_nop 0
    buffer_load_dwordx4 v5, s[36:39], s54 offen lds
    s_add_u32 s54, s54, s57
    v_add_u32 v64, 0, v7
    v_add_u32 v65, 0, v8
    ds_read_b128 v[16:19], v64 offset:0
    ds_read_b128 v[20:23], v64 offset:1024
    ds_read_b128 v[24:27], v64 offset:2048
    ds_read_b128 v[28:31], v64 offset:3072
    ds_read_b64_tr_b16 v[56:57], v65 offset:0
    ds_read_b64_tr_b16 v[58:59], v65 offset:2304
    s_waitcnt lgkmcnt(10)
    v_mfma_f32_16x16x32_bf16 v[80:83], v[60:63], v[32:35], v[80:83]
    v_mfma_f32_16x16x32_bf16 v[84:87], v[60:63], v[36:39], v[84:87]
    s_add_u32 m0, s64, s63
    s_nop 0
    buffer_load_dwordx4 v6, s[40:43], s55 offen lds
    s_add_u32 s55, s55, s58
    s_add_u32 s64, s64, 39936
    s_cmp_eq_u32 s64, 159744
    s_cselect_b32 s64, 0, s64
    v_mfma_f32_16x16x32_bf16 v[88:91], v[60:63], v[40:43], v[88:91]
    v_mfma_f32_16x16x32_bf16 v[92:95], v[60:63], v[44:47], v[92:95]
    ds_read_b64_tr_b16 v[60:61], v65 offset:32
    ds_read_b64_tr_b16 v[62:63], v65 offset:2336
    s_waitcnt lgkmcnt(10)
    v_mfma_f32_16x16x32_bf16 v[96:99], v[48:51], v[32:35], v[96:99]
    v_mfma_f32_16x16x32_bf16 v[100:103], v[48:51], v[36:39], v[100:103]
    v_mfma_f32_16x16x32_bf16 v[104:107], v[48:51], v[40:43], v[104:107]
    v_mfma_f32_16x16x32_bf16 v[108:111], v[48:51], v[44:47], v[108:111]
    ds_read_b64_tr_b16 v[48:49], v65 offset:9216
    ds_read_b64_tr_b16 v[50:51], v65 offset:11520
    s_waitcnt lgkmcnt(10)
    v_mfma_f32_16x16x32_bf16 v[112:115], v[52:55], v[32:35], v[112:115]
    v_mfma_f32_16x16x32_bf16 v[116:119], v[52:55], v[36:39], v[116:119]
    v_mfma_f32_16x16x32_bf16 v[120:123], v[52:55], v[40:43], v[120:123]
    v_mfma_f32_16x16x32_bf16 v[124:127], v[52:55], v[44:47], v[124:127]
    ds_read_b64_tr_b16 v[52:53], v65 offset:9248
    ds_read_b64_tr_b16 v[54:55], v65 offset:11552
    s_waitcnt lgkmcnt(6)
    v_mfma_f32_16x16x32_bf16 v[128:131], v[56:59], v[16:19], v[128:131]
    v_mfma_f32_16x16x32_bf16 v[132:135], v[56:59], v[20:23], v[132:135]
    v_mfma_f32_16x16x32_bf16 v[136:139], v[56:59], v[24:27], v[136:139]
    v_mfma_f32_16x16x32_bf16 v[140:143], v[56:59], v[28:31], v[140:143]
    v_add_u32 v68, 39936, v7
    v_add_u32 v69, 39936, v8
    ds_read_b128 v[32:35], v68 offset:0
    ds_read_b128 v[36:39], v68 offset:1024
    ds_read_b128 v[40:43], v68 offset:2048
    ds_read_b128 v[44:47], v68 offset:3072
    ds_read_b64_tr_b16 v[56:57], v69 offset:0
    ds_read_b64_tr_b16 v[58:59], v69 offset:2304
    s_waitcnt lgkmcnt(10)
    v_mfma_f32_16x16x32_bf16 v[144:147], v[60:63], v[16:19], v[144:147]
    v_mfma_f32_16x16x32_bf16 v[148:151], v[60:63], v[20:23], v[148:151]
    v_mfma_f32_16x16x32_bf16 v[152:155], v[60:63], v[24:27], v[152:155]
    v_mfma_f32_16x16x32_bf16 v[156:159], v[60:63], v[28:31], v[156:159]
    ds_read_b64_tr_b16 v[60:61], v69 offset:32
    ds_read_b64_tr_b16 v[62:63], v69 offset:2336
    s_waitcnt lgkmcnt(10)
    v_mfma_f32_16x16x32_bf16 v[160:163], v[48:51], v[16:19], v[160:163]
    v_mfma_f32_16x16x32_bf16 v[164:167], v[48:51], v[20:23], v[164:167]
    v_mfma_f32_16x16x32_bf16 v[168:171], v[48:51], v[24:27], v[168:171]
    v_mfma_f32_16x16x32_bf16 v[172:175], v[48:51], v[28:31], v[172:175]
    ds_read_b64_tr_b16 v[48:49], v69 offset:9216
    ds_read_b64_tr_b16 v[50:51], v69 offset:11520
    s_waitcnt lgkmcnt(10)
    v_mfma_f32_16x16x32_bf16 v[176:179], v[52:55], v[16:19], v[176:179]
    v_mfma_f32_16x16x32_bf16 v[180:183], v[52:55], v[20:23], v[180:183]
    v_mfma_f32_16x16x32_bf16 v[184:187], v[52:55], v[24:27], v[184:187]
    v_mfma_f32_16x16x32_bf16 v[188:191], v[52:55], v[28:31], v[188:191]
    ds_read_b64_tr_b16 v[52:53], v69 offset:9248
    ds_read_b64_tr_b16 v[54:55], v69 offset:11552
    s_waitcnt lgkmcnt(6)
    v_mfma_f32_16x16x32_bf16 v[128:131], v[56:59], v[32:35], v[128:131]
    v_mfma_f32_16x16x32_bf16 v[132:135], v[56:59], v[36:39], v[132:135]
    v_mfma_f32_16x16x32_bf16 v[136:139], v[56:59], v[40:43], v[136:139]
    v_mfma_f32_16x16x32_bf16 v[140:143], v[56:59], v[44:47], v[140:143]
    s_waitcnt vmcnt(0)
    v_readfirstlane_b32 s3, v79
    s_barrier
    v_add_u32 v64, -79872, v7
    v_add_u32 v66, -79872, v9
    v_add_u32 v67, -79872, v10
    ds_read_b128 v[16:19], v64 offset:0
    ds_read_b128 v[20:23], v64 offset:1024
    ds_read_b128 v[24:27], v64 offset:2048
    ds_read_b128 v[28:31], v64 offset:3072
    ds_read_b64_tr_b16 v[56:57], v66 offset:0
    ds_read_b64_tr_b16 v[58:59], v66 offset:2304
    s_waitcnt lgkmcnt(10)
    v_mfma_f32_16x16x32_bf16 v[144:147], v[60:63], v[32:35], v[144:147]
    v_mfma_f32_16x16x32_bf16 v[148:151], v[60:63], v[36:39], v[148:151]
    v_mfma_f32_16x16x32_bf16 v[152:155], v[60:63], v[40:43], v[152:155]
    v_mfma_f32_16x16x32_bf16 v[156:159], v[60:63], v[44:47], v[156:159]
    ds_read_b64_tr_b16 v[60:61], v66 offset:9216
    ds_read_b64_tr_b16 v[62:63], v66 offset:11520
    s_waitcnt lgkmcnt(10)
    v_mfma_f32_16x16x32_bf16 v[160:163], v[48:51], v[32:35], v[160:163]
    v_mfma_f32_16x16x32_bf16 v[164:167], v[48:51], v[36:39], v[164:167]
    v_mfma_f32_16x16x32_bf16 v[168:171], v[48:51], v[40:43], v[168:171]
    v_mfma_f32_16x16x32_bf16 v[172:175], v[48:51], v[44:47], v[172:175]
    ds_read_b64_tr_b16 v[48:49], v67 offset:0
    ds_read_b64_tr_b16 v[50:51], v67 offset:1280
    s_waitcnt lgkmcnt(10)
    v_mfma_f32_16x16x32_bf16 v[176:179], v[52:55], v[32:35], v[176:179]
    v_mfma_f32_16x16x32_bf16 v[180:183], v[52:55], v[36:39], v[180:183]
    v_mfma_f32_16x16x32_bf16 v[184:187], v[52:55], v[40:43], v[184:187]
    v_mfma_f32_16x16x32_bf16 v[188:191], v[52:55], v[44:47], v[188:191]
    v_add_u32 v68, -39936, v7
    v_add_u32 v70, -39936, v9
    v_add_u32 v71, -39936, v10
    ds_read_b128 v[32:35], v68 offset:0
    ds_read_b128 v[36:39], v68 offset:1024
    ds_read_b128 v[40:43], v68 offset:2048
    ds_read_b128 v[44:47], v68 offset:3072
    ds_read_b64_tr_b16 v[52:53], v70 offset:0
    ds_read_b64_tr_b16 v[54:55], v70 offset:2304
    s_waitcnt lgkmcnt(10)
    v_mfma_f32_16x16x32_bf16 v[80:83], v[56:59], v[16:19], v[80:83]
    v_mfma_f32_16x16x32_bf16 v[84:87], v[56:59], v[20:23], v[84:87]
    v_mfma_f32_16x16x32_bf16 v[88:91], v[56:59], v[24:27], v[88:91]
    v_mfma_f32_16x16x32_bf16 v[92:95], v[56:59], v[28:31], v[92:95]
    ds_read_b64_tr_b16 v[56:57], v70 offset:9216
    ds_read_b64_tr_b16 v[58:59], v70 offset:11520
    s_waitcnt lgkmcnt(10)
    v_mfma_f32_16x16x32_bf16 v[96:99], v[60:63], v[16:19], v[96:99]
    v_mfma_f32_16x16x32_bf16 v[100:103], v[60:63], v[20:23], v[100:103]
    v_mfma_f32_16x16x32_bf16 v[104:107], v[60:63], v[24:27], v[104:107]
    v_mfma_f32_16x16x32_bf16 v[108:111], v[60:63], v[28:31], v[108:111]
    ds_read_b64_tr_b16 v[60:61], v71 offset:0
    ds_read_b64_tr_b16 v[62:63], v71 offset:1280
    s_waitcnt lgkmcnt(10)
    v_mfma_f32_16x16x32_bf16 v[112:115], v[48:51], v[16:19], v[112:115]
    v_mfma_f32_16x16x32_bf16 v[116:119], v[48:51], v[20:23], v[116:119]
    v_mfma_f32_16x16x32_bf16 v[120:123], v[48:51], v[24:27], v[120:123]
    v_mfma_f32_16x16x32_bf16 v[124:127], v[48:51], v[28:31], v[124:127]
    v_add_u32 v64, -79872, v7
    v_add_u32 v65, -79872, v8
    ds_read_b128 v[16:19], v64 offset:0
    ds_read_b128 v[20:23], v64 offset:1024
    ds_read_b128 v[24:27], v64 offset:2048
    ds_read_b128 v[28:31], v64 offset:3072
    ds_read_b64_tr_b16 v[48:49], v65 offset:0
    ds_read_b64_tr_b16 v[50:51], v65 offset:2304
    s_waitcnt lgkmcnt(10)
    v_mfma_f32_16x16x32_bf16 v[80:83], v[52:55], v[32:35], v[80:83]
    v_mfma_f32_16x16x32_bf16 v[84:87], v[52:55], v[36:39], v[84:87]
    v_mfma_f32_16x16x32_bf16 v[88:91], v[52:55], v[40:43], v[88:91]
    v_mfma_f32_16x16x32_bf16 v[92:95], v[52:55], v[44:47], v[92:95]
    ds_read_b64_tr_b16 v[52:53], v65 offset:32
    ds_read_b64_tr_b16 v[54:55], v65 offset:2336
    s_waitcnt lgkmcnt(10)
    v_mfma_f32_16x16x32_bf16 v[96:99], v[56:59], v[32:35], v[96:99]
    v_mfma_f32_16x16x32_bf16 v[100:103], v[56:59], v[36:39], v[100:103]
    v_mfma_f32_16x16x32_bf16 v[104:107], v[56:59], v[40:43], v[104:107]
    v_mfma_f32_16x16x32_bf16 v[108:111], v[56:59], v[44:47], v[108:111]
    ds_read_b64_tr_b16 v[56:57], v65 offset:9216
    ds_read_b64_tr_b16 v[58:59], v65 offset:11520
    s_waitcnt lgkmcnt(10)
    v_mfma_f32_16x16x32_bf16 v[112:115], v[60:63], v[32:35], v[112:115]
    v_mfma_f32_16x16x32_bf16 v[116:119], v[60:63], v[36:39], v[116:119]
    v_mfma_f32_16x16x32_bf16 v[120:123], v[60:63], v[40:43], v[120:123]
    v_mfma_f32_16x16x32_bf16 v[124:127], v[60:63], v[44:47], v[124:127]
    ds_read_b64_tr_b16 v[60:61], v65 offset:9248
    ds_read_b64_tr_b16 v[62:63], v65 offset:11552
    s_waitcnt lgkmcnt(6)
    v_mfma_f32_16x16x32_bf16 v[128:131], v[48:51], v[16:19], v[128:131]
    s_lshl_b32 s72, s20, 4
    s_lshl_b32 s73, s23, 2
    s_add_u32 s72, s72, s73
    v_lshlrev_b32 v14, 4, v1
    v_lshlrev_b32 v15, 3, v1
    v_mfma_f32_16x16x32_bf16 v[132:135], v[48:51], v[20:23], v[132:135]
    s_mul_i32 s73, s21, 9
    s_add_u32 s74, s73, s68
    s_lshr_b32 s74, s74, 1
    s_mul_i32 s75, s72, 144
    s_add_u32 s74, s74, s75
    v_mfma_f32_16x16x32_bf16 v[136:139], v[48:51], v[24:27], v[136:139]
    s_lshl_b32 s74, s74, 10
    s_add_u32 s76, s73, s69
    s_and_b32 s77, s76, 1
    s_lshr_b32 s76, s76, 1
    s_add_u32 s76, s76, s75
    v_mfma_f32_16x16x32_bf16 v[140:143], v[48:51], v[28:31], v[140:143]
    s_lshl_b32 s76, s76, 10
    s_lshl_b32 s77, s77, 3
    s_add_u32 s76, s76, s77
    s_mov_b32 s78, 0xbdd2d3e8
    s_mov_b32 s79, 0xbdd2d3e8
    v_add_u32 v68, -39936, v7
    v_add_u32 v69, -39936, v8
    ds_read_b128 v[32:35], v68 offset:0
    ds_read_b128 v[36:39], v68 offset:1024
    ds_read_b128 v[40:43], v68 offset:2048
    ds_read_b128 v[44:47], v68 offset:3072
    ds_read_b64_tr_b16 v[48:49], v69 offset:0
    ds_read_b64_tr_b16 v[50:51], v69 offset:2304
    s_waitcnt lgkmcnt(10)
    v_mfma_f32_16x16x32_bf16 v[144:147], v[52:55], v[16:19], v[144:147]
    s_mov_b32 s80, 0xc0135761
    v_mov_b32 v0, s80
    s_lshl_b32 s73, s72, 4
    s_add_u32 s73, s73, s21
    s_lshl_b32 s73, s73, 10
    v_mfma_f32_16x16x32_bf16 v[148:151], v[52:55], v[20:23], v[148:151]
    s_add_u32 s73, s73, 18874368
    v_min_f32 v11, 0, v114
    v_min_f32 v12, 0, v115
    v_mul_f32 v11, s84, v11
    v_mul_f32 v12, s84, v12
    v_mfma_f32_16x16x32_bf16 v[152:155], v[52:55], v[24:27], v[152:155]
    v_exp_f32 v11, v11
    v_exp_f32 v12, v12
    v_max_f32 v114, 0, v114
    v_max_f32 v115, 0, v115
    v_add_f32 v114, v11, v114
    v_mfma_f32_16x16x32_bf16 v[156:159], v[52:55], v[28:31], v[156:159]
    v_add_f32 v115, v12, v115
    v_add_f32 v114, s85, v114
    v_add_f32 v115, s85, v115
    v_cvt_pk_bf16_f32 v115, v114, v115
    v_min_f32 v11, 0, v112
    ds_read_b64_tr_b16 v[52:53], v69 offset:32
    ds_read_b64_tr_b16 v[54:55], v69 offset:2336
    s_waitcnt lgkmcnt(10)
    v_mfma_f32_16x16x32_bf16 v[160:163], v[56:59], v[16:19], v[160:163]
    v_min_f32 v12, 0, v113
    v_mul_f32 v11, s84, v11
    v_mul_f32 v12, s84, v12
    v_exp_f32 v11, v11
    v_exp_f32 v12, v12
    v_mfma_f32_16x16x32_bf16 v[164:167], v[56:59], v[20:23], v[164:167]
    v_max_f32 v112, 0, v112
    v_max_f32 v113, 0, v113
    v_add_f32 v112, v11, v112
    v_add_f32 v113, v12, v113
    v_add_f32 v112, s85, v112
    v_mfma_f32_16x16x32_bf16 v[168:171], v[56:59], v[24:27], v[168:171]
    v_add_f32 v113, s85, v113
    v_cvt_pk_bf16_f32 v114, v112, v113
    v_min_f32 v11, 0, v116
    v_min_f32 v12, 0, v117
    v_mul_f32 v11, s84, v11
    v_mfma_f32_16x16x32_bf16 v[172:175], v[56:59], v[28:31], v[172:175]
    v_mul_f32 v12, s84, v12
    v_exp_f32 v11, v11
    v_exp_f32 v12, v12
    v_max_f32 v116, 0, v116
    v_max_f32 v117, 0, v117
    ds_read_b64_tr_b16 v[56:57], v69 offset:9216
    ds_read_b64_tr_b16 v[58:59], v69 offset:11520
    s_waitcnt lgkmcnt(10)
    v_mfma_f32_16x16x32_bf16 v[176:179], v[60:63], v[16:19], v[176:179]
    v_add_f32 v116, v11, v116
    v_add_f32 v117, v12, v117
    v_add_f32 v116, s85, v116
    v_add_f32 v117, s85, v117
    v_cvt_pk_bf16_f32 v116, v116, v117
    v_mfma_f32_16x16x32_bf16 v[180:183], v[60:63], v[20:23], v[180:183]
    v_min_f32 v11, 0, v118
    v_min_f32 v12, 0, v119
    v_mul_f32 v11, s84, v11
    v_mul_f32 v12, s84, v12
    v_exp_f32 v11, v11
    v_mfma_f32_16x16x32_bf16 v[184:187], v[60:63], v[24:27], v[184:187]
    v_exp_f32 v12, v12
    v_max_f32 v118, 0, v118
    v_max_f32 v119, 0, v119
    v_add_f32 v118, v11, v118
    v_add_f32 v119, v12, v119
    v_mfma_f32_16x16x32_bf16 v[188:191], v[60:63], v[28:31], v[188:191]
    v_add_f32 v118, s85, v118
    v_add_f32 v119, s85, v119
    v_cvt_pk_bf16_f32 v117, v118, v119
    buffer_store_dwordx4 v[114:117], v14, s[44:47], s73 offen sc1
    s_add_u32 s73, s73, 32768
    ds_read_b64_tr_b16 v[60:61], v69 offset:9248
    ds_read_b64_tr_b16 v[62:63], v69 offset:11552
    s_waitcnt lgkmcnt(6)
    v_mfma_f32_16x16x32_bf16 v[128:131], v[48:51], v[32:35], v[128:131]
    v_min_f32 v11, 0, v122
    v_min_f32 v12, 0, v123
    v_mul_f32 v11, s84, v11
    v_mul_f32 v12, s84, v12
    v_exp_f32 v11, v11
    v_mfma_f32_16x16x32_bf16 v[132:135], v[48:51], v[36:39], v[132:135]
    v_exp_f32 v12, v12
    v_max_f32 v122, 0, v122
    v_max_f32 v123, 0, v123
    v_add_f32 v122, v11, v122
    v_add_f32 v123, v12, v123
    v_mfma_f32_16x16x32_bf16 v[136:139], v[48:51], v[40:43], v[136:139]
    v_add_f32 v122, s85, v122
    v_add_f32 v123, s85, v123
    v_cvt_pk_bf16_f32 v123, v122, v123
    v_min_f32 v11, 0, v120
    v_min_f32 v12, 0, v121
    v_mfma_f32_16x16x32_bf16 v[140:143], v[48:51], v[44:47], v[140:143]
    v_mul_f32 v11, s84, v11
    v_mul_f32 v12, s84, v12
    v_exp_f32 v11, v11
    v_exp_f32 v12, v12
    v_max_f32 v120, 0, v120
    v_add_u32 v64, 0, v7
    v_add_u32 v65, 0, v8
    ds_read_b128 v[16:19], v64 offset:0
    ds_read_b128 v[20:23], v64 offset:1024
    ds_read_b128 v[24:27], v64 offset:2048
    ds_read_b128 v[28:31], v64 offset:3072
    ds_read_b64_tr_b16 v[48:49], v65 offset:64
    ds_read_b64_tr_b16 v[50:51], v65 offset:2368
    s_waitcnt lgkmcnt(10)
    v_mfma_f32_16x16x32_bf16 v[144:147], v[52:55], v[32:35], v[144:147]
    v_max_f32 v121, 0, v121
    v_add_f32 v120, v11, v120
    v_add_f32 v121, v12, v121
    v_add_f32 v120, s85, v120
    v_add_f32 v121, s85, v121
    v_mfma_f32_16x16x32_bf16 v[148:151], v[52:55], v[36:39], v[148:151]
    v_cvt_pk_bf16_f32 v122, v120, v121
    v_min_f32 v11, 0, v124
    v_min_f32 v12, 0, v125
    v_mul_f32 v11, s84, v11
    v_mul_f32 v12, s84, v12
    v_mfma_f32_16x16x32_bf16 v[152:155], v[52:55], v[40:43], v[152:155]
    v_exp_f32 v11, v11
    v_exp_f32 v12, v12
    v_max_f32 v124, 0, v124
    v_max_f32 v125, 0, v125
    v_add_f32 v124, v11, v124
    v_mfma_f32_16x16x32_bf16 v[156:159], v[52:55], v[44:47], v[156:159]
    v_add_f32 v125, v12, v125
    v_add_f32 v124, s85, v124
    v_add_f32 v125, s85, v125
    v_cvt_pk_bf16_f32 v124, v124, v125
    v_min_f32 v11, 0, v126
    ds_read_b64_tr_b16 v[52:53], v65 offset:96
    ds_read_b64_tr_b16 v[54:55], v65 offset:2400
    s_waitcnt lgkmcnt(10)
    v_mfma_f32_16x16x32_bf16 v[160:163], v[56:59], v[32:35], v[160:163]
    v_min_f32 v12, 0, v127
    v_mul_f32 v11, s84, v11
    v_mul_f32 v12, s84, v12
    v_exp_f32 v11, v11
    v_exp_f32 v12, v12
    v_mfma_f32_16x16x32_bf16 v[164:167], v[56:59], v[36:39], v[164:167]
    v_max_f32 v126, 0, v126
    v_max_f32 v127, 0, v127
    v_add_f32 v126, v11, v126
    v_add_f32 v127, v12, v127
    v_add_f32 v126, s85, v126
    v_mfma_f32_16x16x32_bf16 v[168:171], v[56:59], v[40:43], v[168:171]
    v_add_f32 v127, s85, v127
    v_cvt_pk_bf16_f32 v125, v126, v127
    buffer_store_dwordx4 v[122:125], v14, s[44:47], s73 offen sc1
    s_add_u32 s73, s73, 32768
    v_pk_mul_f32 v[72:73], v[80:81], v[80:81]
    v_mfma_f32_16x16x32_bf16 v[172:175], v[56:59], v[44:47], v[172:175]
    v_pk_mul_f32 v[76:77], v[82:83], v[82:83]
    v_pk_fma_f32 v[72:73], v[72:73], s[78:79], v[0:1] op_sel_hi:[1,1,0]
    v_pk_fma_f32 v[76:77], v[76:77], s[78:79], v[0:1] op_sel_hi:[1,1,0]
    v_pk_mul_f32 v[72:73], v[72:73], v[80:81]
    v_pk_mul_f32 v[76:77], v[76:77], v[82:83]
    ds_read_b64_tr_b16 v[56:57], v65 offset:9280
    ds_read_b64_tr_b16 v[58:59], v65 offset:11584
    s_waitcnt lgkmcnt(10)
    v_mfma_f32_16x16x32_bf16 v[176:179], v[60:63], v[32:35], v[176:179]
    v_exp_f32 v72, v72
    v_exp_f32 v76, v76
    v_exp_f32 v73, v73
    v_exp_f32 v77, v77
    v_pk_mul_f32 v[74:75], v[80:81], v[96:97]
    v_mfma_f32_16x16x32_bf16 v[180:183], v[60:63], v[36:39], v[180:183]
    v_pk_mul_f32 v[78:79], v[82:83], v[98:99]
    v_pk_add_f32 v[72:73], v[72:73], 1.0 op_sel_hi:[1,0]
    v_pk_add_f32 v[76:77], v[76:77], 1.0 op_sel_hi:[1,0]
    v_rcp_f32 v72, v72
    v_rcp_f32 v76, v76
    v_mfma_f32_16x16x32_bf16 v[184:187], v[60:63], v[40:43], v[184:187]
    v_rcp_f32 v73, v73
    v_rcp_f32 v77, v77
    v_pk_mul_f32 v[74:75], v[74:75], v[72:73]
    v_pk_mul_f32 v[78:79], v[78:79], v[76:77]
    v_cvt_pk_bf16_f32 v11, v74, v75
    v_mfma_f32_16x16x32_bf16 v[188:191], v[60:63], v[44:47], v[188:191]
    v_cvt_pk_bf16_f32 v81, v78, v79
    v_mov_b32 v80, v11
    buffer_store_dwordx2 v[80:81], v14, s[44:47], s76 offen sc1
    s_add_u32 s76, s76, 147456
    v_pk_mul_f32 v[72:73], v[84:85], v[84:85]
    ds_read_b64_tr_b16 v[60:61], v65 offset:9312
    ds_read_b64_tr_b16 v[62:63], v65 offset:11616
    s_waitcnt lgkmcnt(6)
    v_mfma_f32_16x16x32_bf16 v[192:195], v[48:51], v[16:19], v[192:195]
    v_pk_mul_f32 v[76:77], v[86:87], v[86:87]
    v_pk_fma_f32 v[72:73], v[72:73], s[78:79], v[0:1] op_sel_hi:[1,1,0]
    v_pk_fma_f32 v[76:77], v[76:77], s[78:79], v[0:1] op_sel_hi:[1,1,0]
    v_pk_mul_f32 v[72:73], v[72:73], v[84:85]
    v_pk_mul_f32 v[76:77], v[76:77], v[86:87]
    v_mfma_f32_16x16x32_bf16 v[196:199], v[48:51], v[20:23], v[196:199]
    v_exp_f32 v72, v72
    v_exp_f32 v76, v76
    v_exp_f32 v73, v73
    v_exp_f32 v77, v77
    v_pk_mul_f32 v[74:75], v[84:85], v[100:101]
    v_mfma_f32_16x16x32_bf16 v[200:203], v[48:51], v[24:27], v[200:203]
    v_pk_mul_f32 v[78:79], v[86:87], v[102:103]
    v_pk_add_f32 v[72:73], v[72:73], 1.0 op_sel_hi:[1,0]
    v_pk_add_f32 v[76:77], v[76:77], 1.0 op_sel_hi:[1,0]
    v_rcp_f32 v72, v72
    v_rcp_f32 v76, v76
    v_mfma_f32_16x16x32_bf16 v[204:207], v[48:51], v[28:31], v[204:207]
    v_rcp_f32 v73, v73
    v_rcp_f32 v77, v77
    v_pk_mul_f32 v[74:75], v[74:75], v[72:73]
    v_pk_mul_f32 v[78:79], v[78:79], v[76:77]
    v_cvt_pk_bf16_f32 v11, v74, v75
    v_add_u32 v68, 39936, v7
    v_add_u32 v69, 39936, v8
    ds_read_b128 v[32:35], v68 offset:0
    ds_read_b128 v[36:39], v68 offset:1024
    ds_read_b128 v[40:43], v68 offset:2048
    ds_read_b128 v[44:47], v68 offset:3072
    ds_read_b64_tr_b16 v[48:49], v69 offset:64
    ds_read_b64_tr_b16 v[50:51], v69 offset:2368
    s_waitcnt lgkmcnt(10)
    v_mfma_f32_16x16x32_bf16 v[208:211], v[52:55], v[16:19], v[208:211]
    v_cvt_pk_bf16_f32 v85, v78, v79
    v_mov_b32 v84, v11
    buffer_store_dwordx2 v[84:85], v14, s[44:47], s76 offen sc1
    s_add_u32 s76, s76, 147456
    v_pk_mul_f32 v[72:73], v[88:89], v[88:89]
    v_mfma_f32_16x16x32_bf16 v[212:215], v[52:55], v[20:23], v[212:215]
    v_pk_mul_f32 v[76:77], v[90:91], v[90:91]
    v_pk_fma_f32 v[72:73], v[72:73], s[78:79], v[0:1] op_sel_hi:[1,1,0]
    v_pk_fma_f32 v[76:77], v[76:77], s[78:79], v[0:1] op_sel_hi:[1,1,0]
    v_pk_mul_f32 v[72:73], v[72:73], v[88:89]
    v_pk_mul_f32 v[76:77], v[76:77], v[90:91]
    v_mfma_f32_16x16x32_bf16 v[216:219], v[52:55], v[24:27], v[216:219]
    v_exp_f32 v72, v72
    v_exp_f32 v76, v76
    v_exp_f32 v73, v73
    v_exp_f32 v77, v77
    v_pk_mul_f32 v[74:75], v[88:89], v[104:105]
    v_mfma_f32_16x16x32_bf16 v[220:223], v[52:55], v[28:31], v[220:223]
    v_pk_mul_f32 v[78:79], v[90:91], v[106:107]
    v_pk_add_f32 v[72:73], v[72:73], 1.0 op_sel_hi:[1,0]
    v_pk_add_f32 v[76:77], v[76:77], 1.0 op_sel_hi:[1,0]
    v_rcp_f32 v72, v72
    v_rcp_f32 v76, v76
    ds_read_b64_tr_b16 v[52:53], v69 offset:96
    ds_read_b64_tr_b16 v[54:55], v69 offset:2400
    s_waitcnt lgkmcnt(10)
    v_mfma_f32_16x16x32_bf16 v[224:227], v[56:59], v[16:19], v[224:227]
    v_rcp_f32 v73, v73
    v_rcp_f32 v77, v77
    v_pk_mul_f32 v[74:75], v[74:75], v[72:73]
    v_pk_mul_f32 v[78:79], v[78:79], v[76:77]
    v_cvt_pk_bf16_f32 v11, v74, v75
    v_mfma_f32_16x16x32_bf16 v[228:231], v[56:59], v[20:23], v[228:231]
    v_cvt_pk_bf16_f32 v89, v78, v79
    v_mov_b32 v88, v11
    buffer_store_dwordx2 v[88:89], v14, s[44:47], s76 offen sc1
    s_add_u32 s76, s76, 147456
    v_pk_mul_f32 v[72:73], v[92:93], v[92:93]
    v_mfma_f32_16x16x32_bf16 v[232:235], v[56:59], v[24:27], v[232:235]
    v_pk_mul_f32 v[76:77], v[94:95], v[94:95]
    v_pk_fma_f32 v[72:73], v[72:73], s[78:79], v[0:1] op_sel_hi:[1,1,0]
    v_pk_fma_f32 v[76:77], v[76:77], s[78:79], v[0:1] op_sel_hi:[1,1,0]
    v_pk_mul_f32 v[72:73], v[72:73], v[92:93]
    v_pk_mul_f32 v[76:77], v[76:77], v[94:95]
    v_mfma_f32_16x16x32_bf16 v[236:239], v[56:59], v[28:31], v[236:239]
    v_exp_f32 v72, v72
    v_exp_f32 v76, v76
    v_exp_f32 v73, v73
    v_exp_f32 v77, v77
    v_pk_mul_f32 v[74:75], v[92:93], v[108:109]
    ds_read_b64_tr_b16 v[56:57], v69 offset:9280
    ds_read_b64_tr_b16 v[58:59], v69 offset:11584
    s_waitcnt lgkmcnt(10)
    v_mfma_f32_16x16x32_bf16 v[240:243], v[60:63], v[16:19], v[240:243]
    v_pk_mul_f32 v[78:79], v[94:95], v[110:111]
    v_pk_add_f32 v[72:73], v[72:73], 1.0 op_sel_hi:[1,0]
    v_pk_add_f32 v[76:77], v[76:77], 1.0 op_sel_hi:[1,0]
    v_rcp_f32 v72, v72
    v_rcp_f32 v76, v76
    v_mfma_f32_16x16x32_bf16 v[244:247], v[60:63], v[20:23], v[244:247]
    v_rcp_f32 v73, v73
    v_rcp_f32 v77, v77
    v_pk_mul_f32 v[74:75], v[74:75], v[72:73]
    v_pk_mul_f32 v[78:79], v[78:79], v[76:77]
    v_cvt_pk_bf16_f32 v11, v74, v75
    v_mfma_f32_16x16x32_bf16 v[248:251], v[60:63], v[24:27], v[248:251]
    v_cvt_pk_bf16_f32 v93, v78, v79
    v_mov_b32 v92, v11
    buffer_store_dwordx2 v[92:93], v14, s[44:47], s76 offen sc1
    s_add_u32 s76, s76, 147456
    v_pk_mul_f32 v[72:73], v[128:129], v[128:129]
    v_mfma_f32_16x16x32_bf16 v[252:255], v[60:63], v[28:31], v[252:255]
    v_pk_mul_f32 v[76:77], v[130:131], v[130:131]
    v_pk_fma_f32 v[72:73], v[72:73], s[78:79], v[0:1] op_sel_hi:[1,1,0]
    v_pk_fma_f32 v[76:77], v[76:77], s[78:79], v[0:1] op_sel_hi:[1,1,0]
    v_pk_mul_f32 v[72:73], v[72:73], v[128:129]
    v_pk_mul_f32 v[76:77], v[76:77], v[130:131]
    ds_read_b64_tr_b16 v[60:61], v69 offset:9312
    ds_read_b64_tr_b16 v[62:63], v69 offset:11616
    s_waitcnt lgkmcnt(6)
    v_mfma_f32_16x16x32_bf16 v[192:195], v[48:51], v[32:35], v[192:195]
    v_exp_f32 v72, v72
    v_exp_f32 v76, v76
    v_exp_f32 v73, v73
    v_exp_f32 v77, v77
    v_pk_mul_f32 v[74:75], v[128:129], v[160:161]
    v_mfma_f32_16x16x32_bf16 v[196:199], v[48:51], v[36:39], v[196:199]
    v_pk_mul_f32 v[78:79], v[130:131], v[162:163]
    v_pk_add_f32 v[72:73], v[72:73], 1.0 op_sel_hi:[1,0]
    v_pk_add_f32 v[76:77], v[76:77], 1.0 op_sel_hi:[1,0]
    v_rcp_f32 v72, v72
    v_rcp_f32 v76, v76
    v_mfma_f32_16x16x32_bf16 v[200:203], v[48:51], v[40:43], v[200:203]
    v_rcp_f32 v73, v73
    v_rcp_f32 v77, v77
    v_pk_mul_f32 v[74:75], v[74:75], v[72:73]
    v_pk_mul_f32 v[78:79], v[78:79], v[76:77]
    v_cvt_pk_bf16_f32 v11, v74, v75
    v_mfma_f32_16x16x32_bf16 v[204:207], v[48:51], v[44:47], v[204:207]
    v_cvt_pk_bf16_f32 v129, v78, v79
    v_mov_b32 v128, v11
    v_pk_mul_f32 v[72:73], v[144:145], v[144:145]
    v_pk_mul_f32 v[76:77], v[146:147], v[146:147]
    v_pk_fma_f32 v[72:73], v[72:73], s[78:79], v[0:1] op_sel_hi:[1,1,0]
    v_add_u32 v64, -79872, v7
    v_add_u32 v65, -79872, v8
    ds_read_b128 v[16:19], v64 offset:0
    ds_read_b128 v[20:23], v64 offset:1024
    ds_read_b128 v[24:27], v64 offset:2048
    ds_read_b128 v[28:31], v64 offset:3072
    ds_read_b64_tr_b16 v[48:49], v65 offset:64
    ds_read_b64_tr_b16 v[50:51], v65 offset:2368
    s_waitcnt lgkmcnt(10)
    v_mfma_f32_16x16x32_bf16 v[208:211], v[52:55], v[32:35], v[208:211]
    v_pk_fma_f32 v[76:77], v[76:77], s[78:79], v[0:1] op_sel_hi:[1,1,0]
    v_pk_mul_f32 v[72:73], v[72:73], v[144:145]
    v_pk_mul_f32 v[76:77], v[76:77], v[146:147]
    v_exp_f32 v72, v72
    v_exp_f32 v76, v76
    v_mfma_f32_16x16x32_bf16 v[212:215], v[52:55], v[36:39], v[212:215]
    v_exp_f32 v73, v73
    v_exp_f32 v77, v77
    v_pk_mul_f32 v[74:75], v[144:145], v[176:177]
    v_pk_mul_f32 v[78:79], v[146:147], v[178:179]
    v_pk_add_f32 v[72:73], v[72:73], 1.0 op_sel_hi:[1,0]
    v_mfma_f32_16x16x32_bf16 v[216:219], v[52:55], v[40:43], v[216:219]
    v_pk_add_f32 v[76:77], v[76:77], 1.0 op_sel_hi:[1,0]
    v_rcp_f32 v72, v72
    v_rcp_f32 v76, v76
    v_rcp_f32 v73, v73
    v_rcp_f32 v77, v77
    v_mfma_f32_16x16x32_bf16 v[220:223], v[52:55], v[44:47], v[220:223]
    v_pk_mul_f32 v[74:75], v[74:75], v[72:73]
    v_pk_mul_f32 v[78:79], v[78:79], v[76:77]
    v_cvt_pk_bf16_f32 v130, v74, v75
    v_cvt_pk_bf16_f32 v131, v78, v79
    s_add_u32 s81, s74, 0
    ds_read_b64_tr_b16 v[52:53], v65 offset:96
    ds_read_b64_tr_b16 v[54:55], v65 offset:2400
    s_waitcnt lgkmcnt(10)
    v_mfma_f32_16x16x32_bf16 v[224:227], v[56:59], v[32:35], v[224:227]
    buffer_store_dwordx4 v[128:131], v14, s[44:47], s81 offen offset:0 sc1
    v_pk_mul_f32 v[72:73], v[132:133], v[132:133]
    v_pk_mul_f32 v[76:77], v[134:135], v[134:135]
    v_pk_fma_f32 v[72:73], v[72:73], s[78:79], v[0:1] op_sel_hi:[1,1,0]
    v_pk_fma_f32 v[76:77], v[76:77], s[78:79], v[0:1] op_sel_hi:[1,1,0]
    v_mfma_f32_16x16x32_bf16 v[228:231], v[56:59], v[36:39], v[228:231]
    v_pk_mul_f32 v[72:73], v[72:73], v[132:133]
    v_pk_mul_f32 v[76:77], v[76:77], v[134:135]
    v_exp_f32 v72, v72
    v_exp_f32 v76, v76
    v_exp_f32 v73, v73
    v_mfma_f32_16x16x32_bf16 v[232:235], v[56:59], v[40:43], v[232:235]
    v_exp_f32 v77, v77
    v_pk_mul_f32 v[74:75], v[132:133], v[164:165]
    v_pk_mul_f32 v[78:79], v[134:135], v[166:167]
    v_pk_add_f32 v[72:73], v[72:73], 1.0 op_sel_hi:[1,0]
    v_pk_add_f32 v[76:77], v[76:77], 1.0 op_sel_hi:[1,0]
    v_mfma_f32_16x16x32_bf16 v[236:239], v[56:59], v[44:47], v[236:239]
    v_rcp_f32 v72, v72
    v_rcp_f32 v76, v76
    v_rcp_f32 v73, v73
    v_rcp_f32 v77, v77
    v_pk_mul_f32 v[74:75], v[74:75], v[72:73]
    ds_read_b64_tr_b16 v[56:57], v65 offset:9280
    ds_read_b64_tr_b16 v[58:59], v65 offset:11584
    s_waitcnt lgkmcnt(10)
    v_mfma_f32_16x16x32_bf16 v[240:243], v[60:63], v[32:35], v[240:243]
    v_pk_mul_f32 v[78:79], v[78:79], v[76:77]
    v_cvt_pk_bf16_f32 v11, v74, v75
    v_cvt_pk_bf16_f32 v133, v78, v79
    v_mov_b32 v132, v11
    v_pk_mul_f32 v[72:73], v[148:149], v[148:149]
    v_mfma_f32_16x16x32_bf16 v[244:247], v[60:63], v[36:39], v[244:247]
    v_pk_mul_f32 v[76:77], v[150:151], v[150:151]
    v_pk_fma_f32 v[72:73], v[72:73], s[78:79], v[0:1] op_sel_hi:[1,1,0]
    v_pk_fma_f32 v[76:77], v[76:77], s[78:79], v[0:1] op_sel_hi:[1,1,0]
    v_pk_mul_f32 v[72:73], v[72:73], v[148:149]
    v_pk_mul_f32 v[76:77], v[76:77], v[150:151]
    v_mfma_f32_16x16x32_bf16 v[248:251], v[60:63], v[40:43], v[248:251]
    v_exp_f32 v72, v72
    v_exp_f32 v76, v76
    v_exp_f32 v73, v73
    v_exp_f32 v77, v77
    v_pk_mul_f32 v[74:75], v[148:149], v[180:181]
    v_mfma_f32_16x16x32_bf16 v[252:255], v[60:63], v[44:47], v[252:255]
    v_pk_mul_f32 v[78:79], v[150:151], v[182:183]
    v_pk_add_f32 v[72:73], v[72:73], 1.0 op_sel_hi:[1,0]
    v_pk_add_f32 v[76:77], v[76:77], 1.0 op_sel_hi:[1,0]
    v_rcp_f32 v72, v72
    v_rcp_f32 v76, v76
    ds_read_b64_tr_b16 v[60:61], v65 offset:9312
    ds_read_b64_tr_b16 v[62:63], v65 offset:11616
    s_waitcnt lgkmcnt(6)
    v_mfma_f32_16x16x32_bf16 v[192:195], v[48:51], v[16:19], v[192:195]
    v_rcp_f32 v73, v73
    v_rcp_f32 v77, v77
    v_pk_mul_f32 v[74:75], v[74:75], v[72:73]
    v_pk_mul_f32 v[78:79], v[78:79], v[76:77]
    v_cvt_pk_bf16_f32 v134, v74, v75
    v_mfma_f32_16x16x32_bf16 v[196:199], v[48:51], v[20:23], v[196:199]
    v_cvt_pk_bf16_f32 v135, v78, v79
    s_add_u32 s81, s74, 147456
    buffer_store_dwordx4 v[132:135], v14, s[44:47], s81 offen offset:0 sc1
    v_pk_mul_f32 v[72:73], v[136:137], v[136:137]
    v_pk_mul_f32 v[76:77], v[138:139], v[138:139]
    v_mfma_f32_16x16x32_bf16 v[200:203], v[48:51], v[24:27], v[200:203]
    v_pk_fma_f32 v[72:73], v[72:73], s[78:79], v[0:1] op_sel_hi:[1,1,0]
    v_pk_fma_f32 v[76:77], v[76:77], s[78:79], v[0:1] op_sel_hi:[1,1,0]
    v_pk_mul_f32 v[72:73], v[72:73], v[136:137]
    v_pk_mul_f32 v[76:77], v[76:77], v[138:139]
    v_exp_f32 v72, v72
    v_mfma_f32_16x16x32_bf16 v[204:207], v[48:51], v[28:31], v[204:207]
    v_exp_f32 v76, v76
    v_exp_f32 v73, v73
    v_exp_f32 v77, v77
    v_pk_mul_f32 v[74:75], v[136:137], v[168:169]
    v_pk_mul_f32 v[78:79], v[138:139], v[170:171]
    v_add_u32 v68, -39936, v7
    v_add_u32 v69, -39936, v8
    ds_read_b128 v[32:35], v68 offset:0
    ds_read_b128 v[36:39], v68 offset:1024
    ds_read_b128 v[40:43], v68 offset:2048
    ds_read_b128 v[44:47], v68 offset:3072
    ds_read_b64_tr_b16 v[48:49], v69 offset:64
    ds_read_b64_tr_b16 v[50:51], v69 offset:2368
    s_waitcnt lgkmcnt(10)
    v_mfma_f32_16x16x32_bf16 v[208:211], v[52:55], v[16:19], v[208:211]
    v_pk_add_f32 v[72:73], v[72:73], 1.0 op_sel_hi:[1,0]
    v_pk_add_f32 v[76:77], v[76:77], 1.0 op_sel_hi:[1,0]
    v_rcp_f32 v72, v72
    v_rcp_f32 v76, v76
    v_rcp_f32 v73, v73
    v_mfma_f32_16x16x32_bf16 v[212:215], v[52:55], v[20:23], v[212:215]
    v_rcp_f32 v77, v77
    v_pk_mul_f32 v[74:75], v[74:75], v[72:73]
    v_pk_mul_f32 v[78:79], v[78:79], v[76:77]
    v_cvt_pk_bf16_f32 v11, v74, v75
    v_cvt_pk_bf16_f32 v137, v78, v79
    v_mfma_f32_16x16x32_bf16 v[216:219], v[52:55], v[24:27], v[216:219]
    v_mov_b32 v136, v11
    v_pk_mul_f32 v[72:73], v[152:153], v[152:153]
    v_pk_mul_f32 v[76:77], v[154:155], v[154:155]
    v_pk_fma_f32 v[72:73], v[72:73], s[78:79], v[0:1] op_sel_hi:[1,1,0]
    v_pk_fma_f32 v[76:77], v[76:77], s[78:79], v[0:1] op_sel_hi:[1,1,0]
    v_mfma_f32_16x16x32_bf16 v[220:223], v[52:55], v[28:31], v[220:223]
    v_pk_mul_f32 v[72:73], v[72:73], v[152:153]
    v_pk_mul_f32 v[76:77], v[76:77], v[154:155]
    v_exp_f32 v72, v72
    v_exp_f32 v76, v76
    v_exp_f32 v73, v73
    ds_read_b64_tr_b16 v[52:53], v69 offset:96
    ds_read_b64_tr_b16 v[54:55], v69 offset:2400
    s_waitcnt lgkmcnt(10)
    v_mfma_f32_16x16x32_bf16 v[224:227], v[56:59], v[16:19], v[224:227]
    v_exp_f32 v77, v77
    v_pk_mul_f32 v[74:75], v[152:153], v[184:185]
    v_pk_mul_f32 v[78:79], v[154:155], v[186:187]
    v_pk_add_f32 v[72:73], v[72:73], 1.0 op_sel_hi:[1,0]
    v_pk_add_f32 v[76:77], v[76:77], 1.0 op_sel_hi:[1,0]
    v_mfma_f32_16x16x32_bf16 v[228:231], v[56:59], v[20:23], v[228:231]
    v_rcp_f32 v72, v72
    v_rcp_f32 v76, v76
    v_rcp_f32 v73, v73
    v_rcp_f32 v77, v77
    v_pk_mul_f32 v[74:75], v[74:75], v[72:73]
    v_mfma_f32_16x16x32_bf16 v[232:235], v[56:59], v[24:27], v[232:235]
    v_pk_mul_f32 v[78:79], v[78:79], v[76:77]
    v_cvt_pk_bf16_f32 v138, v74, v75
    v_cvt_pk_bf16_f32 v139, v78, v79
    s_add_u32 s81, s74, 294912
    buffer_store_dwordx4 v[136:139], v14, s[44:47], s81 offen offset:0 sc1
    v_mfma_f32_16x16x32_bf16 v[236:239], v[56:59], v[28:31], v[236:239]
    v_pk_mul_f32 v[72:73], v[140:141], v[140:141]
    v_pk_mul_f32 v[76:77], v[142:143], v[142:143]
    v_pk_fma_f32 v[72:73], v[72:73], s[78:79], v[0:1] op_sel_hi:[1,1,0]
    v_pk_fma_f32 v[76:77], v[76:77], s[78:79], v[0:1] op_sel_hi:[1,1,0]
    v_pk_mul_f32 v[72:73], v[72:73], v[140:141]
    ds_read_b64_tr_b16 v[56:57], v69 offset:9280
    ds_read_b64_tr_b16 v[58:59], v69 offset:11584
    s_waitcnt lgkmcnt(10)
    v_mfma_f32_16x16x32_bf16 v[240:243], v[60:63], v[16:19], v[240:243]
    v_pk_mul_f32 v[76:77], v[76:77], v[142:143]
    v_exp_f32 v72, v72
    v_exp_f32 v76, v76
    v_exp_f32 v73, v73
    v_exp_f32 v77, v77
    v_mfma_f32_16x16x32_bf16 v[244:247], v[60:63], v[20:23], v[244:247]
    v_pk_mul_f32 v[74:75], v[140:141], v[172:173]
    v_pk_mul_f32 v[78:79], v[142:143], v[174:175]
    v_pk_add_f32 v[72:73], v[72:73], 1.0 op_sel_hi:[1,0]
    v_pk_add_f32 v[76:77], v[76:77], 1.0 op_sel_hi:[1,0]
    v_rcp_f32 v72, v72
    v_mfma_f32_16x16x32_bf16 v[248:251], v[60:63], v[24:27], v[248:251]
    v_rcp_f32 v76, v76
    v_rcp_f32 v73, v73
    v_rcp_f32 v77, v77
    v_pk_mul_f32 v[74:75], v[74:75], v[72:73]
    v_pk_mul_f32 v[78:79], v[78:79], v[76:77]
    v_mfma_f32_16x16x32_bf16 v[252:255], v[60:63], v[28:31], v[252:255]
    v_cvt_pk_bf16_f32 v11, v74, v75
    v_cvt_pk_bf16_f32 v141, v78, v79
    v_mov_b32 v140, v11
    v_pk_mul_f32 v[72:73], v[156:157], v[156:157]
    v_pk_mul_f32 v[76:77], v[158:159], v[158:159]
    ds_read_b64_tr_b16 v[60:61], v69 offset:9312
    ds_read_b64_tr_b16 v[62:63], v69 offset:11616
    s_waitcnt lgkmcnt(6)
    v_mfma_f32_16x16x32_bf16 v[192:195], v[48:51], v[32:35], v[192:195]
    v_pk_fma_f32 v[72:73], v[72:73], s[78:79], v[0:1] op_sel_hi:[1,1,0]
    v_pk_fma_f32 v[76:77], v[76:77], s[78:79], v[0:1] op_sel_hi:[1,1,0]
    v_pk_mul_f32 v[72:73], v[72:73], v[156:157]
    v_pk_mul_f32 v[76:77], v[76:77], v[158:159]
    v_exp_f32 v72, v72
    v_mfma_f32_16x16x32_bf16 v[196:199], v[48:51], v[36:39], v[196:199]
    v_exp_f32 v76, v76
    v_exp_f32 v73, v73
    v_exp_f32 v77, v77
    v_pk_mul_f32 v[74:75], v[156:157], v[188:189]
    v_pk_mul_f32 v[78:79], v[158:159], v[190:191]
    v_mfma_f32_16x16x32_bf16 v[200:203], v[48:51], v[40:43], v[200:203]
    v_pk_add_f32 v[72:73], v[72:73], 1.0 op_sel_hi:[1,0]
    v_pk_add_f32 v[76:77], v[76:77], 1.0 op_sel_hi:[1,0]
    v_rcp_f32 v72, v72
    v_rcp_f32 v76, v76
    v_rcp_f32 v73, v73
    v_mfma_f32_16x16x32_bf16 v[204:207], v[48:51], v[44:47], v[204:207]
    v_rcp_f32 v77, v77
    v_pk_mul_f32 v[74:75], v[74:75], v[72:73]
    v_pk_mul_f32 v[78:79], v[78:79], v[76:77]
    v_cvt_pk_bf16_f32 v142, v74, v75
    v_cvt_pk_bf16_f32 v143, v78, v79
    s_waitcnt lgkmcnt(4)
    v_mfma_f32_16x16x32_bf16 v[208:211], v[52:55], v[32:35], v[208:211]
    s_add_u32 s81, s74, 442368
    buffer_store_dwordx4 v[140:143], v14, s[44:47], s81 offen offset:0 sc1
    v_mfma_f32_16x16x32_bf16 v[212:215], v[52:55], v[36:39], v[212:215]
    v_mfma_f32_16x16x32_bf16 v[216:219], v[52:55], v[40:43], v[216:219]
    v_mfma_f32_16x16x32_bf16 v[220:223], v[52:55], v[44:47], v[220:223]
    s_waitcnt lgkmcnt(2)
    v_mfma_f32_16x16x32_bf16 v[224:227], v[56:59], v[32:35], v[224:227]
    v_mfma_f32_16x16x32_bf16 v[228:231], v[56:59], v[36:39], v[228:231]
    v_mfma_f32_16x16x32_bf16 v[232:235], v[56:59], v[40:43], v[232:235]
    v_mfma_f32_16x16x32_bf16 v[236:239], v[56:59], v[44:47], v[236:239]
    s_waitcnt lgkmcnt(0)
    v_mfma_f32_16x16x32_bf16 v[240:243], v[60:63], v[32:35], v[240:243]
    v_mfma_f32_16x16x32_bf16 v[244:247], v[60:63], v[36:39], v[244:247]
    v_mfma_f32_16x16x32_bf16 v[248:251], v[60:63], v[40:43], v[248:251]
    v_mfma_f32_16x16x32_bf16 v[252:255], v[60:63], v[44:47], v[252:255]
    s_mov_b32 s83, 0
    v_pk_mul_f32 v[72:73], v[192:193], v[192:193]
    v_pk_mul_f32 v[76:77], v[194:195], v[194:195]
    v_pk_fma_f32 v[72:73], v[72:73], s[78:79], v[0:1] op_sel_hi:[1,1,0]
    v_pk_fma_f32 v[76:77], v[76:77], s[78:79], v[0:1] op_sel_hi:[1,1,0]
    v_pk_mul_f32 v[72:73], v[72:73], v[192:193]
    v_pk_mul_f32 v[76:77], v[76:77], v[194:195]
    v_exp_f32 v72, v72
    v_exp_f32 v76, v76
    v_exp_f32 v73, v73
    v_exp_f32 v77, v77
    v_pk_mul_f32 v[74:75], v[192:193], v[224:225]
    v_pk_mul_f32 v[78:79], v[194:195], v[226:227]
    v_pk_add_f32 v[72:73], v[72:73], 1.0 op_sel_hi:[1,0]
    v_pk_add_f32 v[76:77], v[76:77], 1.0 op_sel_hi:[1,0]
    v_rcp_f32 v72, v72
    v_rcp_f32 v76, v76
    v_rcp_f32 v73, v73
    v_rcp_f32 v77, v77
    v_pk_mul_f32 v[74:75], v[74:75], v[72:73]
    v_pk_mul_f32 v[78:79], v[78:79], v[76:77]
    v_cvt_pk_bf16_f32 v11, v74, v75
    v_cvt_pk_bf16_f32 v193, v78, v79
    v_mov_b32 v192, v11
    v_pk_mul_f32 v[72:73], v[208:209], v[208:209]
    v_pk_mul_f32 v[76:77], v[210:211], v[210:211]
    v_pk_fma_f32 v[72:73], v[72:73], s[78:79], v[0:1] op_sel_hi:[1,1,0]
    v_pk_fma_f32 v[76:77], v[76:77], s[78:79], v[0:1] op_sel_hi:[1,1,0]
    v_pk_mul_f32 v[72:73], v[72:73], v[208:209]
    v_pk_mul_f32 v[76:77], v[76:77], v[210:211]
    v_exp_f32 v72, v72
    v_exp_f32 v76, v76
    v_exp_f32 v73, v73
    v_exp_f32 v77, v77
    v_pk_mul_f32 v[74:75], v[208:209], v[240:241]
    v_pk_mul_f32 v[78:79], v[210:211], v[242:243]
    v_pk_add_f32 v[72:73], v[72:73], 1.0 op_sel_hi:[1,0]
    v_pk_add_f32 v[76:77], v[76:77], 1.0 op_sel_hi:[1,0]
    v_rcp_f32 v72, v72
    v_rcp_f32 v76, v76
    v_rcp_f32 v73, v73
    v_rcp_f32 v77, v77
    v_pk_mul_f32 v[74:75], v[74:75], v[72:73]
    v_pk_mul_f32 v[78:79], v[78:79], v[76:77]
    v_cvt_pk_bf16_f32 v194, v74, v75
    v_cvt_pk_bf16_f32 v195, v78, v79
    s_add_u32 s81, s74, 0
    buffer_store_dwordx4 v[192:195], v14, s[44:47], s81 offen offset:1024 sc1
    v_pk_mul_f32 v[72:73], v[196:197], v[196:197]
    v_pk_mul_f32 v[76:77], v[198:199], v[198:199]
    v_pk_fma_f32 v[72:73], v[72:73], s[78:79], v[0:1] op_sel_hi:[1,1,0]
    v_pk_fma_f32 v[76:77], v[76:77], s[78:79], v[0:1] op_sel_hi:[1,1,0]
    v_pk_mul_f32 v[72:73], v[72:73], v[196:197]
    v_pk_mul_f32 v[76:77], v[76:77], v[198:199]
    v_exp_f32 v72, v72
    v_exp_f32 v76, v76
    v_exp_f32 v73, v73
    v_exp_f32 v77, v77
    v_pk_mul_f32 v[74:75], v[196:197], v[228:229]
    v_pk_mul_f32 v[78:79], v[198:199], v[230:231]
    v_pk_add_f32 v[72:73], v[72:73], 1.0 op_sel_hi:[1,0]
    v_pk_add_f32 v[76:77], v[76:77], 1.0 op_sel_hi:[1,0]
    v_rcp_f32 v72, v72
    v_rcp_f32 v76, v76
    v_rcp_f32 v73, v73
    v_rcp_f32 v77, v77
    v_pk_mul_f32 v[74:75], v[74:75], v[72:73]
    v_pk_mul_f32 v[78:79], v[78:79], v[76:77]
    v_cvt_pk_bf16_f32 v11, v74, v75
    v_cvt_pk_bf16_f32 v197, v78, v79
    v_mov_b32 v196, v11
    v_pk_mul_f32 v[72:73], v[212:213], v[212:213]
    v_pk_mul_f32 v[76:77], v[214:215], v[214:215]
    v_pk_fma_f32 v[72:73], v[72:73], s[78:79], v[0:1] op_sel_hi:[1,1,0]
    v_pk_fma_f32 v[76:77], v[76:77], s[78:79], v[0:1] op_sel_hi:[1,1,0]
    v_pk_mul_f32 v[72:73], v[72:73], v[212:213]
    v_pk_mul_f32 v[76:77], v[76:77], v[214:215]
    v_exp_f32 v72, v72
    v_exp_f32 v76, v76
    v_exp_f32 v73, v73
    v_exp_f32 v77, v77
    v_pk_mul_f32 v[74:75], v[212:213], v[244:245]
    v_pk_mul_f32 v[78:79], v[214:215], v[246:247]
    v_pk_add_f32 v[72:73], v[72:73], 1.0 op_sel_hi:[1,0]
    v_pk_add_f32 v[76:77], v[76:77], 1.0 op_sel_hi:[1,0]
    v_rcp_f32 v72, v72
    v_rcp_f32 v76, v76
    v_rcp_f32 v73, v73
    v_rcp_f32 v77, v77
    v_pk_mul_f32 v[74:75], v[74:75], v[72:73]
    v_pk_mul_f32 v[78:79], v[78:79], v[76:77]
    v_cvt_pk_bf16_f32 v198, v74, v75
    v_cvt_pk_bf16_f32 v199, v78, v79
    s_add_u32 s81, s74, 147456
    buffer_store_dwordx4 v[196:199], v14, s[44:47], s81 offen offset:1024 sc1
    v_pk_mul_f32 v[72:73], v[200:201], v[200:201]
    v_pk_mul_f32 v[76:77], v[202:203], v[202:203]
    v_pk_fma_f32 v[72:73], v[72:73], s[78:79], v[0:1] op_sel_hi:[1,1,0]
    v_pk_fma_f32 v[76:77], v[76:77], s[78:79], v[0:1] op_sel_hi:[1,1,0]
    v_pk_mul_f32 v[72:73], v[72:73], v[200:201]
    v_pk_mul_f32 v[76:77], v[76:77], v[202:203]
    v_exp_f32 v72, v72
    v_exp_f32 v76, v76
    v_exp_f32 v73, v73
    v_exp_f32 v77, v77
    v_pk_mul_f32 v[74:75], v[200:201], v[232:233]
    v_pk_mul_f32 v[78:79], v[202:203], v[234:235]
    v_pk_add_f32 v[72:73], v[72:73], 1.0 op_sel_hi:[1,0]
    v_pk_add_f32 v[76:77], v[76:77], 1.0 op_sel_hi:[1,0]
    v_rcp_f32 v72, v72
    v_rcp_f32 v76, v76
    v_rcp_f32 v73, v73
    v_rcp_f32 v77, v77
    v_pk_mul_f32 v[74:75], v[74:75], v[72:73]
    v_pk_mul_f32 v[78:79], v[78:79], v[76:77]
    v_cvt_pk_bf16_f32 v11, v74, v75
    v_cvt_pk_bf16_f32 v201, v78, v79
    v_mov_b32 v200, v11
    v_pk_mul_f32 v[72:73], v[216:217], v[216:217]
    v_pk_mul_f32 v[76:77], v[218:219], v[218:219]
    v_pk_fma_f32 v[72:73], v[72:73], s[78:79], v[0:1] op_sel_hi:[1,1,0]
    v_pk_fma_f32 v[76:77], v[76:77], s[78:79], v[0:1] op_sel_hi:[1,1,0]
    v_pk_mul_f32 v[72:73], v[72:73], v[216:217]
    v_pk_mul_f32 v[76:77], v[76:77], v[218:219]
    v_exp_f32 v72, v72
    v_exp_f32 v76, v76
    v_exp_f32 v73, v73
    v_exp_f32 v77, v77
    v_pk_mul_f32 v[74:75], v[216:217], v[248:249]
    v_pk_mul_f32 v[78:79], v[218:219], v[250:251]
    v_pk_add_f32 v[72:73], v[72:73], 1.0 op_sel_hi:[1,0]
    v_pk_add_f32 v[76:77], v[76:77], 1.0 op_sel_hi:[1,0]
    v_rcp_f32 v72, v72
    v_rcp_f32 v76, v76
    v_rcp_f32 v73, v73
    v_rcp_f32 v77, v77
    v_pk_mul_f32 v[74:75], v[74:75], v[72:73]
    v_pk_mul_f32 v[78:79], v[78:79], v[76:77]
    v_cvt_pk_bf16_f32 v202, v74, v75
    v_cvt_pk_bf16_f32 v203, v78, v79
    s_add_u32 s81, s74, 294912
    buffer_store_dwordx4 v[200:203], v14, s[44:47], s81 offen offset:1024 sc1
    v_pk_mul_f32 v[72:73], v[204:205], v[204:205]
    v_pk_mul_f32 v[76:77], v[206:207], v[206:207]
    v_pk_fma_f32 v[72:73], v[72:73], s[78:79], v[0:1] op_sel_hi:[1,1,0]
    v_pk_fma_f32 v[76:77], v[76:77], s[78:79], v[0:1] op_sel_hi:[1,1,0]
    v_pk_mul_f32 v[72:73], v[72:73], v[204:205]
    v_pk_mul_f32 v[76:77], v[76:77], v[206:207]
    v_exp_f32 v72, v72
    v_exp_f32 v76, v76
    v_exp_f32 v73, v73
    v_exp_f32 v77, v77
    v_pk_mul_f32 v[74:75], v[204:205], v[236:237]
    v_pk_mul_f32 v[78:79], v[206:207], v[238:239]
    v_pk_add_f32 v[72:73], v[72:73], 1.0 op_sel_hi:[1,0]
    v_pk_add_f32 v[76:77], v[76:77], 1.0 op_sel_hi:[1,0]
    v_rcp_f32 v72, v72
    v_rcp_f32 v76, v76
    v_rcp_f32 v73, v73
    v_rcp_f32 v77, v77
    v_pk_mul_f32 v[74:75], v[74:75], v[72:73]
    v_pk_mul_f32 v[78:79], v[78:79], v[76:77]
    v_cvt_pk_bf16_f32 v11, v74, v75
    v_cvt_pk_bf16_f32 v205, v78, v79
    v_mov_b32 v204, v11
    v_pk_mul_f32 v[72:73], v[220:221], v[220:221]
    v_pk_mul_f32 v[76:77], v[222:223], v[222:223]
    v_pk_fma_f32 v[72:73], v[72:73], s[78:79], v[0:1] op_sel_hi:[1,1,0]
    v_pk_fma_f32 v[76:77], v[76:77], s[78:79], v[0:1] op_sel_hi:[1,1,0]
    v_pk_mul_f32 v[72:73], v[72:73], v[220:221]
    v_pk_mul_f32 v[76:77], v[76:77], v[222:223]
    v_exp_f32 v72, v72
    v_exp_f32 v76, v76
    v_exp_f32 v73, v73
    v_exp_f32 v77, v77
    v_pk_mul_f32 v[74:75], v[220:221], v[252:253]
    v_pk_mul_f32 v[78:79], v[222:223], v[254:255]
    v_pk_add_f32 v[72:73], v[72:73], 1.0 op_sel_hi:[1,0]
    v_pk_add_f32 v[76:77], v[76:77], 1.0 op_sel_hi:[1,0]
    v_rcp_f32 v72, v72
    v_rcp_f32 v76, v76
    v_rcp_f32 v73, v73
    v_rcp_f32 v77, v77
    v_pk_mul_f32 v[74:75], v[74:75], v[72:73]
    v_pk_mul_f32 v[78:79], v[78:79], v[76:77]
    v_cvt_pk_bf16_f32 v206, v74, v75
    v_cvt_pk_bf16_f32 v207, v78, v79
    s_add_u32 s81, s74, 442368
    buffer_store_dwordx4 v[204:207], v14, s[44:47], s81 offen offset:1024 sc1
    s_branch L_phase2
L_k1_ch1:
    s_setprio 1
    ds_read_b128 v[16:19], v7 offset:0
    ds_read_b128 v[20:23], v7 offset:1024
    ds_read_b64_tr_b16 v[48:49], v9 offset:48
    ds_read_b64_tr_b16 v[50:51], v9 offset:1328
    ds_read_b128 v[24:27], v7 offset:2048
    ds_read_b128 v[28:31], v7 offset:3072
    ds_read_b64_tr_b16 v[52:53], v9 offset:96
    ds_read_b64_tr_b16 v[54:55], v9 offset:1376
    ds_read_b64_tr_b16 v[56:57], v10 offset:0
    ds_read_b64_tr_b16 v[58:59], v10 offset:1280
    ds_read_b64_tr_b16 v[60:61], v8 offset:0
    ds_read_b64_tr_b16 v[62:63], v8 offset:2304
    s_waitcnt lgkmcnt(6)
    v_mfma_f32_16x16x32_bf16 v[80:83], v[16:19], v[48:51], 0
    s_lshr_b32 s83, s2, 3
    v_mul_u32_u24 v64, 7282, v1
    v_lshrrev_b32 v64, 16, v64
    v_mul_u32_u24 v65, 9, v64
    v_sub_u32 v65, v1, v65
    v_lshlrev_b32 v64, 5, v64
    v_add_u32 v64, s83, v64
    v_mul_u32_u24 v66, 9216, v64
    v_lshl_add_u32 v66, v65, 7, v66
    s_mul_i32 s82, s25, 1152
    v_add_u32 v66, s82, v66
    v_cmp_gt_u32 vcc, 18, v1
    v_mov_b32 v67, 0x10000000
    s_nop 0
    v_cndmask_b32 v66, v67, v66, vcc
    v_mul_u32_u24 v64, 10923, v1
    v_lshrrev_b32 v64, 16, v64
    v_mul_u32_u24 v65, 6, v64
    v_sub_u32 v65, v1, v65
    v_lshlrev_b32 v64, 5, v64
    v_add_u32 v64, s83, v64
    v_mul_u32_u24 v64, 3456, v64
    v_lshrrev_b32 v68, 1, v65
    v_mul_u32_u24 v68, 1152, v68
    v_and_b32 v65, 1, v65
    v_lshl_add_u32 v65, v65, 7, v68
    v_add_u32 v64, v64, v65
    s_mul_i32 s82, s25, 144
    s_andn2_b32 s82, s82, 127
    v_add_u32 v64, s82, v64
    v_mfma_f32_16x16x32_bf16 v[84:87], v[20:23], v[48:51], 0
    v_cmp_gt_u32 vcc, 12, v1
    s_nop 1
    v_cndmask_b32 v64, v67, v64, vcc
    s_lshl_b32 s82, s83, 6
    v_add_u32 v65, s82, v1
    v_mul_u32_u24 v65, 1152, v65
    v_lshlrev_b32 v68, 7, v1
    s_cmp_eq_u32 s22, 2
    s_cselect_b64 vcc, -1, 0
    v_cndmask_b32 v66, v66, v64, vcc
    v_mfma_f32_16x16x32_bf16 v[88:91], v[24:27], v[48:51], 0
    s_cmp_eq_u32 s22, 3
    s_cselect_b64 vcc, -1, 0
    v_cndmask_b32 v66, v66, v65, vcc
    s_cmp_ge_u32 s22, 4
    s_cselect_b64 vcc, -1, 0
    v_cndmask_b32 v0, v66, v68, vcc
    s_mov_b32 s72, s8
    s_mov_b32 s73, s9
    s_mov_b32 s74, 5308416
    s_mov_b32 s77, 589824
    v_mfma_f32_16x16x32_bf16 v[92:95], v[28:31], v[48:51], 0
    s_cmp_eq_u32 s22, 1
    s_cselect_b32 s72, s10, s72
    s_cselect_b32 s73, s11, s73
    s_cmp_eq_u32 s22, 2
    s_cselect_b32 s72, s6, s72
    s_cselect_b32 s73, s7, s73
    s_cselect_b32 s74, 1990656, s74
    s_cselect_b32 s77, 221184, s77
    ds_read_b64_tr_b16 v[48:49], v8 offset:32
    ds_read_b64_tr_b16 v[50:51], v8 offset:2336
    s_waitcnt lgkmcnt(6)
    v_mfma_f32_16x16x32_bf16 v[96:99], v[16:19], v[52:55], 0
    s_cmp_eq_u32 s22, 3
    s_cselect_b32 s72, s4, s72
    s_cselect_b32 s73, s5, s73
    s_cselect_b32 s74, 2359296, s74
    s_cselect_b32 s77, 128, s77
    s_mov_b32 s76, s77
    s_lshl_b32 s82, s2, 2
    s_add_u32 s82, s82, s23
    s_mul_i32 s82, s82, 8192
    s_cmp_ge_u32 s22, 4
    s_cselect_b32 s72, s12, s72
    s_cselect_b32 s73, s13, s73
    s_cselect_b32 s77, 0x10000000, s77
    s_cselect_b32 s76, s82, s76
    s_sub_u32 s83, s82, 5308416
    v_mfma_f32_16x16x32_bf16 v[100:103], v[20:23], v[52:55], 0
    s_cmp_ge_u32 s82, 5308416
    s_cselect_b32 s86, 1, 0
    s_cmp_ge_u32 s22, 4
    s_cselect_b32 s86, s86, 0
    v_mfma_f32_16x16x32_bf16 v[104:107], v[24:27], v[52:55], 0
    s_cmp_eq_u32 s86, 1
    s_cselect_b32 s72, s26, s72
    s_cselect_b32 s73, s27, s73
    s_cselect_b32 s74, 663552, s74
    s_cselect_b32 s76, s83, s76
    s_sub_u32 s83, s76, 1073741824
    s_cmp_ge_u32 s22, 4
    s_cselect_b32 s76, s83, s76
    s_mov_b32 s75, 0x20000
    v_mfma_f32_16x16x32_bf16 v[108:111], v[28:31], v[52:55], 0
    ds_read_b64_tr_b16 v[52:53], v8 offset:9216
    ds_read_b64_tr_b16 v[54:55], v8 offset:11520
    s_waitcnt lgkmcnt(6)
    v_mfma_f32_16x16x32_bf16 v[112:115], v[16:19], v[56:59], 0
    v_mfma_f32_16x16x32_bf16 v[116:119], v[20:23], v[56:59], 0
    s_add_u32 m0, s64, s59
    s_nop 0
    buffer_load_dwordx4 v2, s[28:31], s52 offen lds
    v_mfma_f32_16x16x32_bf16 v[120:123], v[24:27], v[56:59], 0
    v_mfma_f32_16x16x32_bf16 v[124:127], v[28:31], v[56:59], 0
    ds_read_b64_tr_b16 v[56:57], v8 offset:9248
    ds_read_b64_tr_b16 v[58:59], v8 offset:11552
    s_waitcnt lgkmcnt(6)
    v_mfma_f32_16x16x32_bf16 v[128:131], v[60:63], v[16:19], 0
    v_mfma_f32_16x16x32_bf16 v[132:135], v[60:63], v[20:23], 0
    s_add_u32 m0, s64, s60
    s_nop 0
    buffer_load_dwordx4 v3, s[28:31], s52 offen lds
    s_add_u32 s52, s52, 64
    v_mfma_f32_16x16x32_bf16 v[136:139], v[60:63], v[24:27], 0
    v_mfma_f32_16x16x32_bf16 v[140:143], v[60:63], v[28:31], 0
    ds_read_b64_tr_b16 v[60:61], v8 offset:64
    ds_read_b64_tr_b16 v[62:63], v8 offset:2368
    s_waitcnt lgkmcnt(6)
    v_mfma_f32_16x16x32_bf16 v[144:147], v[48:51], v[16:19], 0
    v_mfma_f32_16x16x32_bf16 v[148:151], v[48:51], v[20:23], 0
    s_add_u32 m0, s64, s61
    s_nop 0
    buffer_load_dwordx4 v4, s[32:35], s53 offen lds
    s_add_u32 s53, s53, s56
    v_mfma_f32_16x16x32_bf16 v[152:155], v[48:51], v[24:27], 0
    v_mfma_f32_16x16x32_bf16 v[156:159], v[48:51], v[28:31], 0
    buffer_load_dword v79, v0, s[72:75], s76 offen
    s_add_u32 s76, s76, s77
    ds_read_b64_tr_b16 v[48:49], v8 offset:96
    ds_read_b64_tr_b16 v[50:51], v8 offset:2400
    s_waitcnt lgkmcnt(6)
    v_mfma_f32_16x16x32_bf16 v[160:163], v[52:55], v[16:19], 0
    v_mfma_f32_16x16x32_bf16 v[164:167], v[52:55], v[20:23], 0
    s_add_u32 m0, s64, s62
    s_nop 0
    buffer_load_dwordx4 v5, s[36:39], s54 offen lds
    s_add_u32 s54, s54, s57
    v_mfma_f32_16x16x32_bf16 v[168:171], v[52:55], v[24:27], 0
    v_mfma_f32_16x16x32_bf16 v[172:175], v[52:55], v[28:31], 0
    buffer_load_dword v79, v0, s[72:75], s76 offen
    s_add_u32 s76, s76, s77
    ds_read_b64_tr_b16 v[52:53], v8 offset:9280
    ds_read_b64_tr_b16 v[54:55], v8 offset:11584
    s_waitcnt lgkmcnt(6)
    v_mfma_f32_16x16x32_bf16 v[176:179], v[56:59], v[16:19], 0
    v_mfma_f32_16x16x32_bf16 v[180:183], v[56:59], v[20:23], 0
    s_add_u32 m0, s64, s63
    s_nop 0
    buffer_load_dwordx4 v6, s[40:43], s55 offen lds
    s_add_u32 s55, s55, s58
    s_add_u32 s64, s64, 39936
    s_cmp_eq_u32 s64, 159744
    s_cselect_b32 s64, 0, s64
    v_mfma_f32_16x16x32_bf16 v[184:187], v[56:59], v[24:27], 0
    v_mfma_f32_16x16x32_bf16 v[188:191], v[56:59], v[28:31], 0
    ds_read_b64_tr_b16 v[56:57], v8 offset:9312
    ds_read_b64_tr_b16 v[58:59], v8 offset:11616
    s_waitcnt lgkmcnt(6)
    v_mfma_f32_16x16x32_bf16 v[192:195], v[60:63], v[16:19], 0
    v_mfma_f32_16x16x32_bf16 v[196:199], v[60:63], v[20:23], 0
    v_mfma_f32_16x16x32_bf16 v[200:203], v[60:63], v[24:27], 0
    v_mfma_f32_16x16x32_bf16 v[204:207], v[60:63], v[28:31], 0
    s_add_u32 s67, s67, 1
    s_and_b32 s67, s67, 3
    s_cmp_eq_u32 s67, 0
    s_mov_b32 s66, 39936
    s_cselect_b32 s66, -119808, s66
    v_add_u32 v7, s66, v7
    v_add_u32 v8, s66, v8
    v_add_u32 v9, s66, v9
    v_add_u32 v10, s66, v10
    s_waitcnt vmcnt(7)
    s_waitcnt lgkmcnt(0)
    s_barrier
    ds_read_b128 v[32:35], v7 offset:0
    ds_read_b128 v[36:39], v7 offset:1024
    v_mfma_f32_16x16x32_bf16 v[208:211], v[48:51], v[16:19], 0
    v_mfma_f32_16x16x32_bf16 v[212:215], v[48:51], v[20:23], 0
    v_mfma_f32_16x16x32_bf16 v[216:219], v[48:51], v[24:27], 0
    v_mfma_f32_16x16x32_bf16 v[220:223], v[48:51], v[28:31], 0
    ds_read_b64_tr_b16 v[48:49], v9 offset:48
    ds_read_b64_tr_b16 v[50:51], v9 offset:1328
    ds_read_b128 v[40:43], v7 offset:2048
    ds_read_b128 v[44:47], v7 offset:3072
    v_mfma_f32_16x16x32_bf16 v[224:227], v[52:55], v[16:19], 0
    v_mfma_f32_16x16x32_bf16 v[228:231], v[52:55], v[20:23], 0
    v_mfma_f32_16x16x32_bf16 v[232:235], v[52:55], v[24:27], 0
    v_mfma_f32_16x16x32_bf16 v[236:239], v[52:55], v[28:31], 0
    ds_read_b64_tr_b16 v[52:53], v9 offset:96
    ds_read_b64_tr_b16 v[54:55], v9 offset:1376
    v_mfma_f32_16x16x32_bf16 v[240:243], v[56:59], v[16:19], 0
    v_mfma_f32_16x16x32_bf16 v[244:247], v[56:59], v[20:23], 0
    s_add_u32 m0, s64, s59
    s_nop 0
    buffer_load_dwordx4 v2, s[28:31], s52 offen lds
    v_mfma_f32_16x16x32_bf16 v[248:251], v[56:59], v[24:27], 0
    v_mfma_f32_16x16x32_bf16 v[252:255], v[56:59], v[28:31], 0
    ds_read_b64_tr_b16 v[56:57], v10 offset:0
    ds_read_b64_tr_b16 v[58:59], v10 offset:1280
    ds_read_b64_tr_b16 v[60:61], v8 offset:0
    ds_read_b64_tr_b16 v[62:63], v8 offset:2304
    s_waitcnt lgkmcnt(6)
    v_mfma_f32_16x16x32_bf16 v[80:83], v[32:35], v[48:51], v[80:83]
    v_mfma_f32_16x16x32_bf16 v[84:87], v[36:39], v[48:51], v[84:87]
    v_mfma_f32_16x16x32_bf16 v[88:91], v[40:43], v[48:51], v[88:91]
    v_mfma_f32_16x16x32_bf16 v[92:95], v[44:47], v[48:51], v[92:95]
    ds_read_b64_tr_b16 v[48:49], v8 offset:32
    ds_read_b64_tr_b16 v[50:51], v8 offset:2336
    s_waitcnt lgkmcnt(6)
    v_mfma_f32_16x16x32_bf16 v[96:99], v[32:35], v[52:55], v[96:99]
    v_mfma_f32_16x16x32_bf16 v[100:103], v[36:39], v[52:55], v[100:103]
    v_mfma_f32_16x16x32_bf16 v[104:107], v[40:43], v[52:55], v[104:107]
    v_mfma_f32_16x16x32_bf16 v[108:111], v[44:47], v[52:55], v[108:111]
    ds_read_b64_tr_b16 v[52:53], v8 offset:9216
    ds_read_b64_tr_b16 v[54:55], v8 offset:11520
    s_waitcnt lgkmcnt(6)
    v_mfma_f32_16x16x32_bf16 v[112:115], v[32:35], v[56:59], v[112:115]
    v_mfma_f32_16x16x32_bf16 v[116:119], v[36:39], v[56:59], v[116:119]
    s_add_u32 m0, s64, s60
    s_nop 0
    buffer_load_dwordx4 v3, s[28:31], s52 offen lds
    s_add_u32 s52, s52, 64
    v_mfma_f32_16x16x32_bf16 v[120:123], v[40:43], v[56:59], v[120:123]
    v_mfma_f32_16x16x32_bf16 v[124:127], v[44:47], v[56:59], v[124:127]
    ds_read_b64_tr_b16 v[56:57], v8 offset:9248
    ds_read_b64_tr_b16 v[58:59], v8 offset:11552
    s_waitcnt lgkmcnt(6)
    v_mfma_f32_16x16x32_bf16 v[128:131], v[60:63], v[32:35], v[128:131]
    v_mfma_f32_16x16x32_bf16 v[132:135], v[60:63], v[36:39], v[132:135]
    s_add_u32 m0, s64, s61
    s_nop 0
    buffer_load_dwordx4 v4, s[32:35], s53 offen lds
    s_add_u32 s53, s53, s56
    v_mfma_f32_16x16x32_bf16 v[136:139], v[60:63], v[40:43], v[136:139]
    v_mfma_f32_16x16x32_bf16 v[140:143], v[60:63], v[44:47], v[140:143]
    buffer_load_dword v79, v0, s[72:75], s76 offen
    s_add_u32 s76, s76, s77
    ds_read_b64_tr_b16 v[60:61], v8 offset:64
    ds_read_b64_tr_b16 v[62:63], v8 offset:2368
    s_waitcnt lgkmcnt(6)
    v_mfma_f32_16x16x32_bf16 v[144:147], v[48:51], v[32:35], v[144:147]
    v_mfma_f32_16x16x32_bf16 v[148:151], v[48:51], v[36:39], v[148:151]
    s_add_u32 m0, s64, s62
    s_nop 0
    buffer_load_dwordx4 v5, s[36:39], s54 offen lds
    s_add_u32 s54, s54, s57
    v_mfma_f32_16x16x32_bf16 v[152:155], v[48:51], v[40:43], v[152:155]
    v_mfma_f32_16x16x32_bf16 v[156:159], v[48:51], v[44:47], v[156:159]
    ds_read_b64_tr_b16 v[48:49], v8 offset:96
    ds_read_b64_tr_b16 v[50:51], v8 offset:2400
    s_waitcnt lgkmcnt(6)
    v_mfma_f32_16x16x32_bf16 v[160:163], v[52:55], v[32:35], v[160:163]
    v_mfma_f32_16x16x32_bf16 v[164:167], v[52:55], v[36:39], v[164:167]
    s_add_u32 m0, s64, s63
    s_nop 0
    buffer_load_dwordx4 v6, s[40:43], s55 offen lds
    s_add_u32 s55, s55, s58
    s_add_u32 s64, s64, 39936
    s_cmp_eq_u32 s64, 159744
    s_cselect_b32 s64, 0, s64
    v_mfma_f32_16x16x32_bf16 v[168:171], v[52:55], v[40:43], v[168:171]
    v_mfma_f32_16x16x32_bf16 v[172:175], v[52:55], v[44:47], v[172:175]
    ds_read_b64_tr_b16 v[52:53], v8 offset:9280
    ds_read_b64_tr_b16 v[54:55], v8 offset:11584
    s_waitcnt lgkmcnt(6)
    v_mfma_f32_16x16x32_bf16 v[176:179], v[56:59], v[32:35], v[176:179]
    v_mfma_f32_16x16x32_bf16 v[180:183], v[56:59], v[36:39], v[180:183]
    v_mfma_f32_16x16x32_bf16 v[184:187], v[56:59], v[40:43], v[184:187]
    v_mfma_f32_16x16x32_bf16 v[188:191], v[56:59], v[44:47], v[188:191]
    ds_read_b64_tr_b16 v[56:57], v8 offset:9312
    ds_read_b64_tr_b16 v[58:59], v8 offset:11616
    s_waitcnt lgkmcnt(6)
    v_mfma_f32_16x16x32_bf16 v[192:195], v[60:63], v[32:35], v[192:195]
    v_mfma_f32_16x16x32_bf16 v[196:199], v[60:63], v[36:39], v[196:199]
    v_mfma_f32_16x16x32_bf16 v[200:203], v[60:63], v[40:43], v[200:203]
    v_mfma_f32_16x16x32_bf16 v[204:207], v[60:63], v[44:47], v[204:207]
    s_add_u32 s67, s67, 1
    s_and_b32 s67, s67, 3
    s_cmp_eq_u32 s67, 0
    s_mov_b32 s66, 39936
    s_cselect_b32 s66, -119808, s66
    v_add_u32 v7, s66, v7
    v_add_u32 v8, s66, v8
    v_add_u32 v9, s66, v9
    v_add_u32 v10, s66, v10
    s_waitcnt vmcnt(6)
    s_waitcnt lgkmcnt(0)
    s_barrier
    ds_read_b128 v[16:19], v7 offset:0
    ds_read_b128 v[20:23], v7 offset:1024
    v_mfma_f32_16x16x32_bf16 v[208:211], v[48:51], v[32:35], v[208:211]
    v_mfma_f32_16x16x32_bf16 v[212:215], v[48:51], v[36:39], v[212:215]
    v_mfma_f32_16x16x32_bf16 v[216:219], v[48:51], v[40:43], v[216:219]
    v_mfma_f32_16x16x32_bf16 v[220:223], v[48:51], v[44:47], v[220:223]
    ds_read_b64_tr_b16 v[48:49], v9 offset:48
    ds_read_b64_tr_b16 v[50:51], v9 offset:1328
    ds_read_b128 v[24:27], v7 offset:2048
    ds_read_b128 v[28:31], v7 offset:3072
    v_mfma_f32_16x16x32_bf16 v[224:227], v[52:55], v[32:35], v[224:227]
    v_mfma_f32_16x16x32_bf16 v[228:231], v[52:55], v[36:39], v[228:231]
    v_mfma_f32_16x16x32_bf16 v[232:235], v[52:55], v[40:43], v[232:235]
    v_mfma_f32_16x16x32_bf16 v[236:239], v[52:55], v[44:47], v[236:239]
    ds_read_b64_tr_b16 v[52:53], v9 offset:96
    ds_read_b64_tr_b16 v[54:55], v9 offset:1376
    v_mfma_f32_16x16x32_bf16 v[240:243], v[56:59], v[32:35], v[240:243]
    v_mfma_f32_16x16x32_bf16 v[244:247], v[56:59], v[36:39], v[244:247]
    s_add_u32 m0, s64, s59
    s_nop 0
    buffer_load_dwordx4 v2, s[28:31], s52 offen lds
    v_mfma_f32_16x16x32_bf16 v[248:251], v[56:59], v[40:43], v[248:251]
    v_mfma_f32_16x16x32_bf16 v[252:255], v[56:59], v[44:47], v[252:255]
    ds_read_b64_tr_b16 v[56:57], v10 offset:0
    ds_read_b64_tr_b16 v[58:59], v10 offset:1280
    s_mov_b32 s65, 5
L_k1_loop1:
    ds_read_b64_tr_b16 v[60:61], v8 offset:0
    ds_read_b64_tr_b16 v[62:63], v8 offset:2304
    s_waitcnt lgkmcnt(6)
    v_mfma_f32_16x16x32_bf16 v[80:83], v[16:19], v[48:51], v[80:83]
    v_mfma_f32_16x16x32_bf16 v[84:87], v[20:23], v[48:51], v[84:87]
    v_mfma_f32_16x16x32_bf16 v[88:91], v[24:27], v[48:51], v[88:91]
    v_mfma_f32_16x16x32_bf16 v[92:95], v[28:31], v[48:51], v[92:95]
    ds_read_b64_tr_b16 v[48:49], v8 offset:32
    ds_read_b64_tr_b16 v[50:51], v8 offset:2336
    s_waitcnt lgkmcnt(6)
    v_mfma_f32_16x16x32_bf16 v[96:99], v[16:19], v[52:55], v[96:99]
    v_mfma_f32_16x16x32_bf16 v[100:103], v[20:23], v[52:55], v[100:103]
    v_mfma_f32_16x16x32_bf16 v[104:107], v[24:27], v[52:55], v[104:107]
    v_mfma_f32_16x16x32_bf16 v[108:111], v[28:31], v[52:55], v[108:111]
    ds_read_b64_tr_b16 v[52:53], v8 offset:9216
    ds_read_b64_tr_b16 v[54:55], v8 offset:11520
    s_waitcnt lgkmcnt(6)
    v_mfma_f32_16x16x32_bf16 v[112:115], v[16:19], v[56:59], v[112:115]
    v_mfma_f32_16x16x32_bf16 v[116:119], v[20:23], v[56:59], v[116:119]
    s_add_u32 m0, s64, s60
    s_nop 0
    buffer_load_dwordx4 v3, s[28:31], s52 offen lds
    s_add_u32 s52, s52, 64
    v_mfma_f32_16x16x32_bf16 v[120:123], v[24:27], v[56:59], v[120:123]
    v_mfma_f32_16x16x32_bf16 v[124:127], v[28:31], v[56:59], v[124:127]
    ds_read_b64_tr_b16 v[56:57], v8 offset:9248
    ds_read_b64_tr_b16 v[58:59], v8 offset:11552
    s_waitcnt lgkmcnt(6)
    v_mfma_f32_16x16x32_bf16 v[128:131], v[60:63], v[16:19], v[128:131]
    v_mfma_f32_16x16x32_bf16 v[132:135], v[60:63], v[20:23], v[132:135]
    s_add_u32 m0, s64, s61
    s_nop 0
    buffer_load_dwordx4 v4, s[32:35], s53 offen lds
    s_add_u32 s53, s53, s56
    v_mfma_f32_16x16x32_bf16 v[136:139], v[60:63], v[24:27], v[136:139]
    v_mfma_f32_16x16x32_bf16 v[140:143], v[60:63], v[28:31], v[140:143]
    ds_read_b64_tr_b16 v[60:61], v8 offset:64
    ds_read_b64_tr_b16 v[62:63], v8 offset:2368
    s_waitcnt lgkmcnt(6)
    v_mfma_f32_16x16x32_bf16 v[144:147], v[48:51], v[16:19], v[144:147]
    v_mfma_f32_16x16x32_bf16 v[148:151], v[48:51], v[20:23], v[148:151]
    s_add_u32 m0, s64, s62
    s_nop 0
    buffer_load_dwordx4 v5, s[36:39], s54 offen lds
    s_add_u32 s54, s54, s57
    v_mfma_f32_16x16x32_bf16 v[152:155], v[48:51], v[24:27], v[152:155]
    v_mfma_f32_16x16x32_bf16 v[156:159], v[48:51], v[28:31], v[156:159]
    ds_read_b64_tr_b16 v[48:49], v8 offset:96
    ds_read_b64_tr_b16 v[50:51], v8 offset:2400
    s_waitcnt lgkmcnt(6)
    v_mfma_f32_16x16x32_bf16 v[160:163], v[52:55], v[16:19], v[160:163]
    v_mfma_f32_16x16x32_bf16 v[164:167], v[52:55], v[20:23], v[164:167]
    s_add_u32 m0, s64, s63
    s_nop 0
    buffer_load_dwordx4 v6, s[40:43], s55 offen lds
    s_add_u32 s55, s55, s58
    s_add_u32 s64, s64, 39936
    s_cmp_eq_u32 s64, 159744
    s_cselect_b32 s64, 0, s64
    v_mfma_f32_16x16x32_bf16 v[168:171], v[52:55], v[24:27], v[168:171]
    v_mfma_f32_16x16x32_bf16 v[172:175], v[52:55], v[28:31], v[172:175]
    ds_read_b64_tr_b16 v[52:53], v8 offset:9280
    ds_read_b64_tr_b16 v[54:55], v8 offset:11584
    s_waitcnt lgkmcnt(6)
    v_mfma_f32_16x16x32_bf16 v[176:179], v[56:59], v[16:19], v[176:179]
    v_mfma_f32_16x16x32_bf16 v[180:183], v[56:59], v[20:23], v[180:183]
    v_mfma_f32_16x16x32_bf16 v[184:187], v[56:59], v[24:27], v[184:187]
    v_mfma_f32_16x16x32_bf16 v[188:191], v[56:59], v[28:31], v[188:191]
    buffer_load_dword v79, v0, s[72:75], s76 offen
    s_add_u32 s76, s76, s77
    ds_read_b64_tr_b16 v[56:57], v8 offset:9312
    ds_read_b64_tr_b16 v[58:59], v8 offset:11616
    s_waitcnt lgkmcnt(6)
    v_mfma_f32_16x16x32_bf16 v[192:195], v[60:63], v[16:19], v[192:195]
    v_mfma_f32_16x16x32_bf16 v[196:199], v[60:63], v[20:23], v[196:199]
    v_mfma_f32_16x16x32_bf16 v[200:203], v[60:63], v[24:27], v[200:203]
    v_mfma_f32_16x16x32_bf16 v[204:207], v[60:63], v[28:31], v[204:207]
    s_add_u32 s67, s67, 1
    s_and_b32 s67, s67, 3
    s_cmp_eq_u32 s67, 0
    s_mov_b32 s66, 39936
    s_cselect_b32 s66, -119808, s66
    v_add_u32 v7, s66, v7
    v_add_u32 v8, s66, v8
    v_add_u32 v9, s66, v9
    v_add_u32 v10, s66, v10
    s_waitcnt vmcnt(6)
    s_waitcnt lgkmcnt(0)
    s_barrier
    ds_read_b128 v[32:35], v7 offset:0
    ds_read_b128 v[36:39], v7 offset:1024
    v_mfma_f32_16x16x32_bf16 v[208:211], v[48:51], v[16:19], v[208:211]
    v_mfma_f32_16x16x32_bf16 v[212:215], v[48:51], v[20:23], v[212:215]
    v_mfma_f32_16x16x32_bf16 v[216:219], v[48:51], v[24:27], v[216:219]
    v_mfma_f32_16x16x32_bf16 v[220:223], v[48:51], v[28:31], v[220:223]
    ds_read_b64_tr_b16 v[48:49], v9 offset:48
    ds_read_b64_tr_b16 v[50:51], v9 offset:1328
    ds_read_b128 v[40:43], v7 offset:2048
    ds_read_b128 v[44:47], v7 offset:3072
    v_mfma_f32_16x16x32_bf16 v[224:227], v[52:55], v[16:19], v[224:227]
    v_mfma_f32_16x16x32_bf16 v[228:231], v[52:55], v[20:23], v[228:231]
    v_mfma_f32_16x16x32_bf16 v[232:235], v[52:55], v[24:27], v[232:235]
    v_mfma_f32_16x16x32_bf16 v[236:239], v[52:55], v[28:31], v[236:239]
    ds_read_b64_tr_b16 v[52:53], v9 offset:96
    ds_read_b64_tr_b16 v[54:55], v9 offset:1376
    v_mfma_f32_16x16x32_bf16 v[240:243], v[56:59], v[16:19], v[240:243]
    v_mfma_f32_16x16x32_bf16 v[244:247], v[56:59], v[20:23], v[244:247]
    s_add_u32 m0, s64, s59
    s_nop 0
    buffer_load_dwordx4 v2, s[28:31], s52 offen lds
    v_mfma_f32_16x16x32_bf16 v[248:251], v[56:59], v[24:27], v[248:251]
    v_mfma_f32_16x16x32_bf16 v[252:255], v[56:59], v[28:31], v[252:255]
    ds_read_b64_tr_b16 v[56:57], v10 offset:0
    ds_read_b64_tr_b16 v[58:59], v10 offset:1280
    ds_read_b64_tr_b16 v[60:61], v8 offset:0
    ds_read_b64_tr_b16 v[62:63], v8 offset:2304
    s_waitcnt lgkmcnt(6)
    v_mfma_f32_16x16x32_bf16 v[80:83], v[32:35], v[48:51], v[80:83]
    v_mfma_f32_16x16x32_bf16 v[84:87], v[36:39], v[48:51], v[84:87]
    v_mfma_f32_16x16x32_bf16 v[88:91], v[40:43], v[48:51], v[88:91]
    v_mfma_f32_16x16x32_bf16 v[92:95], v[44:47], v[48:51], v[92:95]
    ds_read_b64_tr_b16 v[48:49], v8 offset:32
    ds_read_b64_tr_b16 v[50:51], v8 offset:2336
    s_waitcnt lgkmcnt(6)
    v_mfma_f32_16x16x32_bf16 v[96:99], v[32:35], v[52:55], v[96:99]
    v_mfma_f32_16x16x32_bf16 v[100:103], v[36:39], v[52:55], v[100:103]
    v_mfma_f32_16x16x32_bf16 v[104:107], v[40:43], v[52:55], v[104:107]
    v_mfma_f32_16x16x32_bf16 v[108:111], v[44:47], v[52:55], v[108:111]
    ds_read_b64_tr_b16 v[52:53], v8 offset:9216
    ds_read_b64_tr_b16 v[54:55], v8 offset:11520
    s_waitcnt lgkmcnt(6)
    v_mfma_f32_16x16x32_bf16 v[112:115], v[32:35], v[56:59], v[112:115]
    v_mfma_f32_16x16x32_bf16 v[116:119], v[36:39], v[56:59], v[116:119]
    s_add_u32 m0, s64, s60
    s_nop 0
    buffer_load_dwordx4 v3, s[28:31], s52 offen lds
    s_add_u32 s52, s52, 64
    v_mfma_f32_16x16x32_bf16 v[120:123], v[40:43], v[56:59], v[120:123]
    v_mfma_f32_16x16x32_bf16 v[124:127], v[44:47], v[56:59], v[124:127]
    ds_read_b64_tr_b16 v[56:57], v8 offset:9248
    ds_read_b64_tr_b16 v[58:59], v8 offset:11552
    s_waitcnt lgkmcnt(6)
    v_mfma_f32_16x16x32_bf16 v[128:131], v[60:63], v[32:35], v[128:131]
    v_mfma_f32_16x16x32_bf16 v[132:135], v[60:63], v[36:39], v[132:135]
    s_add_u32 m0, s64, s61
    s_nop 0
    buffer_load_dwordx4 v4, s[32:35], s53 offen lds
    s_add_u32 s53, s53, s56
    v_mfma_f32_16x16x32_bf16 v[136:139], v[60:63], v[40:43], v[136:139]
    v_mfma_f32_16x16x32_bf16 v[140:143], v[60:63], v[44:47], v[140:143]
    ds_read_b64_tr_b16 v[60:61], v8 offset:64
    ds_read_b64_tr_b16 v[62:63], v8 offset:2368
    s_waitcnt lgkmcnt(6)
    v_mfma_f32_16x16x32_bf16 v[144:147], v[48:51], v[32:35], v[144:147]
    v_mfma_f32_16x16x32_bf16 v[148:151], v[48:51], v[36:39], v[148:151]
    s_add_u32 m0, s64, s62
    s_nop 0
    buffer_load_dwordx4 v5, s[36:39], s54 offen lds
    s_add_u32 s54, s54, s57
    v_mfma_f32_16x16x32_bf16 v[152:155], v[48:51], v[40:43], v[152:155]
    v_mfma_f32_16x16x32_bf16 v[156:159], v[48:51], v[44:47], v[156:159]
    ds_read_b64_tr_b16 v[48:49], v8 offset:96
    ds_read_b64_tr_b16 v[50:51], v8 offset:2400
    s_waitcnt lgkmcnt(6)
    v_mfma_f32_16x16x32_bf16 v[160:163], v[52:55], v[32:35], v[160:163]
    v_mfma_f32_16x16x32_bf16 v[164:167], v[52:55], v[36:39], v[164:167]
    s_add_u32 m0, s64, s63
    s_nop 0
    buffer_load_dwordx4 v6, s[40:43], s55 offen lds
    s_add_u32 s55, s55, s58
    s_add_u32 s64, s64, 39936
    s_cmp_eq_u32 s64, 159744
    s_cselect_b32 s64, 0, s64
    v_mfma_f32_16x16x32_bf16 v[168:171], v[52:55], v[40:43], v[168:171]
    v_mfma_f32_16x16x32_bf16 v[172:175], v[52:55], v[44:47], v[172:175]
    ds_read_b64_tr_b16 v[52:53], v8 offset:9280
    ds_read_b64_tr_b16 v[54:55], v8 offset:11584
    s_waitcnt lgkmcnt(6)
    v_mfma_f32_16x16x32_bf16 v[176:179], v[56:59], v[32:35], v[176:179]
    v_mfma_f32_16x16x32_bf16 v[180:183], v[56:59], v[36:39], v[180:183]
    v_mfma_f32_16x16x32_bf16 v[184:187], v[56:59], v[40:43], v[184:187]
    v_mfma_f32_16x16x32_bf16 v[188:191], v[56:59], v[44:47], v[188:191]
    ds_read_b64_tr_b16 v[56:57], v8 offset:9312
    ds_read_b64_tr_b16 v[58:59], v8 offset:11616
    s_waitcnt lgkmcnt(6)
    v_mfma_f32_16x16x32_bf16 v[192:195], v[60:63], v[32:35], v[192:195]
    v_mfma_f32_16x16x32_bf16 v[196:199], v[60:63], v[36:39], v[196:199]
    v_mfma_f32_16x16x32_bf16 v[200:203], v[60:63], v[40:43], v[200:203]
    v_mfma_f32_16x16x32_bf16 v[204:207], v[60:63], v[44:47], v[204:207]
    s_add_u32 s67, s67, 1
    s_and_b32 s67, s67, 3
    s_cmp_eq_u32 s67, 0
    s_mov_b32 s66, 39936
    s_cselect_b32 s66, -119808, s66
    v_add_u32 v7, s66, v7
    v_add_u32 v8, s66, v8
    v_add_u32 v9, s66, v9
    v_add_u32 v10, s66, v10
    s_waitcnt vmcnt(6)
    s_waitcnt lgkmcnt(0)
    s_barrier
    ds_read_b128 v[16:19], v7 offset:0
    ds_read_b128 v[20:23], v7 offset:1024
    v_mfma_f32_16x16x32_bf16 v[208:211], v[48:51], v[32:35], v[208:211]
    v_mfma_f32_16x16x32_bf16 v[212:215], v[48:51], v[36:39], v[212:215]
    v_mfma_f32_16x16x32_bf16 v[216:219], v[48:51], v[40:43], v[216:219]
    v_mfma_f32_16x16x32_bf16 v[220:223], v[48:51], v[44:47], v[220:223]
    ds_read_b64_tr_b16 v[48:49], v9 offset:48
    ds_read_b64_tr_b16 v[50:51], v9 offset:1328
    ds_read_b128 v[24:27], v7 offset:2048
    ds_read_b128 v[28:31], v7 offset:3072
    v_mfma_f32_16x16x32_bf16 v[224:227], v[52:55], v[32:35], v[224:227]
    v_mfma_f32_16x16x32_bf16 v[228:231], v[52:55], v[36:39], v[228:231]
    v_mfma_f32_16x16x32_bf16 v[232:235], v[52:55], v[40:43], v[232:235]
    v_mfma_f32_16x16x32_bf16 v[236:239], v[52:55], v[44:47], v[236:239]
    ds_read_b64_tr_b16 v[52:53], v9 offset:96
    ds_read_b64_tr_b16 v[54:55], v9 offset:1376
    v_mfma_f32_16x16x32_bf16 v[240:243], v[56:59], v[32:35], v[240:243]
    v_mfma_f32_16x16x32_bf16 v[244:247], v[56:59], v[36:39], v[244:247]
    s_add_u32 m0, s64, s59
    s_nop 0
    buffer_load_dwordx4 v2, s[28:31], s52 offen lds
    v_mfma_f32_16x16x32_bf16 v[248:251], v[56:59], v[40:43], v[248:251]
    v_mfma_f32_16x16x32_bf16 v[252:255], v[56:59], v[44:47], v[252:255]
    ds_read_b64_tr_b16 v[56:57], v10 offset:0
    ds_read_b64_tr_b16 v[58:59], v10 offset:1280
    s_sub_u32 s65, s65, 1
    s_cmp_lg_u32 s65, 0
    s_cbranch_scc1 L_k1_loop1
    ds_read_b64_tr_b16 v[60:61], v8 offset:0
    ds_read_b64_tr_b16 v[62:63], v8 offset:2304
    s_waitcnt lgkmcnt(6)
    v_mfma_f32_16x16x32_bf16 v[80:83], v[16:19], v[48:51], v[80:83]
    v_mfma_f32_16x16x32_bf16 v[84:87], v[20:23], v[48:51], v[84:87]
    v_mfma_f32_16x16x32_bf16 v[88:91], v[24:27], v[48:51], v[88:91]
    v_mfma_f32_16x16x32_bf16 v[92:95], v[28:31], v[48:51], v[92:95]
    ds_read_b64_tr_b16 v[48:49], v8 offset:32
    ds_read_b64_tr_b16 v[50:51], v8 offset:2336
    s_waitcnt lgkmcnt(6)
    v_mfma_f32_16x16x32_bf16 v[96:99], v[16:19], v[52:55], v[96:99]
    v_mfma_f32_16x16x32_bf16 v[100:103], v[20:23], v[52:55], v[100:103]
    v_mfma_f32_16x16x32_bf16 v[104:107], v[24:27], v[52:55], v[104:107]
    v_mfma_f32_16x16x32_bf16 v[108:111], v[28:31], v[52:55], v[108:111]
    ds_read_b64_tr_b16 v[52:53], v8 offset:9216
    ds_read_b64_tr_b16 v[54:55], v8 offset:11520
    s_waitcnt lgkmcnt(6)
    v_mfma_f32_16x16x32_bf16 v[112:115], v[16:19], v[56:59], v[112:115]
    v_mfma_f32_16x16x32_bf16 v[116:119], v[20:23], v[56:59], v[116:119]
    s_add_u32 m0, s64, s60
    s_nop 0
    buffer_load_dwordx4 v3, s[28:31], s52 offen lds
    s_add_u32 s52, s52, 64
    v_mfma_f32_16x16x32_bf16 v[120:123], v[24:27], v[56:59], v[120:123]
    v_mfma_f32_16x16x32_bf16 v[124:127], v[28:31], v[56:59], v[124:127]
    ds_read_b64_tr_b16 v[56:57], v8 offset:9248
    ds_read_b64_tr_b16 v[58:59], v8 offset:11552
    s_waitcnt lgkmcnt(6)
    v_mfma_f32_16x16x32_bf16 v[128:131], v[60:63], v[16:19], v[128:131]
    v_mfma_f32_16x16x32_bf16 v[132:135], v[60:63], v[20:23], v[132:135]
    s_add_u32 m0, s64, s61
    s_nop 0
    buffer_load_dwordx4 v4, s[32:35], s53 offen lds
    s_add_u32 s53, s53, s56
    v_mfma_f32_16x16x32_bf16 v[136:139], v[60:63], v[24:27], v[136:139]
    v_mfma_f32_16x16x32_bf16 v[140:143], v[60:63], v[28:31], v[140:143]
    buffer_load_dwordx4 v[64:67], v14, s[28:31], s71 offen
    ds_read_b64_tr_b16 v[60:61], v8 offset:64
    ds_read_b64_tr_b16 v[62:63], v8 offset:2368
    s_waitcnt lgkmcnt(6)
    v_mfma_f32_16x16x32_bf16 v[144:147], v[48:51], v[16:19], v[144:147]
    v_mfma_f32_16x16x32_bf16 v[148:151], v[48:51], v[20:23], v[148:151]
    s_add_u32 m0, s64, s62
    s_nop 0
    buffer_load_dwordx4 v5, s[36:39], s54 offen lds
    s_add_u32 s54, s54, s57
    v_mfma_f32_16x16x32_bf16 v[152:155], v[48:51], v[24:27], v[152:155]
    v_mfma_f32_16x16x32_bf16 v[156:159], v[48:51], v[28:31], v[156:159]
    buffer_load_dwordx4 v[68:71], v14, s[28:31], s71 offen offset:16
    ds_read_b64_tr_b16 v[48:49], v8 offset:96
    ds_read_b64_tr_b16 v[50:51], v8 offset:2400
    s_waitcnt lgkmcnt(6)
    v_mfma_f32_16x16x32_bf16 v[160:163], v[52:55], v[16:19], v[160:163]
    v_mfma_f32_16x16x32_bf16 v[164:167], v[52:55], v[20:23], v[164:167]
    s_add_u32 m0, s64, s63
    s_nop 0
    buffer_load_dwordx4 v6, s[40:43], s55 offen lds
    s_add_u32 s55, s55, s58
    s_add_u32 s64, s64, 39936
    s_cmp_eq_u32 s64, 159744
    s_cselect_b32 s64, 0, s64
    v_mfma_f32_16x16x32_bf16 v[168:171], v[52:55], v[24:27], v[168:171]
    v_mfma_f32_16x16x32_bf16 v[172:175], v[52:55], v[28:31], v[172:175]
    buffer_load_dwordx4 v[72:75], v14, s[48:51], 0 offen
    ds_read_b64_tr_b16 v[52:53], v8 offset:9280
    ds_read_b64_tr_b16 v[54:55], v8 offset:11584
    s_waitcnt lgkmcnt(6)
    v_mfma_f32_16x16x32_bf16 v[176:179], v[56:59], v[16:19], v[176:179]
    v_mfma_f32_16x16x32_bf16 v[180:183], v[56:59], v[20:23], v[180:183]
    v_mfma_f32_16x16x32_bf16 v[184:187], v[56:59], v[24:27], v[184:187]
    v_mfma_f32_16x16x32_bf16 v[188:191], v[56:59], v[28:31], v[188:191]
    buffer_load_dwordx4 v[76:79], v14, s[48:51], 0 offen offset:16
    ds_read_b64_tr_b16 v[56:57], v8 offset:9312
    ds_read_b64_tr_b16 v[58:59], v8 offset:11616
    s_waitcnt lgkmcnt(6)
    v_mfma_f32_16x16x32_bf16 v[192:195], v[60:63], v[16:19], v[192:195]
    v_mfma_f32_16x16x32_bf16 v[196:199], v[60:63], v[20:23], v[196:199]
    v_mfma_f32_16x16x32_bf16 v[200:203], v[60:63], v[24:27], v[200:203]
    v_mfma_f32_16x16x32_bf16 v[204:207], v[60:63], v[28:31], v[204:207]
    s_add_u32 s67, s67, 1
    s_and_b32 s67, s67, 3
    s_cmp_eq_u32 s67, 0
    s_mov_b32 s66, 39936
    s_cselect_b32 s66, -119808, s66
    v_add_u32 v7, s66, v7
    v_add_u32 v8, s66, v8
    v_add_u32 v9, s66, v9
    v_add_u32 v10, s66, v10
    s_waitcnt vmcnt(9)
    s_waitcnt lgkmcnt(0)
    s_barrier
    ds_read_b128 v[32:35], v7 offset:0
    ds_read_b128 v[36:39], v7 offset:1024
    v_mfma_f32_16x16x32_bf16 v[208:211], v[48:51], v[16:19], v[208:211]
    v_mfma_f32_16x16x32_bf16 v[212:215], v[48:51], v[20:23], v[212:215]
    v_mfma_f32_16x16x32_bf16 v[216:219], v[48:51], v[24:27], v[216:219]
    v_mfma_f32_16x16x32_bf16 v[220:223], v[48:51], v[28:31], v[220:223]
    ds_read_b64_tr_b16 v[48:49], v9 offset:48
    ds_read_b64_tr_b16 v[50:51], v9 offset:1328
    ds_read_b128 v[40:43], v7 offset:2048
    ds_read_b128 v[44:47], v7 offset:3072
    v_mfma_f32_16x16x32_bf16 v[224:227], v[52:55], v[16:19], v[224:227]
    v_mfma_f32_16x16x32_bf16 v[228:231], v[52:55], v[20:23], v[228:231]
    v_mfma_f32_16x16x32_bf16 v[232:235], v[52:55], v[24:27], v[232:235]
    v_mfma_f32_16x16x32_bf16 v[236:239], v[52:55], v[28:31], v[236:239]
    ds_read_b64_tr_b16 v[52:53], v9 offset:96
    ds_read_b64_tr_b16 v[54:55], v9 offset:1376
    v_mfma_f32_16x16x32_bf16 v[240:243], v[56:59], v[16:19], v[240:243]
    v_mfma_f32_16x16x32_bf16 v[244:247], v[56:59], v[20:23], v[244:247]
    s_add_u32 m0, s64, s59
    s_nop 0
    buffer_load_dwordx4 v2, s[28:31], s52 offen lds
    v_mfma_f32_16x16x32_bf16 v[248:251], v[56:59], v[24:27], v[248:251]
    v_mfma_f32_16x16x32_bf16 v[252:255], v[56:59], v[28:31], v[252:255]
    ds_read_b64_tr_b16 v[56:57], v10 offset:0
    ds_read_b64_tr_b16 v[58:59], v10 offset:1280
    s_waitcnt vmcnt(1)
    ds_read_b64_tr_b16 v[60:61], v8 offset:0
    ds_read_b64_tr_b16 v[62:63], v8 offset:2304
    s_waitcnt lgkmcnt(6)
    v_mfma_f32_16x16x32_bf16 v[80:83], v[32:35], v[48:51], v[80:83]
    v_mov_b32 v11, 0
    v_dot2_f32_bf16 v11, v64, v72, v11
    v_mfma_f32_16x16x32_bf16 v[84:87], v[36:39], v[48:51], v[84:87]
    v_dot2_f32_bf16 v11, v65, v73, v11
    v_dot2_f32_bf16 v11, v66, v74, v11
    v_mfma_f32_16x16x32_bf16 v[88:91], v[40:43], v[48:51], v[88:91]
    v_dot2_f32_bf16 v11, v67, v75, v11
    v_dot2_f32_bf16 v11, v68, v76, v11
    v_mfma_f32_16x16x32_bf16 v[92:95], v[44:47], v[48:51], v[92:95]
    v_dot2_f32_bf16 v11, v69, v77, v11
    v_dot2_f32_bf16 v11, v70, v78, v11
    ds_read_b64_tr_b16 v[48:49], v8 offset:32
    ds_read_b64_tr_b16 v[50:51], v8 offset:2336
    s_waitcnt lgkmcnt(6)
    v_mfma_f32_16x16x32_bf16 v[96:99], v[32:35], v[52:55], v[96:99]
    v_dot2_f32_bf16 v11, v71, v79, v11
    s_nop 2
    v_add_f32_dpp v11, v11, v11 row_shr:1 row_mask:0xf bank_mask:0xf bound_ctrl:0
    v_mfma_f32_16x16x32_bf16 v[100:103], v[36:39], v[52:55], v[100:103]
    s_nop 0
    v_add_f32_dpp v11, v11, v11 row_shr:2 row_mask:0xf bank_mask:0xf bound_ctrl:0
    s_nop 1
    v_add_f32_dpp v11, v11, v11 row_shr:4 row_mask:0xf bank_mask:0xf bound_ctrl:0
    v_mfma_f32_16x16x32_bf16 v[104:107], v[40:43], v[52:55], v[104:107]
    s_nop 0
    v_add_f32_dpp v11, v11, v11 row_shr:8 row_mask:0xf bank_mask:0xf bound_ctrl:0
    s_nop 0
    v_readlane_b32 s78, v11, 15
    v_mfma_f32_16x16x32_bf16 v[108:111], v[44:47], v[52:55], v[108:111]
    v_readlane_b32 s79, v11, 31
    v_readlane_b32 s80, v11, 47
    ds_read_b64_tr_b16 v[52:53], v8 offset:9216
    ds_read_b64_tr_b16 v[54:55], v8 offset:11520
    s_waitcnt lgkmcnt(6)
    v_mfma_f32_16x16x32_bf16 v[112:115], v[32:35], v[56:59], v[112:115]
    v_mov_b32 v11, s78
    v_add_f32 v11, s79, v11
    v_mfma_f32_16x16x32_bf16 v[116:119], v[36:39], v[56:59], v[116:119]
    s_add_u32 m0, s64, s60
    s_nop 0
    buffer_load_dwordx4 v3, s[28:31], s52 offen lds
    s_add_u32 s52, s52, 64
    v_add_f32 v11, s80, v11
    v_cvt_pk_bf16_f32 v11, v11, v11
    v_mfma_f32_16x16x32_bf16 v[120:123], v[40:43], v[56:59], v[120:123]
    v_lshlrev_b32 v11, 16, v11
    v_mul_f32 v11, 0xbfb8aa3b, v11
    v_mfma_f32_16x16x32_bf16 v[124:127], v[44:47], v[56:59], v[124:127]
    v_exp_f32 v11, v11
    s_nop 0
    v_add_f32 v11, 1.0, v11
    ds_read_b64_tr_b16 v[56:57], v8 offset:9248
    ds_read_b64_tr_b16 v[58:59], v8 offset:11552
    s_waitcnt lgkmcnt(6)
    v_mfma_f32_16x16x32_bf16 v[128:131], v[60:63], v[32:35], v[128:131]
    v_rcp_f32 v11, v11
    s_nop 0
    v_cvt_pk_bf16_f32 v11, v11, v11
    v_mfma_f32_16x16x32_bf16 v[132:135], v[60:63], v[36:39], v[132:135]
    s_add_u32 m0, s64, s61
    s_nop 0
    buffer_load_dwordx4 v4, s[32:35], s53 offen lds
    s_add_u32 s53, s53, s56
    v_lshlrev_b32 v11, 16, v11
    v_sub_f32 v12, 1.0, v11
    v_mfma_f32_16x16x32_bf16 v[136:139], v[60:63], v[40:43], v[136:139]
    v_cvt_pk_bf16_f32 v12, v12, v12
    v_lshlrev_b32 v12, 16, v12
    v_mfma_f32_16x16x32_bf16 v[140:143], v[60:63], v[44:47], v[140:143]
    s_lshl_b32 s78, s70, 2
    s_add_u32 s78, s78, 22347776
    ds_read_b64_tr_b16 v[60:61], v8 offset:64
    ds_read_b64_tr_b16 v[62:63], v8 offset:2368
    s_waitcnt lgkmcnt(6)
    v_mfma_f32_16x16x32_bf16 v[144:147], v[48:51], v[32:35], v[144:147]
    s_add_u32 s79, s78, 8192
    v_mov_b32 v13, 0
    v_mfma_f32_16x16x32_bf16 v[148:151], v[48:51], v[36:39], v[148:151]
    s_add_u32 m0, s64, s62
    s_nop 0
    buffer_load_dwordx4 v5, s[36:39], s54 offen lds
    s_add_u32 s54, s54, s57
    s_mov_b64 exec, 1
    buffer_store_dword v11, v13, s[44:47], s78 offen sc1
    buffer_store_dword v12, v13, s[44:47], s79 offen sc1
    s_mov_b64 exec, -1
    v_mfma_f32_16x16x32_bf16 v[152:155], v[48:51], v[40:43], v[152:155]
    v_mfma_f32_16x16x32_bf16 v[156:159], v[48:51], v[44:47], v[156:159]
    ds_read_b64_tr_b16 v[48:49], v8 offset:96
    ds_read_b64_tr_b16 v[50:51], v8 offset:2400
    s_waitcnt lgkmcnt(6)
    v_mfma_f32_16x16x32_bf16 v[160:163], v[52:55], v[32:35], v[160:163]
    v_mfma_f32_16x16x32_bf16 v[164:167], v[52:55], v[36:39], v[164:167]
    s_add_u32 m0, s64, s63
    s_nop 0
    buffer_load_dwordx4 v6, s[40:43], s55 offen lds
    s_add_u32 s55, s55, s58
    s_add_u32 s64, s64, 39936
    s_cmp_eq_u32 s64, 159744
    s_cselect_b32 s64, 0, s64
    v_mfma_f32_16x16x32_bf16 v[168:171], v[52:55], v[40:43], v[168:171]
    v_mfma_f32_16x16x32_bf16 v[172:175], v[52:55], v[44:47], v[172:175]
    ds_read_b64_tr_b16 v[52:53], v8 offset:9280
    ds_read_b64_tr_b16 v[54:55], v8 offset:11584
    s_waitcnt lgkmcnt(6)
    v_mfma_f32_16x16x32_bf16 v[176:179], v[56:59], v[32:35], v[176:179]
    v_mfma_f32_16x16x32_bf16 v[180:183], v[56:59], v[36:39], v[180:183]
    v_mfma_f32_16x16x32_bf16 v[184:187], v[56:59], v[40:43], v[184:187]
    v_mfma_f32_16x16x32_bf16 v[188:191], v[56:59], v[44:47], v[188:191]
    ds_read_b64_tr_b16 v[56:57], v8 offset:9312
    ds_read_b64_tr_b16 v[58:59], v8 offset:11616
    s_waitcnt lgkmcnt(6)
    v_mfma_f32_16x16x32_bf16 v[192:195], v[60:63], v[32:35], v[192:195]
    v_mfma_f32_16x16x32_bf16 v[196:199], v[60:63], v[36:39], v[196:199]
    v_mfma_f32_16x16x32_bf16 v[200:203], v[60:63], v[40:43], v[200:203]
    v_mfma_f32_16x16x32_bf16 v[204:207], v[60:63], v[44:47], v[204:207]
    s_add_u32 s67, s67, 1
    s_and_b32 s67, s67, 3
    s_cmp_eq_u32 s67, 0
    s_mov_b32 s66, 39936
    s_cselect_b32 s66, -119808, s66
    v_add_u32 v7, s66, v7
    v_add_u32 v8, s66, v8
    v_add_u32 v9, s66, v9
    v_add_u32 v10, s66, v10
    s_waitcnt vmcnt(0)
    s_waitcnt lgkmcnt(0)
    s_barrier
    ds_read_b128 v[16:19], v7 offset:0
    ds_read_b128 v[20:23], v7 offset:1024
    v_mfma_f32_16x16x32_bf16 v[208:211], v[48:51], v[32:35], v[208:211]
    v_mfma_f32_16x16x32_bf16 v[212:215], v[48:51], v[36:39], v[212:215]
    v_mfma_f32_16x16x32_bf16 v[216:219], v[48:51], v[40:43], v[216:219]
    v_mfma_f32_16x16x32_bf16 v[220:223], v[48:51], v[44:47], v[220:223]
    ds_read_b64_tr_b16 v[48:49], v9 offset:48
    ds_read_b64_tr_b16 v[50:51], v9 offset:1328
    ds_read_b128 v[24:27], v7 offset:2048
    ds_read_b128 v[28:31], v7 offset:3072
    v_mfma_f32_16x16x32_bf16 v[224:227], v[52:55], v[32:35], v[224:227]
    v_mfma_f32_16x16x32_bf16 v[228:231], v[52:55], v[36:39], v[228:231]
    v_mfma_f32_16x16x32_bf16 v[232:235], v[52:55], v[40:43], v[232:235]
    v_mfma_f32_16x16x32_bf16 v[236:239], v[52:55], v[44:47], v[236:239]
    ds_read_b64_tr_b16 v[52:53], v9 offset:96
    ds_read_b64_tr_b16 v[54:55], v9 offset:1376
    v_mfma_f32_16x16x32_bf16 v[240:243], v[56:59], v[32:35], v[240:243]
    v_mfma_f32_16x16x32_bf16 v[244:247], v[56:59], v[36:39], v[244:247]
    s_add_u32 m0, s64, s59
    s_nop 0
    buffer_load_dwordx4 v2, s[28:31], s52 offen lds
    v_mfma_f32_16x16x32_bf16 v[248:251], v[56:59], v[40:43], v[248:251]
    v_mfma_f32_16x16x32_bf16 v[252:255], v[56:59], v[44:47], v[252:255]
    ds_read_b64_tr_b16 v[56:57], v10 offset:0
    ds_read_b64_tr_b16 v[58:59], v10 offset:1280
    s_mov_b32 s48, s16
    s_mov_b32 s49, s17
    s_mov_b32 s50, 256
    s_mov_b32 s51, 0x20000
    v_mov_b32 v11, 252
    buffer_load_dword v79, v11, s[48:51], 0 offen sc1
    v_add_u32 v68, 39936, v7
    v_add_u32 v70, 39936, v9
    v_add_u32 v71, 39936, v10
    ds_read_b128 v[32:35], v68 offset:0
    ds_read_b128 v[36:39], v68 offset:1024
    ds_read_b128 v[40:43], v68 offset:2048
    ds_read_b128 v[44:47], v68 offset:3072
    ds_read_b64_tr_b16 v[60:61], v70 offset:48
    ds_read_b64_tr_b16 v[62:63], v70 offset:1328
    s_waitcnt lgkmcnt(10)
    v_mfma_f32_16x16x32_bf16 v[80:83], v[16:19], v[48:51], v[80:83]
    v_mfma_f32_16x16x32_bf16 v[84:87], v[20:23], v[48:51], v[84:87]
    s_add_u32 m0, s64, s60
    s_nop 0
    buffer_load_dwordx4 v3, s[28:31], s52 offen lds
    s_add_u32 s52, s52, 64
    v_mfma_f32_16x16x32_bf16 v[88:91], v[24:27], v[48:51], v[88:91]
    v_mfma_f32_16x16x32_bf16 v[92:95], v[28:31], v[48:51], v[92:95]
    s_add_u32 m0, s64, s61
    s_nop 0
    buffer_load_dwordx4 v4, s[32:35], s53 offen lds
    s_add_u32 s53, s53, s56
    ds_read_b64_tr_b16 v[48:49], v70 offset:96
    ds_read_b64_tr_b16 v[50:51], v70 offset:1376
    s_waitcnt lgkmcnt(10)
    v_mfma_f32_16x16x32_bf16 v[96:99], v[16:19], v[52:55], v[96:99]
    v_mfma_f32_16x16x32_bf16 v[100:103], v[20:23], v[52:55], v[100:103]
    s_add_u32 m0, s64, s62
    s_nop 0
    buffer_load_dwordx4 v5, s[36:39], s54 offen lds
    s_add_u32 s54, s54, s57
    v_mfma_f32_16x16x32_bf16 v[104:107], v[24:27], v[52:55], v[104:107]
    v_mfma_f32_16x16x32_bf16 v[108:111], v[28:31], v[52:55], v[108:111]
    s_add_u32 m0, s64, s63
    s_nop 0
    buffer_load_dwordx4 v6, s[40:43], s55 offen lds
    s_add_u32 s55, s55, s58
    s_add_u32 s64, s64, 39936
    s_cmp_eq_u32 s64, 159744
    s_cselect_b32 s64, 0, s64
    ds_read_b64_tr_b16 v[52:53], v71 offset:0
    ds_read_b64_tr_b16 v[54:55], v71 offset:1280
    s_waitcnt lgkmcnt(10)
    v_mfma_f32_16x16x32_bf16 v[112:115], v[16:19], v[56:59], v[112:115]
    v_mfma_f32_16x16x32_bf16 v[116:119], v[20:23], v[56:59], v[116:119]
    s_add_u32 m0, s64, s59
    s_nop 0
    buffer_load_dwordx4 v2, s[28:31], s52 offen lds
    v_mfma_f32_16x16x32_bf16 v[120:123], v[24:27], v[56:59], v[120:123]
    v_mfma_f32_16x16x32_bf16 v[124:127], v[28:31], v[56:59], v[124:127]
    s_add_u32 m0, s64, s60
    s_nop 0
    buffer_load_dwordx4 v3, s[28:31], s52 offen lds
    s_add_u32 s52, s52, 64
    v_add_u32 v64, 0, v7
    v_add_u32 v65, 0, v8
    ds_read_b128 v[16:19], v64 offset:0
    ds_read_b128 v[20:23], v64 offset:1024
    ds_read_b128 v[24:27], v64 offset:2048
    ds_read_b128 v[28:31], v64 offset:3072
    ds_read_b64_tr_b16 v[56:57], v65 offset:0
    ds_read_b64_tr_b16 v[58:59], v65 offset:2304
    s_waitcnt lgkmcnt(10)
    v_mfma_f32_16x16x32_bf16 v[80:83], v[32:35], v[60:63], v[80:83]
    v_mfma_f32_16x16x32_bf16 v[84:87], v[36:39], v[60:63], v[84:87]
    s_add_u32 m0, s64, s61
    s_nop 0
    buffer_load_dwordx4 v4, s[32:35], s53 offen lds
    s_add_u32 s53, s53, s56
    v_mfma_f32_16x16x32_bf16 v[88:91], v[40:43], v[60:63], v[88:91]
    v_mfma_f32_16x16x32_bf16 v[92:95], v[44:47], v[60:63], v[92:95]
    s_add_u32 m0, s64, s62
    s_nop 0
    buffer_load_dwordx4 v5, s[36:39], s54 offen lds
    s_add_u32 s54, s54, s57
    ds_read_b64_tr_b16 v[60:61], v65 offset:32
    ds_read_b64_tr_b16 v[62:63], v65 offset:2336
    s_waitcnt lgkmcnt(10)
    v_mfma_f32_16x16x32_bf16 v[96:99], v[32:35], v[48:51], v[96:99]
    v_mfma_f32_16x16x32_bf16 v[100:103], v[36:39], v[48:51], v[100:103]
    s_add_u32 m0, s64, s63
    s_nop 0
    buffer_load_dwordx4 v6, s[40:43], s55 offen lds
    s_add_u32 s55, s55, s58
    s_add_u32 s64, s64, 39936
    s_cmp_eq_u32 s64, 159744
    s_cselect_b32 s64, 0, s64
    v_mfma_f32_16x16x32_bf16 v[104:107], v[40:43], v[48:51], v[104:107]
    v_mfma_f32_16x16x32_bf16 v[108:111], v[44:47], v[48:51], v[108:111]
    ds_read_b64_tr_b16 v[48:49], v65 offset:9216
    ds_read_b64_tr_b16 v[50:51], v65 offset:11520
    s_waitcnt lgkmcnt(10)
    v_mfma_f32_16x16x32_bf16 v[112:115], v[32:35], v[52:55], v[112:115]
    v_mfma_f32_16x16x32_bf16 v[116:119], v[36:39], v[52:55], v[116:119]
    v_mfma_f32_16x16x32_bf16 v[120:123], v[40:43], v[52:55], v[120:123]
    v_mfma_f32_16x16x32_bf16 v[124:127], v[44:47], v[52:55], v[124:127]
    ds_read_b64_tr_b16 v[52:53], v65 offset:9248
    ds_read_b64_tr_b16 v[54:55], v65 offset:11552
    s_waitcnt lgkmcnt(6)
    v_mfma_f32_16x16x32_bf16 v[128:131], v[56:59], v[16:19], v[128:131]
    v_mfma_f32_16x16x32_bf16 v[132:135], v[56:59], v[20:23], v[132:135]
    v_mfma_f32_16x16x32_bf16 v[136:139], v[56:59], v[24:27], v[136:139]
    v_mfma_f32_16x16x32_bf16 v[140:143], v[56:59], v[28:31], v[140:143]
    v_add_u32 v68, 39936, v7
    v_add_u32 v69, 39936, v8
    ds_read_b128 v[32:35], v68 offset:0
    ds_read_b128 v[36:39], v68 offset:1024
    ds_read_b128 v[40:43], v68 offset:2048
    ds_read_b128 v[44:47], v68 offset:3072
    ds_read_b64_tr_b16 v[56:57], v69 offset:0
    ds_read_b64_tr_b16 v[58:59], v69 offset:2304
    s_waitcnt lgkmcnt(10)
    v_mfma_f32_16x16x32_bf16 v[144:147], v[60:63], v[16:19], v[144:147]
    v_mfma_f32_16x16x32_bf16 v[148:151], v[60:63], v[20:23], v[148:151]
    v_mfma_f32_16x16x32_bf16 v[152:155], v[60:63], v[24:27], v[152:155]
    v_mfma_f32_16x16x32_bf16 v[156:159], v[60:63], v[28:31], v[156:159]
    ds_read_b64_tr_b16 v[60:61], v69 offset:32
    ds_read_b64_tr_b16 v[62:63], v69 offset:2336
    s_waitcnt lgkmcnt(10)
    v_mfma_f32_16x16x32_bf16 v[160:163], v[48:51], v[16:19], v[160:163]
    v_mfma_f32_16x16x32_bf16 v[164:167], v[48:51], v[20:23], v[164:167]
    v_mfma_f32_16x16x32_bf16 v[168:171], v[48:51], v[24:27], v[168:171]
    v_mfma_f32_16x16x32_bf16 v[172:175], v[48:51], v[28:31], v[172:175]
    ds_read_b64_tr_b16 v[48:49], v69 offset:9216
    ds_read_b64_tr_b16 v[50:51], v69 offset:11520
    s_waitcnt lgkmcnt(10)
    v_mfma_f32_16x16x32_bf16 v[176:179], v[52:55], v[16:19], v[176:179]
    v_mfma_f32_16x16x32_bf16 v[180:183], v[52:55], v[20:23], v[180:183]
    v_mfma_f32_16x16x32_bf16 v[184:187], v[52:55], v[24:27], v[184:187]
    v_mfma_f32_16x16x32_bf16 v[188:191], v[52:55], v[28:31], v[188:191]
    ds_read_b64_tr_b16 v[52:53], v69 offset:9248
    ds_read_b64_tr_b16 v[54:55], v69 offset:11552
    s_waitcnt lgkmcnt(6)
    v_mfma_f32_16x16x32_bf16 v[128:131], v[56:59], v[32:35], v[128:131]
    v_mfma_f32_16x16x32_bf16 v[132:135], v[56:59], v[36:39], v[132:135]
    v_mfma_f32_16x16x32_bf16 v[136:139], v[56:59], v[40:43], v[136:139]
    v_mfma_f32_16x16x32_bf16 v[140:143], v[56:59], v[44:47], v[140:143]
    s_waitcnt vmcnt(0)
    v_readfirstlane_b32 s3, v79
    s_barrier
    v_add_u32 v64, -79872, v7
    v_add_u32 v66, -79872, v9
    v_add_u32 v67, -79872, v10
    ds_read_b128 v[16:19], v64 offset:0
    ds_read_b128 v[20:23], v64 offset:1024
    ds_read_b128 v[24:27], v64 offset:2048
    ds_read_b128 v[28:31], v64 offset:3072
    ds_read_b64_tr_b16 v[56:57], v66 offset:48
    ds_read_b64_tr_b16 v[58:59], v66 offset:1328
    s_waitcnt lgkmcnt(10)
    v_mfma_f32_16x16x32_bf16 v[144:147], v[60:63], v[32:35], v[144:147]
    v_mfma_f32_16x16x32_bf16 v[148:151], v[60:63], v[36:39], v[148:151]
    v_mfma_f32_16x16x32_bf16 v[152:155], v[60:63], v[40:43], v[152:155]
    v_mfma_f32_16x16x32_bf16 v[156:159], v[60:63], v[44:47], v[156:159]
    ds_read_b64_tr_b16 v[60:61], v66 offset:96
    ds_read_b64_tr_b16 v[62:63], v66 offset:1376
    s_waitcnt lgkmcnt(10)
    v_mfma_f32_16x16x32_bf16 v[160:163], v[48:51], v[32:35], v[160:163]
    v_mfma_f32_16x16x32_bf16 v[164:167], v[48:51], v[36:39], v[164:167]
    v_mfma_f32_16x16x32_bf16 v[168:171], v[48:51], v[40:43], v[168:171]
    v_mfma_f32_16x16x32_bf16 v[172:175], v[48:51], v[44:47], v[172:175]
    ds_read_b64_tr_b16 v[48:49], v67 offset:0
    ds_read_b64_tr_b16 v[50:51], v67 offset:1280
    s_waitcnt lgkmcnt(10)
    v_mfma_f32_16x16x32_bf16 v[176:179], v[52:55], v[32:35], v[176:179]
    v_mfma_f32_16x16x32_bf16 v[180:183], v[52:55], v[36:39], v[180:183]
    v_mfma_f32_16x16x32_bf16 v[184:187], v[52:55], v[40:43], v[184:187]
    v_mfma_f32_16x16x32_bf16 v[188:191], v[52:55], v[44:47], v[188:191]
    v_add_u32 v68, -39936, v7
    v_add_u32 v70, -39936, v9
    v_add_u32 v71, -39936, v10
    ds_read_b128 v[32:35], v68 offset:0
    ds_read_b128 v[36:39], v68 offset:1024
    ds_read_b128 v[40:43], v68 offset:2048
    ds_read_b128 v[44:47], v68 offset:3072
    ds_read_b64_tr_b16 v[52:53], v70 offset:48
    ds_read_b64_tr_b16 v[54:55], v70 offset:1328
    s_waitcnt lgkmcnt(10)
    v_mfma_f32_16x16x32_bf16 v[80:83], v[16:19], v[56:59], v[80:83]
    v_mfma_f32_16x16x32_bf16 v[84:87], v[20:23], v[56:59], v[84:87]
    v_mfma_f32_16x16x32_bf16 v[88:91], v[24:27], v[56:59], v[88:91]
    v_mfma_f32_16x16x32_bf16 v[92:95], v[28:31], v[56:59], v[92:95]
    ds_read_b64_tr_b16 v[56:57], v70 offset:96
    ds_read_b64_tr_b16 v[58:59], v70 offset:1376
    s_waitcnt lgkmcnt(10)
    v_mfma_f32_16x16x32_bf16 v[96:99], v[16:19], v[60:63], v[96:99]
    v_mfma_f32_16x16x32_bf16 v[100:103], v[20:23], v[60:63], v[100:103]
    v_mfma_f32_16x16x32_bf16 v[104:107], v[24:27], v[60:63], v[104:107]
    v_mfma_f32_16x16x32_bf16 v[108:111], v[28:31], v[60:63], v[108:111]
    ds_read_b64_tr_b16 v[60:61], v71 offset:0
    ds_read_b64_tr_b16 v[62:63], v71 offset:1280
    s_waitcnt lgkmcnt(10)
    v_mfma_f32_16x16x32_bf16 v[112:115], v[16:19], v[48:51], v[112:115]
    v_mfma_f32_16x16x32_bf16 v[116:119], v[20:23], v[48:51], v[116:119]
    v_mfma_f32_16x16x32_bf16 v[120:123], v[24:27], v[48:51], v[120:123]
    v_mfma_f32_16x16x32_bf16 v[124:127], v[28:31], v[48:51], v[124:127]
    v_add_u32 v64, -79872, v7
    v_add_u32 v65, -79872, v8
    ds_read_b128 v[16:19], v64 offset:0
    ds_read_b128 v[20:23], v64 offset:1024
    ds_read_b128 v[24:27], v64 offset:2048
    ds_read_b128 v[28:31], v64 offset:3072
    ds_read_b64_tr_b16 v[48:49], v65 offset:0
    ds_read_b64_tr_b16 v[50:51], v65 offset:2304
    s_waitcnt lgkmcnt(10)
    v_mfma_f32_16x16x32_bf16 v[80:83], v[32:35], v[52:55], v[80:83]
    v_mfma_f32_16x16x32_bf16 v[84:87], v[36:39], v[52:55], v[84:87]
    v_mfma_f32_16x16x32_bf16 v[88:91], v[40:43], v[52:55], v[88:91]
    v_mfma_f32_16x16x32_bf16 v[92:95], v[44:47], v[52:55], v[92:95]
    ds_read_b64_tr_b16 v[52:53], v65 offset:32
    ds_read_b64_tr_b16 v[54:55], v65 offset:2336
    s_waitcnt lgkmcnt(10)
    v_mfma_f32_16x16x32_bf16 v[96:99], v[32:35], v[56:59], v[96:99]
    v_mfma_f32_16x16x32_bf16 v[100:103], v[36:39], v[56:59], v[100:103]
    v_mfma_f32_16x16x32_bf16 v[104:107], v[40:43], v[56:59], v[104:107]
    v_mfma_f32_16x16x32_bf16 v[108:111], v[44:47], v[56:59], v[108:111]
    ds_read_b64_tr_b16 v[56:57], v65 offset:9216
    ds_read_b64_tr_b16 v[58:59], v65 offset:11520
    s_waitcnt lgkmcnt(10)
    v_mfma_f32_16x16x32_bf16 v[112:115], v[32:35], v[60:63], v[112:115]
    v_mfma_f32_16x16x32_bf16 v[116:119], v[36:39], v[60:63], v[116:119]
    v_mfma_f32_16x16x32_bf16 v[120:123], v[40:43], v[60:63], v[120:123]
    v_mfma_f32_16x16x32_bf16 v[124:127], v[44:47], v[60:63], v[124:127]
    ds_read_b64_tr_b16 v[60:61], v65 offset:9248
    ds_read_b64_tr_b16 v[62:63], v65 offset:11552
    s_waitcnt lgkmcnt(6)
    v_mfma_f32_16x16x32_bf16 v[128:131], v[48:51], v[16:19], v[128:131]
    s_lshl_b32 s72, s20, 4
    s_lshl_b32 s73, s23, 2
    s_add_u32 s72, s72, s73
    v_lshlrev_b32 v14, 4, v1
    v_lshlrev_b32 v15, 3, v1
    v_mfma_f32_16x16x32_bf16 v[132:135], v[48:51], v[20:23], v[132:135]
    s_mul_i32 s73, s21, 9
    s_add_u32 s74, s73, s68
    s_lshr_b32 s74, s74, 1
    s_mul_i32 s75, s72, 144
    s_add_u32 s74, s74, s75
    v_mfma_f32_16x16x32_bf16 v[136:139], v[48:51], v[24:27], v[136:139]
    s_lshl_b32 s74, s74, 10
    s_add_u32 s76, s73, s69
    s_and_b32 s77, s76, 1
    s_lshr_b32 s76, s76, 1
    s_add_u32 s76, s76, s75
    v_mfma_f32_16x16x32_bf16 v[140:143], v[48:51], v[28:31], v[140:143]
    s_lshl_b32 s76, s76, 10
    s_lshl_b32 s77, s77, 3
    s_add_u32 s76, s76, s77
    s_mov_b32 s78, 0xbdd2d3e8
    s_mov_b32 s79, 0xbdd2d3e8
    v_add_u32 v68, -39936, v7
    v_add_u32 v69, -39936, v8
    ds_read_b128 v[32:35], v68 offset:0
    ds_read_b128 v[36:39], v68 offset:1024
    ds_read_b128 v[40:43], v68 offset:2048
    ds_read_b128 v[44:47], v68 offset:3072
    ds_read_b64_tr_b16 v[48:49], v69 offset:0
    ds_read_b64_tr_b16 v[50:51], v69 offset:2304
    s_waitcnt lgkmcnt(10)
    v_mfma_f32_16x16x32_bf16 v[144:147], v[52:55], v[16:19], v[144:147]
    s_mov_b32 s80, 0xc0135761
    v_mov_b32 v0, s80
    v_and_b32 v11, 3, v1
    v_cmp_eq_u32 s[86:87], 2, v11
    v_mov_b32 v6, 0x3f803f80
    v_mfma_f32_16x16x32_bf16 v[148:151], v[52:55], v[20:23], v[148:151]
    v_min_f32 v11, 0, v82
    v_min_f32 v12, 0, v83
    v_mul_f32 v11, s84, v11
    v_mul_f32 v12, s84, v12
    v_exp_f32 v11, v11
    v_mfma_f32_16x16x32_bf16 v[152:155], v[52:55], v[24:27], v[152:155]
    v_exp_f32 v12, v12
    v_max_f32 v82, 0, v82
    v_max_f32 v83, 0, v83
    v_add_f32 v82, v11, v82
    v_add_f32 v83, v12, v83
    v_mfma_f32_16x16x32_bf16 v[156:159], v[52:55], v[28:31], v[156:159]
    v_add_f32 v82, s85, v82
    v_add_f32 v83, s85, v83
    v_cvt_pk_bf16_f32 v83, v82, v83
    v_min_f32 v11, 0, v80
    v_min_f32 v12, 0, v81
    ds_read_b64_tr_b16 v[52:53], v69 offset:32
    ds_read_b64_tr_b16 v[54:55], v69 offset:2336
    s_waitcnt lgkmcnt(10)
    v_mfma_f32_16x16x32_bf16 v[160:163], v[56:59], v[16:19], v[160:163]
    v_mul_f32 v11, s84, v11
    v_mul_f32 v12, s84, v12
    v_exp_f32 v11, v11
    v_exp_f32 v12, v12
    v_max_f32 v80, 0, v80
    v_mfma_f32_16x16x32_bf16 v[164:167], v[56:59], v[20:23], v[164:167]
    v_max_f32 v81, 0, v81
    v_add_f32 v80, v11, v80
    v_add_f32 v81, v12, v81
    v_add_f32 v80, s85, v80
    v_add_f32 v81, s85, v81
    v_mfma_f32_16x16x32_bf16 v[168:171], v[56:59], v[24:27], v[168:171]
    v_cvt_pk_bf16_f32 v82, v80, v81
    v_cvt_pk_bf16_f32 v99, v98, v99
    v_cvt_pk_bf16_f32 v98, v96, v97
    v_min_f32 v11, 0, v84
    v_min_f32 v12, 0, v85
    v_mfma_f32_16x16x32_bf16 v[172:175], v[56:59], v[28:31], v[172:175]
    v_mul_f32 v11, s84, v11
    v_mul_f32 v12, s84, v12
    v_exp_f32 v11, v11
    v_exp_f32 v12, v12
    v_max_f32 v84, 0, v84
    ds_read_b64_tr_b16 v[56:57], v69 offset:9216
    ds_read_b64_tr_b16 v[58:59], v69 offset:11520
    s_waitcnt lgkmcnt(10)
    v_mfma_f32_16x16x32_bf16 v[176:179], v[60:63], v[16:19], v[176:179]
    v_max_f32 v85, 0, v85
    v_add_f32 v84, v11, v84
    v_add_f32 v85, v12, v85
    v_add_f32 v84, s85, v84
    v_add_f32 v85, s85, v85
    v_mfma_f32_16x16x32_bf16 v[180:183], v[60:63], v[20:23], v[180:183]
    v_cvt_pk_bf16_f32 v84, v84, v85
    v_min_f32 v11, 0, v86
    v_min_f32 v12, 0, v87
    v_mul_f32 v11, s84, v11
    v_mul_f32 v12, s84, v12
    v_mfma_f32_16x16x32_bf16 v[184:187], v[60:63], v[24:27], v[184:187]
    v_exp_f32 v11, v11
    v_exp_f32 v12, v12
    v_max_f32 v86, 0, v86
    v_max_f32 v87, 0, v87
    v_add_f32 v86, v11, v86
    v_mfma_f32_16x16x32_bf16 v[188:191], v[60:63], v[28:31], v[188:191]
    v_add_f32 v87, v12, v87
    v_add_f32 v86, s85, v86
    v_add_f32 v87, s85, v87
    v_cvt_pk_bf16_f32 v85, v86, v87
    v_cvt_pk_bf16_f32 v100, v100, v101
    ds_read_b64_tr_b16 v[60:61], v69 offset:9248
    ds_read_b64_tr_b16 v[62:63], v69 offset:11552
    s_waitcnt lgkmcnt(6)
    v_mfma_f32_16x16x32_bf16 v[128:131], v[48:51], v[32:35], v[128:131]
    v_cvt_pk_bf16_f32 v101, v102, v103
    v_min_f32 v11, 0, v90
    v_min_f32 v12, 0, v91
    v_mul_f32 v11, s84, v11
    v_mul_f32 v12, s84, v12
    v_mfma_f32_16x16x32_bf16 v[132:135], v[48:51], v[36:39], v[132:135]
    v_exp_f32 v11, v11
    v_exp_f32 v12, v12
    v_max_f32 v90, 0, v90
    v_max_f32 v91, 0, v91
    v_add_f32 v90, v11, v90
    v_mfma_f32_16x16x32_bf16 v[136:139], v[48:51], v[40:43], v[136:139]
    v_add_f32 v91, v12, v91
    v_add_f32 v90, s85, v90
    v_add_f32 v91, s85, v91
    v_cvt_pk_bf16_f32 v91, v90, v91
    v_min_f32 v11, 0, v88
    v_mfma_f32_16x16x32_bf16 v[140:143], v[48:51], v[44:47], v[140:143]
    v_min_f32 v12, 0, v89
    v_mul_f32 v11, s84, v11
    v_mul_f32 v12, s84, v12
    v_exp_f32 v11, v11
    v_exp_f32 v12, v12
    v_add_u32 v64, 0, v7
    v_add_u32 v65, 0, v8
    ds_read_b128 v[16:19], v64 offset:0
    ds_read_b128 v[20:23], v64 offset:1024
    ds_read_b128 v[24:27], v64 offset:2048
    ds_read_b128 v[28:31], v64 offset:3072
    ds_read_b64_tr_b16 v[48:49], v65 offset:64
    ds_read_b64_tr_b16 v[50:51], v65 offset:2368
    s_waitcnt lgkmcnt(10)
    v_mfma_f32_16x16x32_bf16 v[144:147], v[52:55], v[32:35], v[144:147]
    v_max_f32 v88, 0, v88
    v_max_f32 v89, 0, v89
    v_add_f32 v88, v11, v88
    v_add_f32 v89, v12, v89
    v_add_f32 v88, s85, v88
    v_mfma_f32_16x16x32_bf16 v[148:151], v[52:55], v[36:39], v[148:151]
    v_add_f32 v89, s85, v89
    v_cvt_pk_bf16_f32 v90, v88, v89
    v_cvt_pk_bf16_f32 v107, v106, v107
    v_cvt_pk_bf16_f32 v106, v104, v105
    v_min_f32 v11, 0, v92
    v_mfma_f32_16x16x32_bf16 v[152:155], v[52:55], v[40:43], v[152:155]
    v_min_f32 v12, 0, v93
    v_mul_f32 v11, s84, v11
    v_mul_f32 v12, s84, v12
    v_exp_f32 v11, v11
    v_exp_f32 v12, v12
    v_mfma_f32_16x16x32_bf16 v[156:159], v[52:55], v[44:47], v[156:159]
    v_max_f32 v92, 0, v92
    v_max_f32 v93, 0, v93
    v_add_f32 v92, v11, v92
    v_add_f32 v93, v12, v93
    v_add_f32 v92, s85, v92
    ds_read_b64_tr_b16 v[52:53], v65 offset:96
    ds_read_b64_tr_b16 v[54:55], v65 offset:2400
    s_waitcnt lgkmcnt(10)
    v_mfma_f32_16x16x32_bf16 v[160:163], v[56:59], v[32:35], v[160:163]
    v_add_f32 v93, s85, v93
    v_cvt_pk_bf16_f32 v92, v92, v93
    v_min_f32 v11, 0, v94
    v_min_f32 v12, 0, v95
    v_mul_f32 v11, s84, v11
    v_mfma_f32_16x16x32_bf16 v[164:167], v[56:59], v[36:39], v[164:167]
    v_mul_f32 v12, s84, v12
    v_exp_f32 v11, v11
    v_exp_f32 v12, v12
    v_max_f32 v94, 0, v94
    v_max_f32 v95, 0, v95
    v_mfma_f32_16x16x32_bf16 v[168:171], v[56:59], v[40:43], v[168:171]
    v_add_f32 v94, v11, v94
    v_add_f32 v95, v12, v95
    v_add_f32 v94, s85, v94
    v_add_f32 v95, s85, v95
    v_cvt_pk_bf16_f32 v93, v94, v95
    v_mfma_f32_16x16x32_bf16 v[172:175], v[56:59], v[44:47], v[172:175]
    v_cvt_pk_bf16_f32 v108, v108, v109
    v_cvt_pk_bf16_f32 v109, v110, v111
    v_cvt_pk_bf16_f32 v86, v112, v113
    v_cvt_pk_bf16_f32 v87, v114, v115
    v_cndmask_b32 v86, v86, v6, s[86:87]
    ds_read_b64_tr_b16 v[56:57], v65 offset:9280
    ds_read_b64_tr_b16 v[58:59], v65 offset:11584
    s_waitcnt lgkmcnt(10)
    v_mfma_f32_16x16x32_bf16 v[176:179], v[60:63], v[32:35], v[176:179]
    v_cndmask_b32 v87, v87, v6, s[86:87]
    v_min_f32 v11, 0, v114
    v_min_f32 v12, 0, v115
    v_mul_f32 v11, s84, v11
    v_mul_f32 v12, s84, v12
    v_mfma_f32_16x16x32_bf16 v[180:183], v[60:63], v[36:39], v[180:183]
    v_exp_f32 v11, v11
    v_exp_f32 v12, v12
    v_max_f32 v114, 0, v114
    v_max_f32 v115, 0, v115
    v_add_f32 v114, v11, v114
    v_mfma_f32_16x16x32_bf16 v[184:187], v[60:63], v[40:43], v[184:187]
    v_add_f32 v115, v12, v115
    v_add_f32 v114, s85, v114
    v_add_f32 v115, s85, v115
    v_cvt_pk_bf16_f32 v115, v114, v115
    v_min_f32 v11, 0, v112
    v_mfma_f32_16x16x32_bf16 v[188:191], v[60:63], v[44:47], v[188:191]
    v_min_f32 v12, 0, v113
    v_mul_f32 v11, s84, v11
    v_mul_f32 v12, s84, v12
    v_exp_f32 v11, v11
    v_exp_f32 v12, v12
    ds_read_b64_tr_b16 v[60:61], v65 offset:9312
    ds_read_b64_tr_b16 v[62:63], v65 offset:11616
    s_waitcnt lgkmcnt(6)
    v_mfma_f32_16x16x32_bf16 v[192:195], v[48:51], v[16:19], v[192:195]
    v_max_f32 v112, 0, v112
    v_max_f32 v113, 0, v113
    v_add_f32 v112, v11, v112
    v_add_f32 v113, v12, v113
    v_add_f32 v112, s85, v112
    v_mfma_f32_16x16x32_bf16 v[196:199], v[48:51], v[20:23], v[196:199]
    v_add_f32 v113, s85, v113
    v_cvt_pk_bf16_f32 v114, v112, v113
    v_cvt_pk_bf16_f32 v88, v116, v117
    v_cvt_pk_bf16_f32 v89, v118, v119
    v_cndmask_b32 v88, v88, v6, s[86:87]
    v_mfma_f32_16x16x32_bf16 v[200:203], v[48:51], v[24:27], v[200:203]
    v_cndmask_b32 v89, v89, v6, s[86:87]
    v_min_f32 v11, 0, v116
    v_min_f32 v12, 0, v117
    v_mul_f32 v11, s84, v11
    v_mul_f32 v12, s84, v12
    v_mfma_f32_16x16x32_bf16 v[204:207], v[48:51], v[28:31], v[204:207]
    v_exp_f32 v11, v11
    v_exp_f32 v12, v12
    v_max_f32 v116, 0, v116
    v_max_f32 v117, 0, v117
    v_add_f32 v116, v11, v116
    v_add_u32 v68, 39936, v7
    v_add_u32 v69, 39936, v8
    ds_read_b128 v[32:35], v68 offset:0
    ds_read_b128 v[36:39], v68 offset:1024
    ds_read_b128 v[40:43], v68 offset:2048
    ds_read_b128 v[44:47], v68 offset:3072
    ds_read_b64_tr_b16 v[48:49], v69 offset:64
    ds_read_b64_tr_b16 v[50:51], v69 offset:2368
    s_waitcnt lgkmcnt(10)
    v_mfma_f32_16x16x32_bf16 v[208:211], v[52:55], v[16:19], v[208:211]
    v_add_f32 v117, v12, v117
    v_add_f32 v116, s85, v116
    v_add_f32 v117, s85, v117
    v_cvt_pk_bf16_f32 v116, v116, v117
    v_min_f32 v11, 0, v118
    v_mfma_f32_16x16x32_bf16 v[212:215], v[52:55], v[20:23], v[212:215]
    v_min_f32 v12, 0, v119
    v_mul_f32 v11, s84, v11
    v_mul_f32 v12, s84, v12
    v_exp_f32 v11, v11
    v_exp_f32 v12, v12
    v_mfma_f32_16x16x32_bf16 v[216:219], v[52:55], v[24:27], v[216:219]
    v_max_f32 v118, 0, v118
    v_max_f32 v119, 0, v119
    v_add_f32 v118, v11, v118
    v_add_f32 v119, v12, v119
    v_add_f32 v118, s85, v118
    v_mfma_f32_16x16x32_bf16 v[220:223], v[52:55], v[28:31], v[220:223]
    v_add_f32 v119, s85, v119
    v_cvt_pk_bf16_f32 v117, v118, v119
    v_cvt_pk_bf16_f32 v102, v120, v121
    v_cvt_pk_bf16_f32 v103, v122, v123
    v_cndmask_b32 v102, v102, v6, s[86:87]
    ds_read_b64_tr_b16 v[52:53], v69 offset:96
    ds_read_b64_tr_b16 v[54:55], v69 offset:2400
    s_waitcnt lgkmcnt(10)
    v_mfma_f32_16x16x32_bf16 v[224:227], v[56:59], v[16:19], v[224:227]
    v_cndmask_b32 v103, v103, v6, s[86:87]
    v_min_f32 v11, 0, v122
    v_min_f32 v12, 0, v123
    v_mul_f32 v11, s84, v11
    v_mul_f32 v12, s84, v12
    v_mfma_f32_16x16x32_bf16 v[228:231], v[56:59], v[20:23], v[228:231]
    v_exp_f32 v11, v11
    v_exp_f32 v12, v12
    v_max_f32 v122, 0, v122
    v_max_f32 v123, 0, v123
    v_add_f32 v122, v11, v122
    v_mfma_f32_16x16x32_bf16 v[232:235], v[56:59], v[24:27], v[232:235]
    v_add_f32 v123, v12, v123
    v_add_f32 v122, s85, v122
    v_add_f32 v123, s85, v123
    v_cvt_pk_bf16_f32 v123, v122, v123
    v_min_f32 v11, 0, v120
    v_mfma_f32_16x16x32_bf16 v[236:239], v[56:59], v[28:31], v[236:239]
    v_min_f32 v12, 0, v121
    v_mul_f32 v11, s84, v11
    v_mul_f32 v12, s84, v12
    v_exp_f32 v11, v11
    v_exp_f32 v12, v12
    ds_read_b64_tr_b16 v[56:57], v69 offset:9280
    ds_read_b64_tr_b16 v[58:59], v69 offset:11584
    s_waitcnt lgkmcnt(10)
    v_mfma_f32_16x16x32_bf16 v[240:243], v[60:63], v[16:19], v[240:243]
    v_max_f32 v120, 0, v120
    v_max_f32 v121, 0, v121
    v_add_f32 v120, v11, v120
    v_add_f32 v121, v12, v121
    v_add_f32 v120, s85, v120
    v_mfma_f32_16x16x32_bf16 v[244:247], v[60:63], v[20:23], v[244:247]
    v_add_f32 v121, s85, v121
    v_cvt_pk_bf16_f32 v122, v120, v121
    v_cvt_pk_bf16_f32 v104, v124, v125
    v_cvt_pk_bf16_f32 v105, v126, v127
    v_cndmask_b32 v104, v104, v6, s[86:87]
    v_mfma_f32_16x16x32_bf16 v[248:251], v[60:63], v[24:27], v[248:251]
    v_cndmask_b32 v105, v105, v6, s[86:87]
    v_min_f32 v11, 0, v124
    v_min_f32 v12, 0, v125
    v_mul_f32 v11, s84, v11
    v_mul_f32 v12, s84, v12
    v_mfma_f32_16x16x32_bf16 v[252:255], v[60:63], v[28:31], v[252:255]
    v_exp_f32 v11, v11
    v_exp_f32 v12, v12
    v_max_f32 v124, 0, v124
    v_max_f32 v125, 0, v125
    v_add_f32 v124, v11, v124
    ds_read_b64_tr_b16 v[60:61], v69 offset:9312
    ds_read_b64_tr_b16 v[62:63], v69 offset:11616
    s_waitcnt lgkmcnt(6)
    v_mfma_f32_16x16x32_bf16 v[192:195], v[48:51], v[32:35], v[192:195]
    v_add_f32 v125, v12, v125
    v_add_f32 v124, s85, v124
    v_add_f32 v125, s85, v125
    v_cvt_pk_bf16_f32 v124, v124, v125
    v_min_f32 v11, 0, v126
    v_mfma_f32_16x16x32_bf16 v[196:199], v[48:51], v[36:39], v[196:199]
    v_min_f32 v12, 0, v127
    v_mul_f32 v11, s84, v11
    v_mul_f32 v12, s84, v12
    v_exp_f32 v11, v11
    v_exp_f32 v12, v12
    v_mfma_f32_16x16x32_bf16 v[200:203], v[48:51], v[40:43], v[200:203]
    v_max_f32 v126, 0, v126
    v_max_f32 v127, 0, v127
    v_add_f32 v126, v11, v126
    v_add_f32 v127, v12, v127
    v_add_f32 v126, s85, v126
    v_mfma_f32_16x16x32_bf16 v[204:207], v[48:51], v[44:47], v[204:207]
    v_add_f32 v127, s85, v127
    v_cvt_pk_bf16_f32 v125, v126, v127
    v_mfma_f32_16x16x32_bf16 v[72:75], v[82:85], v[98:101], 0
    v_mfma_f32_16x16x32_bf16 v[76:79], v[82:85], v[86:89], 0
    v_mfma_f32_16x16x32_bf16 v[2:5], v[114:117], v[86:89], 0
    v_add_u32 v64, -79872, v7
    v_add_u32 v65, -79872, v8
    ds_read_b128 v[16:19], v64 offset:0
    ds_read_b128 v[20:23], v64 offset:1024
    ds_read_b128 v[24:27], v64 offset:2048
    ds_read_b128 v[28:31], v64 offset:3072
    ds_read_b64_tr_b16 v[48:49], v65 offset:64
    ds_read_b64_tr_b16 v[50:51], v65 offset:2368
    s_waitcnt lgkmcnt(10)
    v_mfma_f32_16x16x32_bf16 v[208:211], v[52:55], v[32:35], v[208:211]
    v_mfma_f32_16x16x32_bf16 v[72:75], v[90:93], v[106:109], v[72:75]
    v_mfma_f32_16x16x32_bf16 v[76:79], v[90:93], v[102:105], v[76:79]
    v_mfma_f32_16x16x32_bf16 v[2:5], v[122:125], v[102:105], v[2:5]
    v_mfma_f32_16x16x32_bf16 v[118:121], v[114:117], v[98:101], 0
    v_mfma_f32_16x16x32_bf16 v[118:121], v[122:125], v[106:109], v[118:121]
    v_mfma_f32_16x16x32_bf16 v[212:215], v[52:55], v[36:39], v[212:215]
    s_lshl_b32 s73, s21, 11
    s_lshl_b32 s75, s72, 4
    s_add_u32 s73, s73, s75
    s_lshl_b32 s73, s73, 2
    s_add_u32 s73, s73, 20971520
    v_mfma_f32_16x16x32_bf16 v[216:219], v[52:55], v[40:43], v[216:219]
    v_lshrrev_b32 v6, 4, v1
    v_lshlrev_b32 v6, 4, v6
    s_mov_b32 s82, 0x05040100
    s_mov_b32 s83, 0x07060302
    s_mov_b32 s86, 0x01000100
    v_mfma_f32_16x16x32_bf16 v[220:223], v[52:55], v[44:47], v[220:223]
    s_mov_b32 s87, 0x01000100
    v_mov_b32_dpp v11, v114 quad_perm:[1,0,3,2] row_mask:0xf bank_mask:0xf
    v_mov_b32_dpp v12, v115 quad_perm:[1,0,3,2] row_mask:0xf bank_mask:0xf
    v_perm_b32 v94, v11, v114, s82
    v_perm_b32 v95, v11, v114, s83
    ds_read_b64_tr_b16 v[52:53], v65 offset:96
    ds_read_b64_tr_b16 v[54:55], v65 offset:2400
    s_waitcnt lgkmcnt(10)
    v_mfma_f32_16x16x32_bf16 v[224:227], v[56:59], v[32:35], v[224:227]
    v_perm_b32 v96, v12, v115, s82
    v_perm_b32 v97, v12, v115, s83
    s_mov_b64 exec, s[86:87]
    buffer_store_dwordx4 v[94:97], v6, s[44:47], s73 offen offset:0 sc1
    s_mov_b64 exec, -1
    v_mov_b32_dpp v11, v116 quad_perm:[1,0,3,2] row_mask:0xf bank_mask:0xf
    v_mov_b32_dpp v12, v117 quad_perm:[1,0,3,2] row_mask:0xf bank_mask:0xf
    v_mfma_f32_16x16x32_bf16 v[228:231], v[56:59], v[36:39], v[228:231]
    v_perm_b32 v94, v11, v116, s82
    v_perm_b32 v95, v11, v116, s83
    v_perm_b32 v96, v12, v117, s82
    v_perm_b32 v97, v12, v117, s83
    s_mov_b64 exec, s[86:87]
    buffer_store_dwordx4 v[94:97], v6, s[44:47], s73 offen offset:64 sc1
    s_mov_b64 exec, -1
    v_mfma_f32_16x16x32_bf16 v[232:235], v[56:59], v[40:43], v[232:235]
    v_mov_b32_dpp v11, v122 quad_perm:[1,0,3,2] row_mask:0xf bank_mask:0xf
    v_mov_b32_dpp v12, v123 quad_perm:[1,0,3,2] row_mask:0xf bank_mask:0xf
    v_perm_b32 v94, v11, v122, s82
    v_perm_b32 v95, v11, v122, s83
    v_perm_b32 v96, v12, v123, s82
    v_mfma_f32_16x16x32_bf16 v[236:239], v[56:59], v[44:47], v[236:239]
    v_perm_b32 v97, v12, v123, s83
    s_mov_b64 exec, s[86:87]
    buffer_store_dwordx4 v[94:97], v6, s[44:47], s73 offen offset:128 sc1
    s_mov_b64 exec, -1
    v_mov_b32_dpp v11, v124 quad_perm:[1,0,3,2] row_mask:0xf bank_mask:0xf
    v_mov_b32_dpp v12, v125 quad_perm:[1,0,3,2] row_mask:0xf bank_mask:0xf
    v_perm_b32 v94, v11, v124, s82
    ds_read_b64_tr_b16 v[56:57], v65 offset:9280
    ds_read_b64_tr_b16 v[58:59], v65 offset:11584
    s_waitcnt lgkmcnt(10)
    v_mfma_f32_16x16x32_bf16 v[240:243], v[60:63], v[32:35], v[240:243]
    v_perm_b32 v95, v11, v124, s83
    v_perm_b32 v96, v12, v125, s82
    v_perm_b32 v97, v12, v125, s83
    s_mov_b64 exec, s[86:87]
    buffer_store_dwordx4 v[94:97], v6, s[44:47], s73 offen offset:192 sc1
    s_mov_b64 exec, -1
    v_mov_b32 v120, v2
    v_mov_b32 v121, v3
    s_mov_b32 s73, 114688
    s_cmp_eq_u32 s23, 1
    s_cselect_b32 s73, 154624, s73
    s_cmp_eq_u32 s23, 2
    s_cselect_b32 s73, 34816, s73
    s_cmp_eq_u32 s23, 3
    s_cselect_b32 s73, 159744, s73
    v_add_u32 v11, s73, v14
    ds_write_b128 v11, v[72:75]
    ds_write_b128 v11, v[76:79] offset:1024
    ds_write_b128 v11, v[118:121] offset:2048
    v_mov_b32 v12, 162816
    v_mov_b32 v13, 1
    s_waitcnt lgkmcnt(0)
    s_mov_b64 exec, 1
    ds_add_rtn_u32 v13, v12, v13
    s_mov_b64 exec, -1
    s_waitcnt lgkmcnt(0)
    v_readfirstlane_b32 s82, v13
    s_nop 1
    s_cmp_lg_u32 s82, 3
    s_cbranch_scc1 L_k1_skip1
    v_add_u32 v11, 114688, v14
    ds_read_b128 v[80:83], v11 offset:0
    ds_read_b128 v[84:87], v11 offset:1024
    ds_read_b128 v[88:91], v11 offset:2048
    v_add_u32 v11, 154624, v14
    ds_read_b128 v[92:95], v11 offset:0
    ds_read_b128 v[96:99], v11 offset:1024
    ds_read_b128 v[100:103], v11 offset:2048
    v_add_u32 v11, 34816, v14
    ds_read_b128 v[104:107], v11 offset:0
    ds_read_b128 v[108:111], v11 offset:1024
    ds_read_b128 v[112:115], v11 offset:2048
    v_add_u32 v11, 159744, v14
    ds_read_b128 v[116:119], v11 offset:0
    ds_read_b128 v[120:123], v11 offset:1024
    ds_read_b128 v[124:127], v11 offset:2048
    s_lshl_b32 s73, s21, 3
    s_add_u32 s73, s73, s20
    s_lshl_b32 s73, s73, 12
    s_add_u32 s73, s73, 21233664
    s_waitcnt lgkmcnt(0)
    v_pk_add_f32 v[80:81], v[80:81], v[92:93]
    v_pk_add_f32 v[104:105], v[104:105], v[116:117]
    v_pk_add_f32 v[80:81], v[80:81], v[104:105]
    v_pk_add_f32 v[82:83], v[82:83], v[94:95]
    v_pk_add_f32 v[106:107], v[106:107], v[118:119]
    v_pk_add_f32 v[82:83], v[82:83], v[106:107]
    v_pk_add_f32 v[84:85], v[84:85], v[96:97]
    v_pk_add_f32 v[108:109], v[108:109], v[120:121]
    v_pk_add_f32 v[84:85], v[84:85], v[108:109]
    v_pk_add_f32 v[86:87], v[86:87], v[98:99]
    v_pk_add_f32 v[110:111], v[110:111], v[122:123]
    v_pk_add_f32 v[86:87], v[86:87], v[110:111]
    v_pk_add_f32 v[88:89], v[88:89], v[100:101]
    v_pk_add_f32 v[112:113], v[112:113], v[124:125]
    v_pk_add_f32 v[88:89], v[88:89], v[112:113]
    v_pk_add_f32 v[90:91], v[90:91], v[102:103]
    v_pk_add_f32 v[114:115], v[114:115], v[126:127]
    v_pk_add_f32 v[90:91], v[90:91], v[114:115]
    buffer_store_dwordx4 v[80:83], v14, s[44:47], s73 offen sc1
    buffer_store_dwordx4 v[84:87], v14, s[44:47], s73 offen offset:1024 sc1
    buffer_store_dwordx4 v[88:91], v14, s[44:47], s73 offen offset:2048 sc1
L_k1_skip1:
    v_mfma_f32_16x16x32_bf16 v[244:247], v[60:63], v[36:39], v[244:247]
    v_pk_mul_f32 v[72:73], v[128:129], v[128:129]
    v_pk_mul_f32 v[76:77], v[130:131], v[130:131]
    v_pk_fma_f32 v[72:73], v[72:73], s[78:79], v[0:1] op_sel_hi:[1,1,0]
    v_pk_fma_f32 v[76:77], v[76:77], s[78:79], v[0:1] op_sel_hi:[1,1,0]
    v_pk_mul_f32 v[72:73], v[72:73], v[128:129]
    v_mfma_f32_16x16x32_bf16 v[248:251], v[60:63], v[40:43], v[248:251]
    v_pk_mul_f32 v[76:77], v[76:77], v[130:131]
    v_exp_f32 v72, v72
    v_exp_f32 v76, v76
    v_exp_f32 v73, v73
    v_exp_f32 v77, v77
    v_mfma_f32_16x16x32_bf16 v[252:255], v[60:63], v[44:47], v[252:255]
    v_pk_mul_f32 v[74:75], v[128:129], v[160:161]
    v_pk_mul_f32 v[78:79], v[130:131], v[162:163]
    v_pk_add_f32 v[72:73], v[72:73], 1.0 op_sel_hi:[1,0]
    v_pk_add_f32 v[76:77], v[76:77], 1.0 op_sel_hi:[1,0]
    v_rcp_f32 v72, v72
    ds_read_b64_tr_b16 v[60:61], v65 offset:9312
    ds_read_b64_tr_b16 v[62:63], v65 offset:11616
    v_mfma_f32_16x16x32_bf16 v[192:195], v[48:51], v[16:19], v[192:195]
    v_rcp_f32 v76, v76
    v_rcp_f32 v73, v73
    v_rcp_f32 v77, v77
    v_pk_mul_f32 v[74:75], v[74:75], v[72:73]
    v_pk_mul_f32 v[78:79], v[78:79], v[76:77]
    v_mfma_f32_16x16x32_bf16 v[196:199], v[48:51], v[20:23], v[196:199]
    v_cvt_pk_bf16_f32 v11, v74, v75
    v_cvt_pk_bf16_f32 v129, v78, v79
    v_mov_b32 v128, v11
    v_pk_mul_f32 v[72:73], v[144:145], v[144:145]
    v_pk_mul_f32 v[76:77], v[146:147], v[146:147]
    v_mfma_f32_16x16x32_bf16 v[200:203], v[48:51], v[24:27], v[200:203]
    v_pk_fma_f32 v[72:73], v[72:73], s[78:79], v[0:1] op_sel_hi:[1,1,0]
    v_pk_fma_f32 v[76:77], v[76:77], s[78:79], v[0:1] op_sel_hi:[1,1,0]
    v_pk_mul_f32 v[72:73], v[72:73], v[144:145]
    v_pk_mul_f32 v[76:77], v[76:77], v[146:147]
    v_exp_f32 v72, v72
    v_mfma_f32_16x16x32_bf16 v[204:207], v[48:51], v[28:31], v[204:207]
    v_exp_f32 v76, v76
    v_exp_f32 v73, v73
    v_exp_f32 v77, v77
    v_pk_mul_f32 v[74:75], v[144:145], v[176:177]
    v_pk_mul_f32 v[78:79], v[146:147], v[178:179]
    v_add_u32 v68, -39936, v7
    v_add_u32 v69, -39936, v8
    ds_read_b128 v[32:35], v68 offset:0
    ds_read_b128 v[36:39], v68 offset:1024
    ds_read_b128 v[40:43], v68 offset:2048
    ds_read_b128 v[44:47], v68 offset:3072
    ds_read_b64_tr_b16 v[48:49], v69 offset:64
    ds_read_b64_tr_b16 v[50:51], v69 offset:2368
    v_mfma_f32_16x16x32_bf16 v[208:211], v[52:55], v[16:19], v[208:211]
    v_pk_add_f32 v[72:73], v[72:73], 1.0 op_sel_hi:[1,0]
    v_pk_add_f32 v[76:77], v[76:77], 1.0 op_sel_hi:[1,0]
    v_rcp_f32 v72, v72
    v_rcp_f32 v76, v76
    v_rcp_f32 v73, v73
    v_mfma_f32_16x16x32_bf16 v[212:215], v[52:55], v[20:23], v[212:215]
    v_rcp_f32 v77, v77
    v_pk_mul_f32 v[74:75], v[74:75], v[72:73]
    v_pk_mul_f32 v[78:79], v[78:79], v[76:77]
    v_cvt_pk_bf16_f32 v130, v74, v75
    v_cvt_pk_bf16_f32 v131, v78, v79
    v_mfma_f32_16x16x32_bf16 v[216:219], v[52:55], v[24:27], v[216:219]
    s_add_u32 s81, s74, 0
    buffer_store_dwordx4 v[128:131], v14, s[44:47], s81 offen offset:0 sc1
    v_pk_mul_f32 v[72:73], v[132:133], v[132:133]
    v_pk_mul_f32 v[76:77], v[134:135], v[134:135]
    v_pk_fma_f32 v[72:73], v[72:73], s[78:79], v[0:1] op_sel_hi:[1,1,0]
    v_mfma_f32_16x16x32_bf16 v[220:223], v[52:55], v[28:31], v[220:223]
    v_pk_fma_f32 v[76:77], v[76:77], s[78:79], v[0:1] op_sel_hi:[1,1,0]
    v_pk_mul_f32 v[72:73], v[72:73], v[132:133]
    v_pk_mul_f32 v[76:77], v[76:77], v[134:135]
    v_exp_f32 v72, v72
    v_exp_f32 v76, v76
    ds_read_b64_tr_b16 v[52:53], v69 offset:96
    ds_read_b64_tr_b16 v[54:55], v69 offset:2400
    v_mfma_f32_16x16x32_bf16 v[224:227], v[56:59], v[16:19], v[224:227]
    v_exp_f32 v73, v73
    v_exp_f32 v77, v77
    v_pk_mul_f32 v[74:75], v[132:133], v[164:165]
    v_pk_mul_f32 v[78:79], v[134:135], v[166:167]
    v_pk_add_f32 v[72:73], v[72:73], 1.0 op_sel_hi:[1,0]
    v_mfma_f32_16x16x32_bf16 v[228:231], v[56:59], v[20:23], v[228:231]
    v_pk_add_f32 v[76:77], v[76:77], 1.0 op_sel_hi:[1,0]
    v_rcp_f32 v72, v72
    v_rcp_f32 v76, v76
    v_rcp_f32 v73, v73
    v_rcp_f32 v77, v77
    v_mfma_f32_16x16x32_bf16 v[232:235], v[56:59], v[24:27], v[232:235]
    v_pk_mul_f32 v[74:75], v[74:75], v[72:73]
    v_pk_mul_f32 v[78:79], v[78:79], v[76:77]
    v_cvt_pk_bf16_f32 v11, v74, v75
    v_cvt_pk_bf16_f32 v133, v78, v79
    v_mov_b32 v132, v11
    v_mfma_f32_16x16x32_bf16 v[236:239], v[56:59], v[28:31], v[236:239]
    v_pk_mul_f32 v[72:73], v[148:149], v[148:149]
    v_pk_mul_f32 v[76:77], v[150:151], v[150:151]
    v_pk_fma_f32 v[72:73], v[72:73], s[78:79], v[0:1] op_sel_hi:[1,1,0]
    v_pk_fma_f32 v[76:77], v[76:77], s[78:79], v[0:1] op_sel_hi:[1,1,0]
    v_pk_mul_f32 v[72:73], v[72:73], v[148:149]
    ds_read_b64_tr_b16 v[56:57], v69 offset:9280
    ds_read_b64_tr_b16 v[58:59], v69 offset:11584
    s_waitcnt lgkmcnt(10)
    v_mfma_f32_16x16x32_bf16 v[240:243], v[60:63], v[16:19], v[240:243]
    v_pk_mul_f32 v[76:77], v[76:77], v[150:151]
    v_exp_f32 v72, v72
    v_exp_f32 v76, v76
    v_exp_f32 v73, v73
    v_exp_f32 v77, v77
    v_mfma_f32_16x16x32_bf16 v[244:247], v[60:63], v[20:23], v[244:247]
    v_pk_mul_f32 v[74:75], v[148:149], v[180:181]
    v_pk_mul_f32 v[78:79], v[150:151], v[182:183]
    v_pk_add_f32 v[72:73], v[72:73], 1.0 op_sel_hi:[1,0]
    v_pk_add_f32 v[76:77], v[76:77], 1.0 op_sel_hi:[1,0]
    v_rcp_f32 v72, v72
    v_mfma_f32_16x16x32_bf16 v[248:251], v[60:63], v[24:27], v[248:251]
    v_rcp_f32 v76, v76
    v_rcp_f32 v73, v73
    v_rcp_f32 v77, v77
    v_pk_mul_f32 v[74:75], v[74:75], v[72:73]
    v_pk_mul_f32 v[78:79], v[78:79], v[76:77]
    v_mfma_f32_16x16x32_bf16 v[252:255], v[60:63], v[28:31], v[252:255]
    v_cvt_pk_bf16_f32 v134, v74, v75
    v_cvt_pk_bf16_f32 v135, v78, v79
    s_add_u32 s81, s74, 147456
    buffer_store_dwordx4 v[132:135], v14, s[44:47], s81 offen offset:0 sc1
    v_pk_mul_f32 v[72:73], v[136:137], v[136:137]
    ds_read_b64_tr_b16 v[60:61], v69 offset:9312
    ds_read_b64_tr_b16 v[62:63], v69 offset:11616
    s_waitcnt lgkmcnt(6)
    v_mfma_f32_16x16x32_bf16 v[192:195], v[48:51], v[32:35], v[192:195]
    v_pk_mul_f32 v[76:77], v[138:139], v[138:139]
    v_pk_fma_f32 v[72:73], v[72:73], s[78:79], v[0:1] op_sel_hi:[1,1,0]
    v_pk_fma_f32 v[76:77], v[76:77], s[78:79], v[0:1] op_sel_hi:[1,1,0]
    v_pk_mul_f32 v[72:73], v[72:73], v[136:137]
    v_pk_mul_f32 v[76:77], v[76:77], v[138:139]
    v_mfma_f32_16x16x32_bf16 v[196:199], v[48:51], v[36:39], v[196:199]
    v_exp_f32 v72, v72
    v_exp_f32 v76, v76
    v_exp_f32 v73, v73
    v_exp_f32 v77, v77
    v_pk_mul_f32 v[74:75], v[136:137], v[168:169]
    v_mfma_f32_16x16x32_bf16 v[200:203], v[48:51], v[40:43], v[200:203]
    v_pk_mul_f32 v[78:79], v[138:139], v[170:171]
    v_pk_add_f32 v[72:73], v[72:73], 1.0 op_sel_hi:[1,0]
    v_pk_add_f32 v[76:77], v[76:77], 1.0 op_sel_hi:[1,0]
    v_rcp_f32 v72, v72
    v_rcp_f32 v76, v76
    v_mfma_f32_16x16x32_bf16 v[204:207], v[48:51], v[44:47], v[204:207]
    v_rcp_f32 v73, v73
    v_rcp_f32 v77, v77
    v_pk_mul_f32 v[74:75], v[74:75], v[72:73]
    v_pk_mul_f32 v[78:79], v[78:79], v[76:77]
    v_cvt_pk_bf16_f32 v11, v74, v75
    s_waitcnt lgkmcnt(4)
    v_mfma_f32_16x16x32_bf16 v[208:211], v[52:55], v[32:35], v[208:211]
    v_cvt_pk_bf16_f32 v137, v78, v79
    v_mov_b32 v136, v11
    v_pk_mul_f32 v[72:73], v[152:153], v[152:153]
    v_pk_mul_f32 v[76:77], v[154:155], v[154:155]
    v_pk_fma_f32 v[72:73], v[72:73], s[78:79], v[0:1] op_sel_hi:[1,1,0]
    v_mfma_f32_16x16x32_bf16 v[212:215], v[52:55], v[36:39], v[212:215]
    v_pk_fma_f32 v[76:77], v[76:77], s[78:79], v[0:1] op_sel_hi:[1,1,0]
    v_pk_mul_f32 v[72:73], v[72:73], v[152:153]
    v_pk_mul_f32 v[76:77], v[76:77], v[154:155]
    v_exp_f32 v72, v72
    v_exp_f32 v76, v76
    v_mfma_f32_16x16x32_bf16 v[216:219], v[52:55], v[40:43], v[216:219]
    v_exp_f32 v73, v73
    v_exp_f32 v77, v77
    v_pk_mul_f32 v[74:75], v[152:153], v[184:185]
    v_pk_mul_f32 v[78:79], v[154:155], v[186:187]
    v_pk_add_f32 v[72:73], v[72:73], 1.0 op_sel_hi:[1,0]
    v_mfma_f32_16x16x32_bf16 v[220:223], v[52:55], v[44:47], v[220:223]
    v_pk_add_f32 v[76:77], v[76:77], 1.0 op_sel_hi:[1,0]
    v_rcp_f32 v72, v72
    v_rcp_f32 v76, v76
    v_rcp_f32 v73, v73
    v_rcp_f32 v77, v77
    s_waitcnt lgkmcnt(2)
    v_mfma_f32_16x16x32_bf16 v[224:227], v[56:59], v[32:35], v[224:227]
    v_pk_mul_f32 v[74:75], v[74:75], v[72:73]
    v_pk_mul_f32 v[78:79], v[78:79], v[76:77]
    v_cvt_pk_bf16_f32 v138, v74, v75
    v_cvt_pk_bf16_f32 v139, v78, v79
    s_add_u32 s81, s74, 294912
    v_mfma_f32_16x16x32_bf16 v[228:231], v[56:59], v[36:39], v[228:231]
    buffer_store_dwordx4 v[136:139], v14, s[44:47], s81 offen offset:0 sc1
    v_pk_mul_f32 v[72:73], v[140:141], v[140:141]
    v_pk_mul_f32 v[76:77], v[142:143], v[142:143]
    v_pk_fma_f32 v[72:73], v[72:73], s[78:79], v[0:1] op_sel_hi:[1,1,0]
    v_pk_fma_f32 v[76:77], v[76:77], s[78:79], v[0:1] op_sel_hi:[1,1,0]
    v_mfma_f32_16x16x32_bf16 v[232:235], v[56:59], v[40:43], v[232:235]
    v_pk_mul_f32 v[72:73], v[72:73], v[140:141]
    v_pk_mul_f32 v[76:77], v[76:77], v[142:143]
    v_exp_f32 v72, v72
    v_exp_f32 v76, v76
    v_exp_f32 v73, v73
    v_mfma_f32_16x16x32_bf16 v[236:239], v[56:59], v[44:47], v[236:239]
    v_exp_f32 v77, v77
    v_pk_mul_f32 v[74:75], v[140:141], v[172:173]
    v_pk_mul_f32 v[78:79], v[142:143], v[174:175]
    v_pk_add_f32 v[72:73], v[72:73], 1.0 op_sel_hi:[1,0]
    v_pk_add_f32 v[76:77], v[76:77], 1.0 op_sel_hi:[1,0]
    s_waitcnt lgkmcnt(0)
    v_mfma_f32_16x16x32_bf16 v[240:243], v[60:63], v[32:35], v[240:243]
    v_rcp_f32 v72, v72
    v_rcp_f32 v76, v76
    v_rcp_f32 v73, v73
    v_rcp_f32 v77, v77
    v_pk_mul_f32 v[74:75], v[74:75], v[72:73]
    v_mfma_f32_16x16x32_bf16 v[244:247], v[60:63], v[36:39], v[244:247]
    v_pk_mul_f32 v[78:79], v[78:79], v[76:77]
    v_cvt_pk_bf16_f32 v11, v74, v75
    v_cvt_pk_bf16_f32 v141, v78, v79
    v_mov_b32 v140, v11
    v_pk_mul_f32 v[72:73], v[156:157], v[156:157]
    v_mfma_f32_16x16x32_bf16 v[248:251], v[60:63], v[40:43], v[248:251]
    v_pk_mul_f32 v[76:77], v[158:159], v[158:159]
    v_pk_fma_f32 v[72:73], v[72:73], s[78:79], v[0:1] op_sel_hi:[1,1,0]
    v_pk_fma_f32 v[76:77], v[76:77], s[78:79], v[0:1] op_sel_hi:[1,1,0]
    v_pk_mul_f32 v[72:73], v[72:73], v[156:157]
    v_pk_mul_f32 v[76:77], v[76:77], v[158:159]
    v_mfma_f32_16x16x32_bf16 v[252:255], v[60:63], v[44:47], v[252:255]
    v_exp_f32 v72, v72
    v_exp_f32 v76, v76
    v_exp_f32 v73, v73
    v_exp_f32 v77, v77
    v_pk_mul_f32 v[74:75], v[156:157], v[188:189]
    v_pk_mul_f32 v[78:79], v[158:159], v[190:191]
    v_pk_add_f32 v[72:73], v[72:73], 1.0 op_sel_hi:[1,0]
    v_pk_add_f32 v[76:77], v[76:77], 1.0 op_sel_hi:[1,0]
    v_rcp_f32 v72, v72
    v_rcp_f32 v76, v76
    v_rcp_f32 v73, v73
    v_rcp_f32 v77, v77
    v_pk_mul_f32 v[74:75], v[74:75], v[72:73]
    v_pk_mul_f32 v[78:79], v[78:79], v[76:77]
    v_cvt_pk_bf16_f32 v142, v74, v75
    v_cvt_pk_bf16_f32 v143, v78, v79
    s_add_u32 s81, s74, 442368
    buffer_store_dwordx4 v[140:143], v14, s[44:47], s81 offen offset:0 sc1
    s_cmp_lg_u32 s82, 3
    s_cbranch_scc1 L_k1_skip2
    s_waitcnt vmcnt(4)
    s_mov_b32 s48, s16
    s_mov_b32 s49, s17
    s_mov_b32 s50, 256
    s_mov_b32 s51, 0x20000
    s_lshl_b32 s73, s21, 2
    s_add_u32 s73, s73, 64
    v_mov_b32 v6, 0x100
    v_mov_b32 v12, 0
    s_mov_b64 exec, 1
    buffer_atomic_add v6, v12, s[48:51], s73 offen sc0
    s_mov_b64 exec, -1
L_k1_skip2:
    s_setprio 0
    s_mov_b32 s83, 0
    v_pk_mul_f32 v[72:73], v[192:193], v[192:193]
    v_pk_mul_f32 v[76:77], v[194:195], v[194:195]
    v_pk_fma_f32 v[72:73], v[72:73], s[78:79], v[0:1] op_sel_hi:[1,1,0]
    v_pk_fma_f32 v[76:77], v[76:77], s[78:79], v[0:1] op_sel_hi:[1,1,0]
    v_pk_mul_f32 v[72:73], v[72:73], v[192:193]
    v_pk_mul_f32 v[76:77], v[76:77], v[194:195]
    v_exp_f32 v72, v72
    v_exp_f32 v76, v76
    v_exp_f32 v73, v73
    v_exp_f32 v77, v77
    v_pk_mul_f32 v[74:75], v[192:193], v[224:225]
    v_pk_mul_f32 v[78:79], v[194:195], v[226:227]
    v_pk_add_f32 v[72:73], v[72:73], 1.0 op_sel_hi:[1,0]
    v_pk_add_f32 v[76:77], v[76:77], 1.0 op_sel_hi:[1,0]
    v_rcp_f32 v72, v72
    v_rcp_f32 v76, v76
    v_rcp_f32 v73, v73
    v_rcp_f32 v77, v77
    v_pk_mul_f32 v[74:75], v[74:75], v[72:73]
    v_pk_mul_f32 v[78:79], v[78:79], v[76:77]
    v_cvt_pk_bf16_f32 v11, v74, v75
    v_cvt_pk_bf16_f32 v193, v78, v79
    v_mov_b32 v192, v11
    v_pk_mul_f32 v[72:73], v[208:209], v[208:209]
    v_pk_mul_f32 v[76:77], v[210:211], v[210:211]
    v_pk_fma_f32 v[72:73], v[72:73], s[78:79], v[0:1] op_sel_hi:[1,1,0]
    v_pk_fma_f32 v[76:77], v[76:77], s[78:79], v[0:1] op_sel_hi:[1,1,0]
    v_pk_mul_f32 v[72:73], v[72:73], v[208:209]
    v_pk_mul_f32 v[76:77], v[76:77], v[210:211]
    v_exp_f32 v72, v72
    v_exp_f32 v76, v76
    v_exp_f32 v73, v73
    v_exp_f32 v77, v77
    v_pk_mul_f32 v[74:75], v[208:209], v[240:241]
    v_pk_mul_f32 v[78:79], v[210:211], v[242:243]
    v_pk_add_f32 v[72:73], v[72:73], 1.0 op_sel_hi:[1,0]
    v_pk_add_f32 v[76:77], v[76:77], 1.0 op_sel_hi:[1,0]
    v_rcp_f32 v72, v72
    v_rcp_f32 v76, v76
    v_rcp_f32 v73, v73
    v_rcp_f32 v77, v77
    v_pk_mul_f32 v[74:75], v[74:75], v[72:73]
    v_pk_mul_f32 v[78:79], v[78:79], v[76:77]
    v_cvt_pk_bf16_f32 v194, v74, v75
    v_cvt_pk_bf16_f32 v195, v78, v79
    s_add_u32 s81, s74, 0
    buffer_store_dwordx4 v[192:195], v14, s[44:47], s81 offen offset:1024 sc1
    s_cmp_lg_u32 s82, 3
    s_cbranch_scc1 L_k1_mid
    s_waitcnt vmcnt(1)
    v_readfirstlane_b32 s73, v6
    s_nop 1
    s_bfe_u32 s73, s73, 0x30008
    s_cmp_lg_u32 s73, 7
    s_cbranch_scc1 L_k1_mid
    s_mov_b32 s83, 1
    s_lshl_b32 s73, s21, 15
    s_add_u32 s73, s73, 21233664
    buffer_load_dwordx4 v[80:83], v14, s[44:47], s73 offen offset:0 sc1
    buffer_load_dwordx4 v[84:87], v14, s[44:47], s73 offen offset:1024 sc1
    buffer_load_dwordx4 v[88:91], v14, s[44:47], s73 offen offset:2048 sc1
    s_add_u32 s73, s73, 4096
    buffer_load_dwordx4 v[92:95], v14, s[44:47], s73 offen offset:0 sc1
    buffer_load_dwordx4 v[96:99], v14, s[44:47], s73 offen offset:1024 sc1
    buffer_load_dwordx4 v[100:103], v14, s[44:47], s73 offen offset:2048 sc1
    s_add_u32 s73, s73, 4096
    buffer_load_dwordx4 v[104:107], v14, s[44:47], s73 offen offset:0 sc1
    buffer_load_dwordx4 v[108:111], v14, s[44:47], s73 offen offset:1024 sc1
    buffer_load_dwordx4 v[112:115], v14, s[44:47], s73 offen offset:2048 sc1
    s_add_u32 s73, s73, 4096
    buffer_load_dwordx4 v[116:119], v14, s[44:47], s73 offen offset:0 sc1
    buffer_load_dwordx4 v[120:123], v14, s[44:47], s73 offen offset:1024 sc1
    buffer_load_dwordx4 v[124:127], v14, s[44:47], s73 offen offset:2048 sc1
    s_add_u32 s73, s73, 4096
    buffer_load_dwordx4 v[128:131], v14, s[44:47], s73 offen offset:0 sc1
    buffer_load_dwordx4 v[132:135], v14, s[44:47], s73 offen offset:1024 sc1
    buffer_load_dwordx4 v[136:139], v14, s[44:47], s73 offen offset:2048 sc1
    s_add_u32 s73, s73, 4096
    buffer_load_dwordx4 v[140:143], v14, s[44:47], s73 offen offset:0 sc1
    buffer_load_dwordx4 v[144:147], v14, s[44:47], s73 offen offset:1024 sc1
    buffer_load_dwordx4 v[148:151], v14, s[44:47], s73 offen offset:2048 sc1
    s_add_u32 s73, s73, 4096
    buffer_load_dwordx4 v[152:155], v14, s[44:47], s73 offen offset:0 sc1
    buffer_load_dwordx4 v[156:159], v14, s[44:47], s73 offen offset:1024 sc1
    buffer_load_dwordx4 v[160:163], v14, s[44:47], s73 offen offset:2048 sc1
    s_add_u32 s73, s73, 4096
    buffer_load_dwordx4 v[164:167], v14, s[44:47], s73 offen offset:0 sc1
    buffer_load_dwordx4 v[168:171], v14, s[44:47], s73 offen offset:1024 sc1
    buffer_load_dwordx4 v[172:175], v14, s[44:47], s73 offen offset:2048 sc1
    s_add_u32 s73, s73, 4096
L_k1_mid:
    v_pk_mul_f32 v[72:73], v[196:197], v[196:197]
    v_pk_mul_f32 v[76:77], v[198:199], v[198:199]
    v_pk_fma_f32 v[72:73], v[72:73], s[78:79], v[0:1] op_sel_hi:[1,1,0]
    v_pk_fma_f32 v[76:77], v[76:77], s[78:79], v[0:1] op_sel_hi:[1,1,0]
    v_pk_mul_f32 v[72:73], v[72:73], v[196:197]
    v_pk_mul_f32 v[76:77], v[76:77], v[198:199]
    v_exp_f32 v72, v72
    v_exp_f32 v76, v76
    v_exp_f32 v73, v73
    v_exp_f32 v77, v77
    v_pk_mul_f32 v[74:75], v[196:197], v[228:229]
    v_pk_mul_f32 v[78:79], v[198:199], v[230:231]
    v_pk_add_f32 v[72:73], v[72:73], 1.0 op_sel_hi:[1,0]
    v_pk_add_f32 v[76:77], v[76:77], 1.0 op_sel_hi:[1,0]
    v_rcp_f32 v72, v72
    v_rcp_f32 v76, v76
    v_rcp_f32 v73, v73
    v_rcp_f32 v77, v77
    v_pk_mul_f32 v[74:75], v[74:75], v[72:73]
    v_pk_mul_f32 v[78:79], v[78:79], v[76:77]
    v_cvt_pk_bf16_f32 v11, v74, v75
    v_cvt_pk_bf16_f32 v197, v78, v79
    v_mov_b32 v196, v11
    v_pk_mul_f32 v[72:73], v[212:213], v[212:213]
    v_pk_mul_f32 v[76:77], v[214:215], v[214:215]
    v_pk_fma_f32 v[72:73], v[72:73], s[78:79], v[0:1] op_sel_hi:[1,1,0]
    v_pk_fma_f32 v[76:77], v[76:77], s[78:79], v[0:1] op_sel_hi:[1,1,0]
    v_pk_mul_f32 v[72:73], v[72:73], v[212:213]
    v_pk_mul_f32 v[76:77], v[76:77], v[214:215]
    v_exp_f32 v72, v72
    v_exp_f32 v76, v76
    v_exp_f32 v73, v73
    v_exp_f32 v77, v77
    v_pk_mul_f32 v[74:75], v[212:213], v[244:245]
    v_pk_mul_f32 v[78:79], v[214:215], v[246:247]
    v_pk_add_f32 v[72:73], v[72:73], 1.0 op_sel_hi:[1,0]
    v_pk_add_f32 v[76:77], v[76:77], 1.0 op_sel_hi:[1,0]
    v_rcp_f32 v72, v72
    v_rcp_f32 v76, v76
    v_rcp_f32 v73, v73
    v_rcp_f32 v77, v77
    v_pk_mul_f32 v[74:75], v[74:75], v[72:73]
    v_pk_mul_f32 v[78:79], v[78:79], v[76:77]
    v_cvt_pk_bf16_f32 v198, v74, v75
    v_cvt_pk_bf16_f32 v199, v78, v79
    s_add_u32 s81, s74, 147456
    buffer_store_dwordx4 v[196:199], v14, s[44:47], s81 offen offset:1024 sc1
    v_pk_mul_f32 v[72:73], v[200:201], v[200:201]
    v_pk_mul_f32 v[76:77], v[202:203], v[202:203]
    v_pk_fma_f32 v[72:73], v[72:73], s[78:79], v[0:1] op_sel_hi:[1,1,0]
    v_pk_fma_f32 v[76:77], v[76:77], s[78:79], v[0:1] op_sel_hi:[1,1,0]
    v_pk_mul_f32 v[72:73], v[72:73], v[200:201]
    v_pk_mul_f32 v[76:77], v[76:77], v[202:203]
    v_exp_f32 v72, v72
    v_exp_f32 v76, v76
    v_exp_f32 v73, v73
    v_exp_f32 v77, v77
    v_pk_mul_f32 v[74:75], v[200:201], v[232:233]
    v_pk_mul_f32 v[78:79], v[202:203], v[234:235]
    v_pk_add_f32 v[72:73], v[72:73], 1.0 op_sel_hi:[1,0]
    v_pk_add_f32 v[76:77], v[76:77], 1.0 op_sel_hi:[1,0]
    v_rcp_f32 v72, v72
    v_rcp_f32 v76, v76
    v_rcp_f32 v73, v73
    v_rcp_f32 v77, v77
    v_pk_mul_f32 v[74:75], v[74:75], v[72:73]
    v_pk_mul_f32 v[78:79], v[78:79], v[76:77]
    v_cvt_pk_bf16_f32 v11, v74, v75
    v_cvt_pk_bf16_f32 v201, v78, v79
    v_mov_b32 v200, v11
    v_pk_mul_f32 v[72:73], v[216:217], v[216:217]
    v_pk_mul_f32 v[76:77], v[218:219], v[218:219]
    v_pk_fma_f32 v[72:73], v[72:73], s[78:79], v[0:1] op_sel_hi:[1,1,0]
    v_pk_fma_f32 v[76:77], v[76:77], s[78:79], v[0:1] op_sel_hi:[1,1,0]
    v_pk_mul_f32 v[72:73], v[72:73], v[216:217]
    v_pk_mul_f32 v[76:77], v[76:77], v[218:219]
    v_exp_f32 v72, v72
    v_exp_f32 v76, v76
    v_exp_f32 v73, v73
    v_exp_f32 v77, v77
    v_pk_mul_f32 v[74:75], v[216:217], v[248:249]
    v_pk_mul_f32 v[78:79], v[218:219], v[250:251]
    v_pk_add_f32 v[72:73], v[72:73], 1.0 op_sel_hi:[1,0]
    v_pk_add_f32 v[76:77], v[76:77], 1.0 op_sel_hi:[1,0]
    v_rcp_f32 v72, v72
    v_rcp_f32 v76, v76
    v_rcp_f32 v73, v73
    v_rcp_f32 v77, v77
    v_pk_mul_f32 v[74:75], v[74:75], v[72:73]
    v_pk_mul_f32 v[78:79], v[78:79], v[76:77]
    v_cvt_pk_bf16_f32 v202, v74, v75
    v_cvt_pk_bf16_f32 v203, v78, v79
    s_add_u32 s81, s74, 294912
    buffer_store_dwordx4 v[200:203], v14, s[44:47], s81 offen offset:1024 sc1
    v_pk_mul_f32 v[72:73], v[204:205], v[204:205]
    v_pk_mul_f32 v[76:77], v[206:207], v[206:207]
    v_pk_fma_f32 v[72:73], v[72:73], s[78:79], v[0:1] op_sel_hi:[1,1,0]
    v_pk_fma_f32 v[76:77], v[76:77], s[78:79], v[0:1] op_sel_hi:[1,1,0]
    v_pk_mul_f32 v[72:73], v[72:73], v[204:205]
    v_pk_mul_f32 v[76:77], v[76:77], v[206:207]
    v_exp_f32 v72, v72
    v_exp_f32 v76, v76
    v_exp_f32 v73, v73
    v_exp_f32 v77, v77
    v_pk_mul_f32 v[74:75], v[204:205], v[236:237]
    v_pk_mul_f32 v[78:79], v[206:207], v[238:239]
    v_pk_add_f32 v[72:73], v[72:73], 1.0 op_sel_hi:[1,0]
    v_pk_add_f32 v[76:77], v[76:77], 1.0 op_sel_hi:[1,0]
    v_rcp_f32 v72, v72
    v_rcp_f32 v76, v76
    v_rcp_f32 v73, v73
    v_rcp_f32 v77, v77
    v_pk_mul_f32 v[74:75], v[74:75], v[72:73]
    v_pk_mul_f32 v[78:79], v[78:79], v[76:77]
    v_cvt_pk_bf16_f32 v11, v74, v75
    v_cvt_pk_bf16_f32 v205, v78, v79
    v_mov_b32 v204, v11
    v_pk_mul_f32 v[72:73], v[220:221], v[220:221]
    v_pk_mul_f32 v[76:77], v[222:223], v[222:223]
    v_pk_fma_f32 v[72:73], v[72:73], s[78:79], v[0:1] op_sel_hi:[1,1,0]
    v_pk_fma_f32 v[76:77], v[76:77], s[78:79], v[0:1] op_sel_hi:[1,1,0]
    v_pk_mul_f32 v[72:73], v[72:73], v[220:221]
    v_pk_mul_f32 v[76:77], v[76:77], v[222:223]
    v_exp_f32 v72, v72
    v_exp_f32 v76, v76
    v_exp_f32 v73, v73
    v_exp_f32 v77, v77
    v_pk_mul_f32 v[74:75], v[220:221], v[252:253]
    v_pk_mul_f32 v[78:79], v[222:223], v[254:255]
    v_pk_add_f32 v[72:73], v[72:73], 1.0 op_sel_hi:[1,0]
    v_pk_add_f32 v[76:77], v[76:77], 1.0 op_sel_hi:[1,0]
    v_rcp_f32 v72, v72
    v_rcp_f32 v76, v76
    v_rcp_f32 v73, v73
    v_rcp_f32 v77, v77
    v_pk_mul_f32 v[74:75], v[74:75], v[72:73]
    v_pk_mul_f32 v[78:79], v[78:79], v[76:77]
    v_cvt_pk_bf16_f32 v206, v74, v75
    v_cvt_pk_bf16_f32 v207, v78, v79
    s_add_u32 s81, s74, 442368
    buffer_store_dwordx4 v[204:207], v14, s[44:47], s81 offen offset:1024 sc1
    s_cmp_lg_u32 s83, 1
    s_cbranch_scc1 L_k1_fin
    s_waitcnt vmcnt(21)
    v_pk_add_f32 v[80:81], v[80:81], v[92:93]
    v_pk_add_f32 v[82:83], v[82:83], v[94:95]
    v_pk_add_f32 v[84:85], v[84:85], v[96:97]
    v_pk_add_f32 v[86:87], v[86:87], v[98:99]
    v_pk_add_f32 v[88:89], v[88:89], v[100:101]
    v_pk_add_f32 v[90:91], v[90:91], v[102:103]
    s_waitcnt vmcnt(18)
    v_pk_add_f32 v[80:81], v[80:81], v[104:105]
    v_pk_add_f32 v[82:83], v[82:83], v[106:107]
    v_pk_add_f32 v[84:85], v[84:85], v[108:109]
    v_pk_add_f32 v[86:87], v[86:87], v[110:111]
    v_pk_add_f32 v[88:89], v[88:89], v[112:113]
    v_pk_add_f32 v[90:91], v[90:91], v[114:115]
    s_waitcnt vmcnt(15)
    v_pk_add_f32 v[80:81], v[80:81], v[116:117]
    v_pk_add_f32 v[82:83], v[82:83], v[118:119]
    v_pk_add_f32 v[84:85], v[84:85], v[120:121]
    v_pk_add_f32 v[86:87], v[86:87], v[122:123]
    v_pk_add_f32 v[88:89], v[88:89], v[124:125]
    v_pk_add_f32 v[90:91], v[90:91], v[126:127]
    s_waitcnt vmcnt(12)
    v_pk_add_f32 v[80:81], v[80:81], v[128:129]
    v_pk_add_f32 v[82:83], v[82:83], v[130:131]
    v_pk_add_f32 v[84:85], v[84:85], v[132:133]
    v_pk_add_f32 v[86:87], v[86:87], v[134:135]
    v_pk_add_f32 v[88:89], v[88:89], v[136:137]
    v_pk_add_f32 v[90:91], v[90:91], v[138:139]
    s_waitcnt vmcnt(9)
    v_pk_add_f32 v[80:81], v[80:81], v[140:141]
    v_pk_add_f32 v[82:83], v[82:83], v[142:143]
    v_pk_add_f32 v[84:85], v[84:85], v[144:145]
    v_pk_add_f32 v[86:87], v[86:87], v[146:147]
    v_pk_add_f32 v[88:89], v[88:89], v[148:149]
    v_pk_add_f32 v[90:91], v[90:91], v[150:151]
    s_waitcnt vmcnt(6)
    v_pk_add_f32 v[80:81], v[80:81], v[152:153]
    v_pk_add_f32 v[82:83], v[82:83], v[154:155]
    v_pk_add_f32 v[84:85], v[84:85], v[156:157]
    v_pk_add_f32 v[86:87], v[86:87], v[158:159]
    v_pk_add_f32 v[88:89], v[88:89], v[160:161]
    v_pk_add_f32 v[90:91], v[90:91], v[162:163]
    s_waitcnt vmcnt(3)
    v_pk_add_f32 v[80:81], v[80:81], v[164:165]
    v_pk_add_f32 v[82:83], v[82:83], v[166:167]
    v_pk_add_f32 v[84:85], v[84:85], v[168:169]
    v_pk_add_f32 v[86:87], v[86:87], v[170:171]
    v_pk_add_f32 v[88:89], v[88:89], v[172:173]
    v_pk_add_f32 v[90:91], v[90:91], v[174:175]
    v_cmp_gt_u32 vcc, 16, v1
    v_cvt_pk_bf16_f32 v16, v80, v81
    v_cvt_pk_bf16_f32 v17, v82, v83
    v_cvt_pk_bf16_f32 v18, v88, v89
    v_cndmask_b32 v18, 0, v18, vcc
    v_mov_b32 v19, 0
    v_cvt_pk_bf16_f32 v20, v84, v85
    v_cvt_pk_bf16_f32 v21, v86, v87
    v_cvt_pk_bf16_f32 v22, v90, v91
    v_cndmask_b32 v22, 0, v22, vcc
    v_mov_b32 v23, 0
    s_lshl_b32 s73, s21, 11
    s_add_u32 s73, s73, 22282240
    buffer_store_dwordx4 v[16:19], v14, s[44:47], s73 offen sc1
    buffer_store_dwordx4 v[20:23], v14, s[44:47], s73 offen offset:1024 sc1
L_k1_fin:
L_phase2:
    s_setprio 0
    s_waitcnt vmcnt(0) lgkmcnt(0)
    s_barrier
    s_mov_b32 s48, s16
    s_mov_b32 s49, s17
    s_mov_b32 s50, 256
    s_mov_b32 s51, 0x20000
    v_mov_b32 v12, 252
L_f_tag:
    s_nop 0
    s_cmp_lg_u32 s3, 0
    s_cbranch_scc1 L_f_tagok
    buffer_load_dword v11, v12, s[48:51], 0 offen sc1
    s_waitcnt vmcnt(0)
    v_readfirstlane_b32 s3, v11
    s_branch L_f_tag
L_f_tagok:
    s_mov_b32 s85, s3
    s_cmp_lg_u32 s83, 1
    s_cbranch_scc1 L_f_nokvf
    v_mov_b32 v11, s3
    s_lshl_b32 s25, s21, 7
    s_add_u32 s25, s25, 22365184
    v_mov_b32 v12, 0
    s_mov_b64 exec, 1
    buffer_store_dword v11, v12, s[44:47], s25 offen sc1
    s_mov_b64 exec, -1
L_f_nokvf:
    s_cmp_lg_u32 s22, 0
    s_cbranch_scc1 L_f_nosig
    v_mov_b32 v11, s3
    s_lshl_b32 s25, s20, 5
    s_add_u32 s25, s25, s21
    s_lshl_b32 s25, s25, 2
    s_add_u32 s25, s25, 22364160
    v_mov_b32 v12, 0
    s_mov_b64 exec, 1
    buffer_store_dword v11, v12, s[44:47], s25 offen sc1
    s_mov_b64 exec, -1
L_f_nosig:
    s_load_dwordx2 s[4:5], s[0:1], 48
    s_load_dwordx2 s[6:7], s[0:1], 16
    s_load_dwordx2 s[18:19], s[0:1], 80
    s_and_b32 s20, s2, 7
    s_lshr_b32 s26, s2, 3
    s_and_b32 s21, s26, 3
    s_lshr_b32 s23, s26, 2
    s_lshl_b32 s24, s23, 4
    s_lshl_b32 s25, s22, 1
    s_add_u32 s24, s24, s25
    v_lshlrev_b32 v4, 4, v1
    s_lshl_b32 s62, s22, 1
    s_lshl_b32 s25, s62, 6
    v_add_u32 v11, s25, v1
    v_mul_u32_u24 v12, 3641, v11
    v_lshrrev_b32 v12, 16, v12
    v_mul_u32_u24 v13, 18, v12
    v_sub_u32 v13, v11, v13
    v_mul_u32_u24 v12, 1152, v12
    v_lshl_add_u32 v12, v13, 4, v12
    s_mul_i32 s25, s21, 288
    v_add_u32 v2, s25, v12
    s_add_u32 s63, s62, 1
    s_lshl_b32 s25, s63, 6
    v_add_u32 v11, s25, v1
    v_mul_u32_u24 v12, 3641, v11
    v_lshrrev_b32 v12, 16, v12
    v_mul_u32_u24 v13, 18, v12
    v_sub_u32 v13, v11, v13
    v_mul_u32_u24 v12, 1152, v12
    v_lshl_add_u32 v12, v13, 4, v12
    s_mul_i32 s25, s21, 288
    v_add_u32 v3, s25, v12
    s_and_b32 s64, s22, 1
    s_add_u32 s64, s64, 16
    s_lshl_b32 s25, s64, 6
    v_add_u32 v11, s25, v1
    v_mul_u32_u24 v12, 3641, v11
    v_lshrrev_b32 v12, 16, v12
    v_mul_u32_u24 v13, 18, v12
    v_sub_u32 v13, v11, v13
    v_mul_u32_u24 v12, 1152, v12
    v_lshl_add_u32 v12, v13, 4, v12
    s_mul_i32 s25, s21, 288
    v_add_u32 v6, s25, v12
    s_mul_i32 s52, s20, 663552
    s_lshl_b32 s59, s22, 11
    s_lshl_b32 s64, s64, 10
    s_lshr_b32 s65, s22, 1
    v_add_u32 v5, 147456, v4
    s_mul_i32 s53, s24, 144
    s_mul_i32 s25, s20, 18
    s_add_u32 s53, s53, s25
    s_lshl_b32 s53, s53, 10
    s_add_u32 s68, s52, 663552
    s_add_u32 s69, s53, 18432
    s_lshl_b32 s25, s21, 2
    s_lshr_b32 s25, 30000, s25
    s_and_b32 s25, s25, 15
    s_mul_i32 s26, s25, 73728
    s_add_u32 s52, s52, s26
    s_lshl_b32 s26, s25, 11
    s_add_u32 s53, s53, s26
    s_waitcnt lgkmcnt(0)
    s_mov_b32 s28, s4
    s_mov_b32 s29, s5
    s_mov_b32 s30, 5308416
    s_mov_b32 s31, 0x20000
    s_mov_b32 s44, s18
    s_mov_b32 s45, s19
    s_mov_b32 s46, 268435456
    s_mov_b32 s47, 0x20000
    s_cmp_lg_u32 s65, 0
    s_cbranch_scc1 L_k2_nx0_0
    s_add_u32 m0, s64, 0
    s_nop 0
    buffer_load_dwordx4 v6, s[28:31], s52 offen lds
L_k2_nx0_0:
    s_add_u32 m0, s59, 0
    s_nop 0
    buffer_load_dwordx4 v2, s[28:31], s52 offen lds
    buffer_load_dwordx4 v[64:67], v4, s[44:47], s53 offen offset:0 sc1
    buffer_load_dwordx4 v[68:71], v5, s[44:47], s53 offen offset:0 sc1
    s_add_u32 m0, s59, 1024
    s_nop 0
    buffer_load_dwordx4 v3, s[28:31], s52 offen lds
    s_add_u32 s52, s52, 73728
    s_sub_u32 s54, s52, 663552
    s_cmp_eq_u32 s52, s68
    s_cselect_b32 s52, s54, s52
    buffer_load_dwordx4 v[72:75], v4, s[44:47], s53 offen offset:1024 sc1
    buffer_load_dwordx4 v[76:79], v5, s[44:47], s53 offen offset:1024 sc1
    s_add_u32 s53, s53, 2048
    s_sub_u32 s54, s53, 18432
    s_cmp_eq_u32 s53, s69
    s_cselect_b32 s53, s54, s53
    s_cmp_lg_u32 s65, 1
    s_cbranch_scc1 L_k2_nx1_0
    s_add_u32 m0, s64, 18432
    s_nop 0
    buffer_load_dwordx4 v6, s[28:31], s52 offen lds
L_k2_nx1_0:
    s_add_u32 m0, s59, 18432
    s_nop 0
    buffer_load_dwordx4 v2, s[28:31], s52 offen lds
    s_add_u32 m0, s59, 19456
    s_nop 0
    buffer_load_dwordx4 v3, s[28:31], s52 offen lds
    s_add_u32 s52, s52, 73728
    s_sub_u32 s54, s52, 663552
    s_cmp_eq_u32 s52, s68
    s_cselect_b32 s52, s54, s52
    s_mov_b32 s32, s6
    s_mov_b32 s33, s7
    s_mov_b32 s34, 663552
    s_mov_b32 s35, 0x20000
    v_lshrrev_b32 v11, 4, v1
    v_bfe_u32 v12, v1, 2, 2
    v_lshl_add_u32 v11, v11, 2, v12
    v_mul_u32_u24 v11, 288, v11
    v_and_b32 v13, 3, v1
    v_lshl_add_u32 v7, v13, 3, v11
    v_add_u32 v8, 55296, v7
    v_add_u32 v12, 16, v12
    v_mul_u32_u24 v12, 288, v12
    v_lshl_add_u32 v57, v13, 3, v12
    v_add_u32 v57, 92160, v57
    v_add_u32 v56, 92160, v7
    v_add_u32 v58, 113664, v4
    v_and_b32 v11, 15, v1
    v_lshlrev_b32 v14, 2, v11
    v_lshlrev_b32 v15, 3, v1
    v_lshrrev_b32 v13, 4, v1
    v_cmp_eq_u32 s[80:81], 1, v13
    s_lshl_b32 s27, s20, 2
    s_lshl_b32 s72, s24, 4
    s_add_u32 s72, s72, s27
    s_lshl_b32 s72, s72, 10
    s_add_u32 s72, s72, 18874368
    s_add_u32 s74, s27, s22
    s_lshl_b32 s74, s74, 13
    s_lshl_b32 s25, s23, 10
    s_add_u32 s74, s74, s25
    s_add_u32 s74, s74, 20971520
    s_and_b32 s75, s22, 1
    s_lshl_b32 s75, s75, 13
    s_add_u32 s75, s75, s25
    s_add_u32 s75, s75, 22347776
    s_cmp_ge_u32 s22, 4
    s_cselect_b32 s74, s75, s74
    s_and_b32 s75, s22, 1
    s_add_u32 s75, s75, 4
    s_cmp_ge_u32 s22, 4
    s_cselect_b32 s75, s75, s22
    s_lshl_b32 s75, s75, 10
    s_add_u32 s75, s75, 121856
    s_lshl_b32 s25, s22, 7
    s_add_u32 s25, s25, 121856
    v_add_u32 v59, s25, v14
    v_cmp_gt_u32 s[82:83], 16, v1
    s_mov_b32 s79, 0x358637bd
    s_mul_i32 s77, s27, 20736
    s_lshl_b32 s78, s27, 11
    s_lshl_b32 s25, s22, 10
    s_add_u32 s78, s78, s25
    s_add_u32 s78, s78, 22282240
    s_add_u32 s67, s22, 16
    s_min_u32 s67, s67, 20
    s_lshl_b32 s25, s67, 6
    v_add_u32 v11, s25, v1
    v_mul_u32_u24 v12, 3641, v11
    v_lshrrev_b32 v12, 16, v12
    v_mul_u32_u24 v13, 18, v12
    v_sub_u32 v13, v11, v13
    v_mul_u32_u24 v12, 1152, v12
    v_lshl_add_u32 v12, v13, 4, v12
    s_mul_i32 s25, s21, 288
    v_add_u32 v62, s25, v12
    v_mov_b32 v203, 0
    v_mov_b32 v207, 0
    v_mov_b32 v211, 0
    v_mov_b32 v215, 0
    v_mov_b32 v219, 0
    v_mov_b32 v223, 0
    v_mov_b32 v227, 0
    v_mov_b32 v231, 0
    s_cmp_ge_u32 s22, 4
    s_cbranch_scc1 L_k2_ph1
    s_cmp_lg_u32 s22, 0
    s_cbranch_scc1 L_f_doneg
    s_lshl_b32 s25, s23, 5
    s_lshl_b32 s26, s20, 2
    s_add_u32 s25, s25, s26
    s_lshl_b32 s25, s25, 2
    s_add_u32 s25, s25, 22364160
    v_lshl_add_u32 v11, v1, 2, s25
    s_mov_b32 s84, 262144
    s_mov_b32 s86, 15
    s_mov_b32 s87, 0
    s_mov_b64 exec, s[86:87]
L_f_pollg:
    buffer_load_dword v13, v11, s[44:47], 0 offen sc1
    s_waitcnt vmcnt(0)
    v_cmp_ne_u32 vcc, s85, v13
    s_sub_u32 s84, s84, 1
    s_cmp_eq_u32 s84, 0
    s_cbranch_scc1 L_f_outg
    s_cbranch_vccz L_f_outg
    s_sleep 2
    s_branch L_f_pollg
L_f_outg:
    s_mov_b64 exec, -1
L_f_doneg:
    s_waitcnt vmcnt(4)
    s_barrier
    buffer_load_dwordx4 v[80:83], v4, s[44:47], s53 offen offset:0 sc1
    buffer_load_dwordx4 v[84:87], v5, s[44:47], s53 offen offset:0 sc1
    buffer_load_dwordx4 v[88:91], v4, s[44:47], s53 offen offset:1024 sc1
    buffer_load_dwordx4 v[92:95], v5, s[44:47], s53 offen offset:1024 sc1
    s_add_u32 s53, s53, 2048
    s_sub_u32 s54, s53, 18432
    s_cmp_eq_u32 s53, s69
    s_cselect_b32 s53, s54, s53
    ds_read_b64_tr_b16 v[16:17], v7 offset:0
    ds_read_b64_tr_b16 v[18:19], v7 offset:4608
    ds_read_b64_tr_b16 v[20:21], v7 offset:32
    ds_read_b64_tr_b16 v[22:23], v7 offset:4640
    ds_read_b64_tr_b16 v[24:25], v7 offset:64
    ds_read_b64_tr_b16 v[26:27], v7 offset:4672
    s_waitcnt vmcnt(4)
    s_barrier
    ds_read_b64_tr_b16 v[28:29], v7 offset:96
    ds_read_b64_tr_b16 v[30:31], v7 offset:4704
    s_waitcnt lgkmcnt(6)
    v_mfma_f32_16x16x32_bf16 v[128:131], v[16:19], v[64:67], 0
    v_mfma_f32_16x16x32_bf16 v[164:167], v[16:19], v[68:71], 0
    ds_read_b64_tr_b16 v[16:17], v7 offset:128
    ds_read_b64_tr_b16 v[18:19], v7 offset:4736
    s_waitcnt lgkmcnt(6)
    v_mfma_f32_16x16x32_bf16 v[132:135], v[20:23], v[64:67], 0
    v_mfma_f32_16x16x32_bf16 v[168:171], v[20:23], v[68:71], 0
    s_cmp_lg_u32 s65, 2
    s_cbranch_scc1 L_k2_nx2_0
    s_add_u32 m0, s64, 36864
    s_nop 0
    buffer_load_dwordx4 v6, s[28:31], s52 offen lds
L_k2_nx2_0:
    s_add_u32 m0, s59, 36864
    s_nop 0
    buffer_load_dwordx4 v2, s[28:31], s52 offen lds
    ds_read_b64_tr_b16 v[20:21], v7 offset:160
    ds_read_b64_tr_b16 v[22:23], v7 offset:4768
    s_waitcnt lgkmcnt(6)
    v_mfma_f32_16x16x32_bf16 v[136:139], v[24:27], v[64:67], 0
    v_mfma_f32_16x16x32_bf16 v[172:175], v[24:27], v[68:71], 0
    ds_read_b64_tr_b16 v[24:25], v7 offset:192
    ds_read_b64_tr_b16 v[26:27], v7 offset:4800
    s_waitcnt lgkmcnt(6)
    v_mfma_f32_16x16x32_bf16 v[140:143], v[28:31], v[64:67], 0
    v_mfma_f32_16x16x32_bf16 v[176:179], v[28:31], v[68:71], 0
    s_add_u32 m0, s59, 37888
    s_nop 0
    buffer_load_dwordx4 v3, s[28:31], s52 offen lds
    s_add_u32 s52, s52, 73728
    s_sub_u32 s54, s52, 663552
    s_cmp_eq_u32 s52, s68
    s_cselect_b32 s52, s54, s52
    ds_read_b64_tr_b16 v[28:29], v7 offset:224
    ds_read_b64_tr_b16 v[30:31], v7 offset:4832
    s_waitcnt lgkmcnt(6)
    v_mfma_f32_16x16x32_bf16 v[144:147], v[16:19], v[64:67], 0
    v_mfma_f32_16x16x32_bf16 v[180:183], v[16:19], v[68:71], 0
    ds_read_b64_tr_b16 v[16:17], v7 offset:256
    ds_read_b64_tr_b16 v[18:19], v7 offset:4864
    s_waitcnt lgkmcnt(6)
    v_mfma_f32_16x16x32_bf16 v[148:151], v[20:23], v[64:67], 0
    v_mfma_f32_16x16x32_bf16 v[184:187], v[20:23], v[68:71], 0
    buffer_load_dwordx4 v[96:99], v4, s[44:47], s53 offen offset:0 sc1
    buffer_load_dwordx4 v[100:103], v5, s[44:47], s53 offen offset:0 sc1
    ds_read_b64_tr_b16 v[20:21], v7 offset:9216
    ds_read_b64_tr_b16 v[22:23], v7 offset:13824
    s_waitcnt lgkmcnt(6)
    v_mfma_f32_16x16x32_bf16 v[152:155], v[24:27], v[64:67], 0
    v_mfma_f32_16x16x32_bf16 v[188:191], v[24:27], v[68:71], 0
    ds_read_b64_tr_b16 v[24:25], v7 offset:9248
    ds_read_b64_tr_b16 v[26:27], v7 offset:13856
    s_waitcnt lgkmcnt(6)
    v_mfma_f32_16x16x32_bf16 v[156:159], v[28:31], v[64:67], 0
    v_mfma_f32_16x16x32_bf16 v[192:195], v[28:31], v[68:71], 0
    buffer_load_dwordx4 v[104:107], v4, s[44:47], s53 offen offset:1024 sc1
    buffer_load_dwordx4 v[108:111], v5, s[44:47], s53 offen offset:1024 sc1
    s_add_u32 s53, s53, 2048
    s_sub_u32 s54, s53, 18432
    s_cmp_eq_u32 s53, s69
    s_cselect_b32 s53, s54, s53
    ds_read_b64_tr_b16 v[28:29], v7 offset:9280
    ds_read_b64_tr_b16 v[30:31], v7 offset:13888
    s_waitcnt lgkmcnt(6)
    v_mfma_f32_16x16x32_bf16 v[160:163], v[16:19], v[64:67], 0
    v_mfma_f32_16x16x32_bf16 v[196:199], v[16:19], v[68:71], 0
    ds_read_b64_tr_b16 v[16:17], v7 offset:9312
    ds_read_b64_tr_b16 v[18:19], v7 offset:13920
    s_waitcnt lgkmcnt(6)
    v_mfma_f32_16x16x32_bf16 v[128:131], v[20:23], v[72:75], v[128:131]
    v_mfma_f32_16x16x32_bf16 v[164:167], v[20:23], v[76:79], v[164:167]
    s_cmp_lg_u32 s65, 3
    s_cbranch_scc1 L_k2_nx3_0
    s_add_u32 m0, s64, 55296
    s_nop 0
    buffer_load_dwordx4 v6, s[28:31], s52 offen lds
L_k2_nx3_0:
    s_add_u32 m0, s59, 55296
    s_nop 0
    buffer_load_dwordx4 v2, s[28:31], s52 offen lds
    ds_read_b64_tr_b16 v[20:21], v7 offset:9344
    ds_read_b64_tr_b16 v[22:23], v7 offset:13952
    s_waitcnt lgkmcnt(6)
    v_mfma_f32_16x16x32_bf16 v[132:135], v[24:27], v[72:75], v[132:135]
    v_mfma_f32_16x16x32_bf16 v[168:171], v[24:27], v[76:79], v[168:171]
    ds_read_b64_tr_b16 v[24:25], v7 offset:9376
    ds_read_b64_tr_b16 v[26:27], v7 offset:13984
    s_waitcnt lgkmcnt(6)
    v_mfma_f32_16x16x32_bf16 v[136:139], v[28:31], v[72:75], v[136:139]
    v_mfma_f32_16x16x32_bf16 v[172:175], v[28:31], v[76:79], v[172:175]
    s_add_u32 m0, s59, 56320
    s_nop 0
    buffer_load_dwordx4 v3, s[28:31], s52 offen lds
    s_add_u32 s52, s52, 73728
    s_sub_u32 s54, s52, 663552
    s_cmp_eq_u32 s52, s68
    s_cselect_b32 s52, s54, s52
    ds_read_b64_tr_b16 v[28:29], v7 offset:9408
    ds_read_b64_tr_b16 v[30:31], v7 offset:14016
    s_waitcnt lgkmcnt(6)
    v_mfma_f32_16x16x32_bf16 v[140:143], v[16:19], v[72:75], v[140:143]
    v_mfma_f32_16x16x32_bf16 v[176:179], v[16:19], v[76:79], v[176:179]
    ds_read_b64_tr_b16 v[16:17], v7 offset:9440
    ds_read_b64_tr_b16 v[18:19], v7 offset:14048
    s_waitcnt lgkmcnt(6)
    v_mfma_f32_16x16x32_bf16 v[144:147], v[20:23], v[72:75], v[144:147]
    v_mfma_f32_16x16x32_bf16 v[180:183], v[20:23], v[76:79], v[180:183]
    ds_read_b64_tr_b16 v[20:21], v7 offset:9472
    ds_read_b64_tr_b16 v[22:23], v7 offset:14080
    s_waitcnt lgkmcnt(6)
    v_mfma_f32_16x16x32_bf16 v[148:151], v[24:27], v[72:75], v[148:151]
    v_mfma_f32_16x16x32_bf16 v[184:187], v[24:27], v[76:79], v[184:187]
    ds_read_b64_tr_b16 v[24:25], v7 offset:18432
    ds_read_b64_tr_b16 v[26:27], v7 offset:23040
    s_waitcnt lgkmcnt(6)
    v_mfma_f32_16x16x32_bf16 v[152:155], v[28:31], v[72:75], v[152:155]
    v_mfma_f32_16x16x32_bf16 v[188:191], v[28:31], v[76:79], v[188:191]
    ds_read_b64_tr_b16 v[28:29], v7 offset:18464
    ds_read_b64_tr_b16 v[30:31], v7 offset:23072
    s_waitcnt lgkmcnt(6)
    v_mfma_f32_16x16x32_bf16 v[156:159], v[16:19], v[72:75], v[156:159]
    v_mfma_f32_16x16x32_bf16 v[192:195], v[16:19], v[76:79], v[192:195]
    ds_read_b64_tr_b16 v[16:17], v7 offset:18496
    ds_read_b64_tr_b16 v[18:19], v7 offset:23104
    s_waitcnt lgkmcnt(6)
    v_mfma_f32_16x16x32_bf16 v[160:163], v[20:23], v[72:75], v[160:163]
    v_mfma_f32_16x16x32_bf16 v[196:199], v[20:23], v[76:79], v[196:199]
    s_waitcnt vmcnt(6)
    s_barrier
    ds_read_b64_tr_b16 v[20:21], v7 offset:18528
    ds_read_b64_tr_b16 v[22:23], v7 offset:23136
    s_waitcnt lgkmcnt(6)
    v_mfma_f32_16x16x32_bf16 v[128:131], v[24:27], v[80:83], v[128:131]
    v_mfma_f32_16x16x32_bf16 v[164:167], v[24:27], v[84:87], v[164:167]
    ds_read_b64_tr_b16 v[24:25], v7 offset:18560
    ds_read_b64_tr_b16 v[26:27], v7 offset:23168
    s_waitcnt lgkmcnt(6)
    v_mfma_f32_16x16x32_bf16 v[132:135], v[28:31], v[80:83], v[132:135]
    v_mfma_f32_16x16x32_bf16 v[168:171], v[28:31], v[84:87], v[168:171]
    buffer_load_dwordx4 v[112:115], v4, s[44:47], s53 offen offset:0 sc1
    buffer_load_dwordx4 v[116:119], v5, s[44:47], s53 offen offset:0 sc1
    ds_read_b64_tr_b16 v[28:29], v7 offset:18592
    ds_read_b64_tr_b16 v[30:31], v7 offset:23200
    s_waitcnt lgkmcnt(6)
    v_mfma_f32_16x16x32_bf16 v[136:139], v[16:19], v[80:83], v[136:139]
    v_mfma_f32_16x16x32_bf16 v[172:175], v[16:19], v[84:87], v[172:175]
    ds_read_b64_tr_b16 v[16:17], v7 offset:18624
    ds_read_b64_tr_b16 v[18:19], v7 offset:23232
    s_waitcnt lgkmcnt(6)
    v_mfma_f32_16x16x32_bf16 v[140:143], v[20:23], v[80:83], v[140:143]
    v_mfma_f32_16x16x32_bf16 v[176:179], v[20:23], v[84:87], v[176:179]
    buffer_load_dwordx4 v[120:123], v4, s[44:47], s53 offen offset:1024 sc1
    buffer_load_dwordx4 v[124:127], v5, s[44:47], s53 offen offset:1024 sc1
    s_add_u32 s53, s53, 2048
    s_sub_u32 s54, s53, 18432
    s_cmp_eq_u32 s53, s69
    s_cselect_b32 s53, s54, s53
    ds_read_b64_tr_b16 v[20:21], v7 offset:18656
    ds_read_b64_tr_b16 v[22:23], v7 offset:23264
    s_waitcnt lgkmcnt(6)
    v_mfma_f32_16x16x32_bf16 v[144:147], v[24:27], v[80:83], v[144:147]
    v_mfma_f32_16x16x32_bf16 v[180:183], v[24:27], v[84:87], v[180:183]
    ds_read_b64_tr_b16 v[24:25], v7 offset:18688
    ds_read_b64_tr_b16 v[26:27], v7 offset:23296
    s_waitcnt lgkmcnt(6)
    v_mfma_f32_16x16x32_bf16 v[148:151], v[28:31], v[80:83], v[148:151]
    v_mfma_f32_16x16x32_bf16 v[184:187], v[28:31], v[84:87], v[184:187]
    s_cmp_lg_u32 s65, 0
    s_cbranch_scc1 L_k2_nx4_0
    s_add_u32 m0, s64, 73728
    s_nop 0
    buffer_load_dwordx4 v6, s[28:31], s52 offen lds
L_k2_nx4_0:
    s_add_u32 m0, s59, 73728
    s_nop 0
    buffer_load_dwordx4 v2, s[28:31], s52 offen lds
    ds_read_b64_tr_b16 v[28:29], v7 offset:27648
    ds_read_b64_tr_b16 v[30:31], v7 offset:32256
    s_waitcnt lgkmcnt(6)
    v_mfma_f32_16x16x32_bf16 v[152:155], v[16:19], v[80:83], v[152:155]
    v_mfma_f32_16x16x32_bf16 v[188:191], v[16:19], v[84:87], v[188:191]
    ds_read_b64_tr_b16 v[16:17], v7 offset:27680
    ds_read_b64_tr_b16 v[18:19], v7 offset:32288
    s_waitcnt lgkmcnt(6)
    v_mfma_f32_16x16x32_bf16 v[156:159], v[20:23], v[80:83], v[156:159]
    v_mfma_f32_16x16x32_bf16 v[192:195], v[20:23], v[84:87], v[192:195]
    s_add_u32 m0, s59, 74752
    s_nop 0
    buffer_load_dwordx4 v3, s[28:31], s52 offen lds
    s_add_u32 s52, s52, 73728
    s_sub_u32 s54, s52, 663552
    s_cmp_eq_u32 s52, s68
    s_cselect_b32 s52, s54, s52
    ds_read_b64_tr_b16 v[20:21], v7 offset:27712
    ds_read_b64_tr_b16 v[22:23], v7 offset:32320
    s_waitcnt lgkmcnt(6)
    v_mfma_f32_16x16x32_bf16 v[160:163], v[24:27], v[80:83], v[160:163]
    v_mfma_f32_16x16x32_bf16 v[196:199], v[24:27], v[84:87], v[196:199]
    ds_read_b64_tr_b16 v[24:25], v7 offset:27744
    ds_read_b64_tr_b16 v[26:27], v7 offset:32352
    s_waitcnt lgkmcnt(6)
    v_mfma_f32_16x16x32_bf16 v[128:131], v[28:31], v[88:91], v[128:131]
    v_mfma_f32_16x16x32_bf16 v[164:167], v[28:31], v[92:95], v[164:167]
    ds_read_b64_tr_b16 v[28:29], v7 offset:27776
    ds_read_b64_tr_b16 v[30:31], v7 offset:32384
    s_waitcnt lgkmcnt(6)
    v_mfma_f32_16x16x32_bf16 v[132:135], v[16:19], v[88:91], v[132:135]
    v_mfma_f32_16x16x32_bf16 v[168:171], v[16:19], v[92:95], v[168:171]
    ds_read_b64_tr_b16 v[16:17], v7 offset:27808
    ds_read_b64_tr_b16 v[18:19], v7 offset:32416
    s_waitcnt lgkmcnt(6)
    v_mfma_f32_16x16x32_bf16 v[136:139], v[20:23], v[88:91], v[136:139]
    v_mfma_f32_16x16x32_bf16 v[172:175], v[20:23], v[92:95], v[172:175]
    ds_read_b64_tr_b16 v[20:21], v7 offset:27840
    ds_read_b64_tr_b16 v[22:23], v7 offset:32448
    s_waitcnt lgkmcnt(6)
    v_mfma_f32_16x16x32_bf16 v[140:143], v[24:27], v[88:91], v[140:143]
    v_mfma_f32_16x16x32_bf16 v[176:179], v[24:27], v[92:95], v[176:179]
    ds_read_b64_tr_b16 v[24:25], v7 offset:27872
    ds_read_b64_tr_b16 v[26:27], v7 offset:32480
    s_waitcnt lgkmcnt(6)
    v_mfma_f32_16x16x32_bf16 v[144:147], v[28:31], v[88:91], v[144:147]
    v_mfma_f32_16x16x32_bf16 v[180:183], v[28:31], v[92:95], v[180:183]
    ds_read_b64_tr_b16 v[28:29], v7 offset:27904
    ds_read_b64_tr_b16 v[30:31], v7 offset:32512
    s_waitcnt lgkmcnt(6)
    v_mfma_f32_16x16x32_bf16 v[148:151], v[16:19], v[88:91], v[148:151]
    v_mfma_f32_16x16x32_bf16 v[184:187], v[16:19], v[92:95], v[184:187]
    ds_read_b64_tr_b16 v[16:17], v7 offset:36864
    ds_read_b64_tr_b16 v[18:19], v7 offset:41472
    s_waitcnt lgkmcnt(6)
    v_mfma_f32_16x16x32_bf16 v[152:155], v[20:23], v[88:91], v[152:155]
    v_mfma_f32_16x16x32_bf16 v[188:191], v[20:23], v[92:95], v[188:191]
    ds_read_b64_tr_b16 v[20:21], v7 offset:36896
    ds_read_b64_tr_b16 v[22:23], v7 offset:41504
    s_waitcnt lgkmcnt(6)
    v_mfma_f32_16x16x32_bf16 v[156:159], v[24:27], v[88:91], v[156:159]
    v_mfma_f32_16x16x32_bf16 v[192:195], v[24:27], v[92:95], v[192:195]
    ds_read_b64_tr_b16 v[24:25], v7 offset:36928
    ds_read_b64_tr_b16 v[26:27], v7 offset:41536
    s_waitcnt lgkmcnt(6)
    v_mfma_f32_16x16x32_bf16 v[160:163], v[28:31], v[88:91], v[160:163]
    v_mfma_f32_16x16x32_bf16 v[196:199], v[28:31], v[92:95], v[196:199]
    s_waitcnt vmcnt(6)
    s_barrier
    ds_read_b64_tr_b16 v[28:29], v7 offset:36960
    ds_read_b64_tr_b16 v[30:31], v7 offset:41568
    s_waitcnt lgkmcnt(6)
    v_mfma_f32_16x16x32_bf16 v[128:131], v[16:19], v[96:99], v[128:131]
    v_mfma_f32_16x16x32_bf16 v[164:167], v[16:19], v[100:103], v[164:167]
    ds_read_b64_tr_b16 v[16:17], v7 offset:36992
    ds_read_b64_tr_b16 v[18:19], v7 offset:41600
    s_waitcnt lgkmcnt(6)
    v_mfma_f32_16x16x32_bf16 v[132:135], v[20:23], v[96:99], v[132:135]
    v_mfma_f32_16x16x32_bf16 v[168:171], v[20:23], v[100:103], v[168:171]
    buffer_load_dwordx4 v[64:67], v4, s[44:47], s53 offen offset:0 sc1
    buffer_load_dwordx4 v[68:71], v5, s[44:47], s53 offen offset:0 sc1
    ds_read_b64_tr_b16 v[20:21], v7 offset:37024
    ds_read_b64_tr_b16 v[22:23], v7 offset:41632
    s_waitcnt lgkmcnt(6)
    v_mfma_f32_16x16x32_bf16 v[136:139], v[24:27], v[96:99], v[136:139]
    v_mfma_f32_16x16x32_bf16 v[172:175], v[24:27], v[100:103], v[172:175]
    ds_read_b64_tr_b16 v[24:25], v7 offset:37056
    ds_read_b64_tr_b16 v[26:27], v7 offset:41664
    s_waitcnt lgkmcnt(6)
    v_mfma_f32_16x16x32_bf16 v[140:143], v[28:31], v[96:99], v[140:143]
    v_mfma_f32_16x16x32_bf16 v[176:179], v[28:31], v[100:103], v[176:179]
    buffer_load_dwordx4 v[72:75], v4, s[44:47], s53 offen offset:1024 sc1
    buffer_load_dwordx4 v[76:79], v5, s[44:47], s53 offen offset:1024 sc1
    s_add_u32 s53, s53, 2048
    s_sub_u32 s54, s53, 18432
    s_cmp_eq_u32 s53, s69
    s_cselect_b32 s53, s54, s53
    ds_read_b64_tr_b16 v[28:29], v7 offset:37088
    ds_read_b64_tr_b16 v[30:31], v7 offset:41696
    s_waitcnt lgkmcnt(6)
    v_mfma_f32_16x16x32_bf16 v[144:147], v[16:19], v[96:99], v[144:147]
    v_mfma_f32_16x16x32_bf16 v[180:183], v[16:19], v[100:103], v[180:183]
    ds_read_b64_tr_b16 v[16:17], v7 offset:37120
    ds_read_b64_tr_b16 v[18:19], v7 offset:41728
    s_waitcnt lgkmcnt(6)
    v_mfma_f32_16x16x32_bf16 v[148:151], v[20:23], v[96:99], v[148:151]
    v_mfma_f32_16x16x32_bf16 v[184:187], v[20:23], v[100:103], v[184:187]
    s_cmp_lg_u32 s65, 1
    s_cbranch_scc1 L_k2_nx5_0
    s_add_u32 m0, s64, 0
    s_nop 0
    buffer_load_dwordx4 v6, s[28:31], s52 offen lds
L_k2_nx5_0:
    s_add_u32 m0, s59, 0
    s_nop 0
    buffer_load_dwordx4 v2, s[28:31], s52 offen lds
    ds_read_b64_tr_b16 v[20:21], v7 offset:46080
    ds_read_b64_tr_b16 v[22:23], v7 offset:50688
    s_waitcnt lgkmcnt(6)
    v_mfma_f32_16x16x32_bf16 v[152:155], v[24:27], v[96:99], v[152:155]
    v_mfma_f32_16x16x32_bf16 v[188:191], v[24:27], v[100:103], v[188:191]
    ds_read_b64_tr_b16 v[24:25], v7 offset:46112
    ds_read_b64_tr_b16 v[26:27], v7 offset:50720
    s_waitcnt lgkmcnt(6)
    v_mfma_f32_16x16x32_bf16 v[156:159], v[28:31], v[96:99], v[156:159]
    v_mfma_f32_16x16x32_bf16 v[192:195], v[28:31], v[100:103], v[192:195]
    s_add_u32 m0, s59, 1024
    s_nop 0
    buffer_load_dwordx4 v3, s[28:31], s52 offen lds
    s_add_u32 s52, s52, 73728
    s_sub_u32 s54, s52, 663552
    s_cmp_eq_u32 s52, s68
    s_cselect_b32 s52, s54, s52
    ds_read_b64_tr_b16 v[28:29], v7 offset:46144
    ds_read_b64_tr_b16 v[30:31], v7 offset:50752
    s_waitcnt lgkmcnt(6)
    v_mfma_f32_16x16x32_bf16 v[160:163], v[16:19], v[96:99], v[160:163]
    v_mfma_f32_16x16x32_bf16 v[196:199], v[16:19], v[100:103], v[196:199]
    ds_read_b64_tr_b16 v[16:17], v7 offset:46176
    ds_read_b64_tr_b16 v[18:19], v7 offset:50784
    s_waitcnt lgkmcnt(6)
    v_mfma_f32_16x16x32_bf16 v[128:131], v[20:23], v[104:107], v[128:131]
    v_mfma_f32_16x16x32_bf16 v[164:167], v[20:23], v[108:111], v[164:167]
    ds_read_b64_tr_b16 v[20:21], v7 offset:46208
    ds_read_b64_tr_b16 v[22:23], v7 offset:50816
    s_waitcnt lgkmcnt(6)
    v_mfma_f32_16x16x32_bf16 v[132:135], v[24:27], v[104:107], v[132:135]
    v_mfma_f32_16x16x32_bf16 v[168:171], v[24:27], v[108:111], v[168:171]
    ds_read_b64_tr_b16 v[24:25], v7 offset:46240
    ds_read_b64_tr_b16 v[26:27], v7 offset:50848
    s_waitcnt lgkmcnt(6)
    v_mfma_f32_16x16x32_bf16 v[136:139], v[28:31], v[104:107], v[136:139]
    v_mfma_f32_16x16x32_bf16 v[172:175], v[28:31], v[108:111], v[172:175]
    ds_read_b64_tr_b16 v[28:29], v7 offset:46272
    ds_read_b64_tr_b16 v[30:31], v7 offset:50880
    s_waitcnt lgkmcnt(6)
    v_mfma_f32_16x16x32_bf16 v[140:143], v[16:19], v[104:107], v[140:143]
    v_mfma_f32_16x16x32_bf16 v[176:179], v[16:19], v[108:111], v[176:179]
    ds_read_b64_tr_b16 v[16:17], v7 offset:46304
    ds_read_b64_tr_b16 v[18:19], v7 offset:50912
    s_waitcnt lgkmcnt(6)
    v_mfma_f32_16x16x32_bf16 v[144:147], v[20:23], v[104:107], v[144:147]
    v_mfma_f32_16x16x32_bf16 v[180:183], v[20:23], v[108:111], v[180:183]
    ds_read_b64_tr_b16 v[20:21], v7 offset:46336
    ds_read_b64_tr_b16 v[22:23], v7 offset:50944
    s_waitcnt lgkmcnt(6)
    v_mfma_f32_16x16x32_bf16 v[148:151], v[24:27], v[104:107], v[148:151]
    v_mfma_f32_16x16x32_bf16 v[184:187], v[24:27], v[108:111], v[184:187]
    ds_read_b64_tr_b16 v[24:25], v8 offset:0
    ds_read_b64_tr_b16 v[26:27], v8 offset:4608
    s_waitcnt lgkmcnt(6)
    v_mfma_f32_16x16x32_bf16 v[152:155], v[28:31], v[104:107], v[152:155]
    v_mfma_f32_16x16x32_bf16 v[188:191], v[28:31], v[108:111], v[188:191]
    ds_read_b64_tr_b16 v[28:29], v8 offset:32
    ds_read_b64_tr_b16 v[30:31], v8 offset:4640
    s_waitcnt lgkmcnt(6)
    v_mfma_f32_16x16x32_bf16 v[156:159], v[16:19], v[104:107], v[156:159]
    v_mfma_f32_16x16x32_bf16 v[192:195], v[16:19], v[108:111], v[192:195]
    ds_read_b64_tr_b16 v[16:17], v8 offset:64
    ds_read_b64_tr_b16 v[18:19], v8 offset:4672
    s_waitcnt lgkmcnt(6)
    v_mfma_f32_16x16x32_bf16 v[160:163], v[20:23], v[104:107], v[160:163]
    v_mfma_f32_16x16x32_bf16 v[196:199], v[20:23], v[108:111], v[196:199]
    s_waitcnt vmcnt(6)
    s_lshl_b32 s25, s23, 7
    s_add_u32 s25, s25, 22364160
    v_lshl_add_u32 v63, v1, 2, s25
    s_lshl_b32 s25, s20, 9
    s_add_u32 s25, s25, 22361088
    v_lshl_add_u32 v13, v1, 7, s25
    v_cmp_lt_u32 vcc, 31, v1
    s_nop 1
    v_cndmask_b32 v63, v63, v13, vcc
    v_min_u32 v13, 35, v1
    v_cmp_lt_u32 vcc, 35, v1
    v_mov_b32 v13, 22364160
    s_lshl_b32 s25, s23, 7
    v_add_u32 v13, s25, v13
    v_cndmask_b32 v63, v63, v13, vcc
    buffer_load_dword v248, v63, s[44:47], 0 offen sc1
    s_barrier
    ds_read_b64_tr_b16 v[20:21], v8 offset:96
    ds_read_b64_tr_b16 v[22:23], v8 offset:4704
    s_waitcnt lgkmcnt(6)
    v_mfma_f32_16x16x32_bf16 v[128:131], v[24:27], v[112:115], v[128:131]
    v_mfma_f32_16x16x32_bf16 v[164:167], v[24:27], v[116:119], v[164:167]
    ds_read_b64_tr_b16 v[24:25], v8 offset:128
    ds_read_b64_tr_b16 v[26:27], v8 offset:4736
    s_waitcnt lgkmcnt(6)
    v_mfma_f32_16x16x32_bf16 v[132:135], v[28:31], v[112:115], v[132:135]
    v_mfma_f32_16x16x32_bf16 v[168:171], v[28:31], v[116:119], v[168:171]
    buffer_load_dwordx4 v[80:83], v4, s[44:47], s53 offen offset:0 sc1
    buffer_load_dwordx4 v[84:87], v5, s[44:47], s53 offen offset:0 sc1
    ds_read_b64_tr_b16 v[28:29], v8 offset:160
    ds_read_b64_tr_b16 v[30:31], v8 offset:4768
    s_waitcnt lgkmcnt(6)
    v_mfma_f32_16x16x32_bf16 v[136:139], v[16:19], v[112:115], v[136:139]
    v_mfma_f32_16x16x32_bf16 v[172:175], v[16:19], v[116:119], v[172:175]
    ds_read_b64_tr_b16 v[16:17], v8 offset:192
    ds_read_b64_tr_b16 v[18:19], v8 offset:4800
    s_waitcnt lgkmcnt(6)
    v_mfma_f32_16x16x32_bf16 v[140:143], v[20:23], v[112:115], v[140:143]
    v_mfma_f32_16x16x32_bf16 v[176:179], v[20:23], v[116:119], v[176:179]
    buffer_load_dwordx4 v[88:91], v4, s[44:47], s53 offen offset:1024 sc1
    buffer_load_dwordx4 v[92:95], v5, s[44:47], s53 offen offset:1024 sc1
    s_add_u32 s53, s53, 2048
    s_sub_u32 s54, s53, 18432
    s_cmp_eq_u32 s53, s69
    s_cselect_b32 s53, s54, s53
    ds_read_b64_tr_b16 v[20:21], v8 offset:224
    ds_read_b64_tr_b16 v[22:23], v8 offset:4832
    s_waitcnt lgkmcnt(6)
    v_mfma_f32_16x16x32_bf16 v[144:147], v[24:27], v[112:115], v[144:147]
    v_mfma_f32_16x16x32_bf16 v[180:183], v[24:27], v[116:119], v[180:183]
    ds_read_b64_tr_b16 v[24:25], v8 offset:256
    ds_read_b64_tr_b16 v[26:27], v8 offset:4864
    s_waitcnt lgkmcnt(6)
    v_mfma_f32_16x16x32_bf16 v[148:151], v[28:31], v[112:115], v[148:151]
    v_mfma_f32_16x16x32_bf16 v[184:187], v[28:31], v[116:119], v[184:187]
    s_cmp_lg_u32 s65, 2
    s_cbranch_scc1 L_k2_nx6_0
    s_add_u32 m0, s64, 18432
    s_nop 0
    buffer_load_dwordx4 v6, s[28:31], s52 offen lds
L_k2_nx6_0:
    s_add_u32 m0, s59, 18432
    s_nop 0
    buffer_load_dwordx4 v2, s[28:31], s52 offen lds
    ds_read_b64_tr_b16 v[28:29], v8 offset:9216
    ds_read_b64_tr_b16 v[30:31], v8 offset:13824
    s_waitcnt lgkmcnt(6)
    v_mfma_f32_16x16x32_bf16 v[152:155], v[16:19], v[112:115], v[152:155]
    v_mfma_f32_16x16x32_bf16 v[188:191], v[16:19], v[116:119], v[188:191]
    ds_read_b64_tr_b16 v[16:17], v8 offset:9248
    ds_read_b64_tr_b16 v[18:19], v8 offset:13856
    s_waitcnt lgkmcnt(6)
    v_mfma_f32_16x16x32_bf16 v[156:159], v[20:23], v[112:115], v[156:159]
    v_mfma_f32_16x16x32_bf16 v[192:195], v[20:23], v[116:119], v[192:195]
    s_add_u32 m0, s59, 19456
    s_nop 0
    buffer_load_dwordx4 v3, s[28:31], s52 offen lds
    s_add_u32 s52, s52, 73728
    s_sub_u32 s54, s52, 663552
    s_cmp_eq_u32 s52, s68
    s_cselect_b32 s52, s54, s52
    ds_read_b64_tr_b16 v[20:21], v8 offset:9280
    ds_read_b64_tr_b16 v[22:23], v8 offset:13888
    s_waitcnt lgkmcnt(6)
    v_mfma_f32_16x16x32_bf16 v[160:163], v[24:27], v[112:115], v[160:163]
    v_mfma_f32_16x16x32_bf16 v[196:199], v[24:27], v[116:119], v[196:199]
    ds_read_b64_tr_b16 v[24:25], v8 offset:9312
    ds_read_b64_tr_b16 v[26:27], v8 offset:13920
    s_waitcnt lgkmcnt(6)
    v_mfma_f32_16x16x32_bf16 v[128:131], v[28:31], v[120:123], v[128:131]
    v_mfma_f32_16x16x32_bf16 v[164:167], v[28:31], v[124:127], v[164:167]
    ds_read_b64_tr_b16 v[28:29], v8 offset:9344
    ds_read_b64_tr_b16 v[30:31], v8 offset:13952
    s_waitcnt lgkmcnt(6)
    v_mfma_f32_16x16x32_bf16 v[132:135], v[16:19], v[120:123], v[132:135]
    v_mfma_f32_16x16x32_bf16 v[168:171], v[16:19], v[124:127], v[168:171]
    ds_read_b64_tr_b16 v[16:17], v8 offset:9376
    ds_read_b64_tr_b16 v[18:19], v8 offset:13984
    s_waitcnt lgkmcnt(6)
    v_mfma_f32_16x16x32_bf16 v[136:139], v[20:23], v[120:123], v[136:139]
    v_mfma_f32_16x16x32_bf16 v[172:175], v[20:23], v[124:127], v[172:175]
    ds_read_b64_tr_b16 v[20:21], v8 offset:9408
    ds_read_b64_tr_b16 v[22:23], v8 offset:14016
    s_waitcnt lgkmcnt(6)
    v_mfma_f32_16x16x32_bf16 v[140:143], v[24:27], v[120:123], v[140:143]
    v_mfma_f32_16x16x32_bf16 v[176:179], v[24:27], v[124:127], v[176:179]
    ds_read_b64_tr_b16 v[24:25], v8 offset:9440
    ds_read_b64_tr_b16 v[26:27], v8 offset:14048
    s_waitcnt lgkmcnt(6)
    v_mfma_f32_16x16x32_bf16 v[144:147], v[28:31], v[120:123], v[144:147]
    v_mfma_f32_16x16x32_bf16 v[180:183], v[28:31], v[124:127], v[180:183]
    ds_read_b64_tr_b16 v[28:29], v8 offset:9472
    ds_read_b64_tr_b16 v[30:31], v8 offset:14080
    s_waitcnt lgkmcnt(6)
    v_mfma_f32_16x16x32_bf16 v[148:151], v[16:19], v[120:123], v[148:151]
    v_mfma_f32_16x16x32_bf16 v[184:187], v[16:19], v[124:127], v[184:187]
    ds_read_b64_tr_b16 v[16:17], v8 offset:18432
    ds_read_b64_tr_b16 v[18:19], v8 offset:23040
    s_waitcnt lgkmcnt(6)
    v_mfma_f32_16x16x32_bf16 v[152:155], v[20:23], v[120:123], v[152:155]
    v_mfma_f32_16x16x32_bf16 v[188:191], v[20:23], v[124:127], v[188:191]
    ds_read_b64_tr_b16 v[20:21], v8 offset:18464
    ds_read_b64_tr_b16 v[22:23], v8 offset:23072
    s_waitcnt lgkmcnt(6)
    v_mfma_f32_16x16x32_bf16 v[156:159], v[24:27], v[120:123], v[156:159]
    v_mfma_f32_16x16x32_bf16 v[192:195], v[24:27], v[124:127], v[192:195]
    ds_read_b64_tr_b16 v[24:25], v8 offset:18496
    ds_read_b64_tr_b16 v[26:27], v8 offset:23104
    s_waitcnt lgkmcnt(6)
    v_mfma_f32_16x16x32_bf16 v[160:163], v[28:31], v[120:123], v[160:163]
    v_mfma_f32_16x16x32_bf16 v[196:199], v[28:31], v[124:127], v[196:199]
    s_waitcnt vmcnt(7)
    s_barrier
    ds_read_b64_tr_b16 v[28:29], v8 offset:18528
    ds_read_b64_tr_b16 v[30:31], v8 offset:23136
    s_waitcnt lgkmcnt(6)
    v_mfma_f32_16x16x32_bf16 v[128:131], v[16:19], v[64:67], v[128:131]
    v_mfma_f32_16x16x32_bf16 v[164:167], v[16:19], v[68:71], v[164:167]
    ds_read_b64_tr_b16 v[16:17], v8 offset:18560
    ds_read_b64_tr_b16 v[18:19], v8 offset:23168
    s_waitcnt lgkmcnt(6)
    v_mfma_f32_16x16x32_bf16 v[132:135], v[20:23], v[64:67], v[132:135]
    v_mfma_f32_16x16x32_bf16 v[168:171], v[20:23], v[68:71], v[168:171]
    buffer_load_dwordx4 v[96:99], v4, s[44:47], s53 offen offset:0 sc1
    buffer_load_dwordx4 v[100:103], v5, s[44:47], s53 offen offset:0 sc1
    ds_read_b64_tr_b16 v[20:21], v8 offset:18592
    ds_read_b64_tr_b16 v[22:23], v8 offset:23200
    s_waitcnt lgkmcnt(6)
    v_mfma_f32_16x16x32_bf16 v[136:139], v[24:27], v[64:67], v[136:139]
    v_mfma_f32_16x16x32_bf16 v[172:175], v[24:27], v[68:71], v[172:175]
    ds_read_b64_tr_b16 v[24:25], v8 offset:18624
    ds_read_b64_tr_b16 v[26:27], v8 offset:23232
    s_waitcnt lgkmcnt(6)
    v_mfma_f32_16x16x32_bf16 v[140:143], v[28:31], v[64:67], v[140:143]
    v_mfma_f32_16x16x32_bf16 v[176:179], v[28:31], v[68:71], v[176:179]
    buffer_load_dwordx4 v[104:107], v4, s[44:47], s53 offen offset:1024 sc1
    buffer_load_dwordx4 v[108:111], v5, s[44:47], s53 offen offset:1024 sc1
    s_add_u32 s53, s53, 2048
    s_sub_u32 s54, s53, 18432
    s_cmp_eq_u32 s53, s69
    s_cselect_b32 s53, s54, s53
    ds_read_b64_tr_b16 v[28:29], v8 offset:18656
    ds_read_b64_tr_b16 v[30:31], v8 offset:23264
    s_waitcnt lgkmcnt(6)
    v_mfma_f32_16x16x32_bf16 v[144:147], v[16:19], v[64:67], v[144:147]
    v_mfma_f32_16x16x32_bf16 v[180:183], v[16:19], v[68:71], v[180:183]
    ds_read_b64_tr_b16 v[16:17], v8 offset:18688
    ds_read_b64_tr_b16 v[18:19], v8 offset:23296
    s_waitcnt lgkmcnt(6)
    v_mfma_f32_16x16x32_bf16 v[148:151], v[20:23], v[64:67], v[148:151]
    v_mfma_f32_16x16x32_bf16 v[184:187], v[20:23], v[68:71], v[184:187]
    s_cmp_lg_u32 s65, 3
    s_cbranch_scc1 L_k2_nx7_0
    s_add_u32 m0, s64, 36864
    s_nop 0
    buffer_load_dwordx4 v6, s[28:31], s52 offen lds
L_k2_nx7_0:
    s_add_u32 m0, s59, 36864
    s_nop 0
    buffer_load_dwordx4 v2, s[28:31], s52 offen lds
    ds_read_b64_tr_b16 v[20:21], v8 offset:27648
    ds_read_b64_tr_b16 v[22:23], v8 offset:32256
    s_waitcnt lgkmcnt(6)
    v_mfma_f32_16x16x32_bf16 v[152:155], v[24:27], v[64:67], v[152:155]
    v_mfma_f32_16x16x32_bf16 v[188:191], v[24:27], v[68:71], v[188:191]
    ds_read_b64_tr_b16 v[24:25], v8 offset:27680
    ds_read_b64_tr_b16 v[26:27], v8 offset:32288
    s_waitcnt lgkmcnt(6)
    v_mfma_f32_16x16x32_bf16 v[156:159], v[28:31], v[64:67], v[156:159]
    v_mfma_f32_16x16x32_bf16 v[192:195], v[28:31], v[68:71], v[192:195]
    s_add_u32 m0, s59, 37888
    s_nop 0
    buffer_load_dwordx4 v3, s[28:31], s52 offen lds
    s_add_u32 s52, s52, 73728
    s_sub_u32 s54, s52, 663552
    s_cmp_eq_u32 s52, s68
    s_cselect_b32 s52, s54, s52
    ds_read_b64_tr_b16 v[28:29], v8 offset:27712
    ds_read_b64_tr_b16 v[30:31], v8 offset:32320
    s_waitcnt lgkmcnt(6)
    v_mfma_f32_16x16x32_bf16 v[160:163], v[16:19], v[64:67], v[160:163]
    v_mfma_f32_16x16x32_bf16 v[196:199], v[16:19], v[68:71], v[196:199]
    ds_read_b64_tr_b16 v[16:17], v8 offset:27744
    ds_read_b64_tr_b16 v[18:19], v8 offset:32352
    s_waitcnt lgkmcnt(6)
    v_mfma_f32_16x16x32_bf16 v[128:131], v[20:23], v[72:75], v[128:131]
    v_mfma_f32_16x16x32_bf16 v[164:167], v[20:23], v[76:79], v[164:167]
    ds_read_b64_tr_b16 v[20:21], v8 offset:27776
    ds_read_b64_tr_b16 v[22:23], v8 offset:32384
    s_waitcnt lgkmcnt(6)
    v_mfma_f32_16x16x32_bf16 v[132:135], v[24:27], v[72:75], v[132:135]
    v_mfma_f32_16x16x32_bf16 v[168:171], v[24:27], v[76:79], v[168:171]
    ds_read_b64_tr_b16 v[24:25], v8 offset:27808
    ds_read_b64_tr_b16 v[26:27], v8 offset:32416
    s_waitcnt lgkmcnt(6)
    v_mfma_f32_16x16x32_bf16 v[136:139], v[28:31], v[72:75], v[136:139]
    v_mfma_f32_16x16x32_bf16 v[172:175], v[28:31], v[76:79], v[172:175]
    ds_read_b64_tr_b16 v[28:29], v8 offset:27840
    ds_read_b64_tr_b16 v[30:31], v8 offset:32448
    s_waitcnt lgkmcnt(6)
    v_mfma_f32_16x16x32_bf16 v[140:143], v[16:19], v[72:75], v[140:143]
    v_mfma_f32_16x16x32_bf16 v[176:179], v[16:19], v[76:79], v[176:179]
    ds_read_b64_tr_b16 v[16:17], v8 offset:27872
    ds_read_b64_tr_b16 v[18:19], v8 offset:32480
    s_waitcnt lgkmcnt(6)
    v_mfma_f32_16x16x32_bf16 v[144:147], v[20:23], v[72:75], v[144:147]
    v_mfma_f32_16x16x32_bf16 v[180:183], v[20:23], v[76:79], v[180:183]
    ds_read_b64_tr_b16 v[20:21], v8 offset:27904
    ds_read_b64_tr_b16 v[22:23], v8 offset:32512
    s_waitcnt lgkmcnt(6)
    v_mfma_f32_16x16x32_bf16 v[148:151], v[24:27], v[72:75], v[148:151]
    v_mfma_f32_16x16x32_bf16 v[184:187], v[24:27], v[76:79], v[184:187]
    ds_read_b64_tr_b16 v[24:25], v7 offset:0
    ds_read_b64_tr_b16 v[26:27], v7 offset:4608
    s_waitcnt lgkmcnt(6)
    v_mfma_f32_16x16x32_bf16 v[152:155], v[28:31], v[72:75], v[152:155]
    v_mfma_f32_16x16x32_bf16 v[188:191], v[28:31], v[76:79], v[188:191]
    ds_read_b64_tr_b16 v[28:29], v7 offset:32
    ds_read_b64_tr_b16 v[30:31], v7 offset:4640
    s_waitcnt lgkmcnt(6)
    v_mfma_f32_16x16x32_bf16 v[156:159], v[16:19], v[72:75], v[156:159]
    v_mfma_f32_16x16x32_bf16 v[192:195], v[16:19], v[76:79], v[192:195]
    ds_read_b64_tr_b16 v[16:17], v7 offset:64
    ds_read_b64_tr_b16 v[18:19], v7 offset:4672
    s_waitcnt lgkmcnt(6)
    v_mfma_f32_16x16x32_bf16 v[160:163], v[20:23], v[72:75], v[160:163]
    v_mfma_f32_16x16x32_bf16 v[196:199], v[20:23], v[76:79], v[196:199]
    s_waitcnt vmcnt(6)
    s_mov_b32 s84, 0x40000
L_f_chk0:
    v_cmp_ne_u32 vcc, s3, v248
    s_sub_u32 s84, s84, 1
    s_cmp_eq_u32 s84, 0
    s_cbranch_scc1 L_f_ok0
    s_cbranch_vccz L_f_ok0
    s_sleep 2
    buffer_load_dword v248, v63, s[44:47], 0 offen sc1
    s_waitcnt vmcnt(0)
    s_branch L_f_chk0
L_f_ok0:
    s_barrier
    ds_read_b64_tr_b16 v[20:21], v7 offset:96
    ds_read_b64_tr_b16 v[22:23], v7 offset:4704
    s_waitcnt lgkmcnt(6)
    v_mfma_f32_16x16x32_bf16 v[128:131], v[24:27], v[80:83], v[128:131]
    v_mfma_f32_16x16x32_bf16 v[164:167], v[24:27], v[84:87], v[164:167]
    ds_read_b64_tr_b16 v[24:25], v7 offset:128
    ds_read_b64_tr_b16 v[26:27], v7 offset:4736
    s_waitcnt lgkmcnt(6)
    v_mfma_f32_16x16x32_bf16 v[132:135], v[28:31], v[80:83], v[132:135]
    v_mfma_f32_16x16x32_bf16 v[168:171], v[28:31], v[84:87], v[168:171]
    buffer_load_dwordx4 v[112:115], v4, s[44:47], s53 offen offset:0 sc1
    buffer_load_dwordx4 v[116:119], v5, s[44:47], s53 offen offset:0 sc1
    ds_read_b64_tr_b16 v[28:29], v7 offset:160
    ds_read_b64_tr_b16 v[30:31], v7 offset:4768
    s_waitcnt lgkmcnt(6)
    v_mfma_f32_16x16x32_bf16 v[136:139], v[16:19], v[80:83], v[136:139]
    v_mfma_f32_16x16x32_bf16 v[172:175], v[16:19], v[84:87], v[172:175]
    ds_read_b64_tr_b16 v[16:17], v7 offset:192
    ds_read_b64_tr_b16 v[18:19], v7 offset:4800
    s_waitcnt lgkmcnt(6)
    v_mfma_f32_16x16x32_bf16 v[140:143], v[20:23], v[80:83], v[140:143]
    v_mfma_f32_16x16x32_bf16 v[176:179], v[20:23], v[84:87], v[176:179]
    buffer_load_dwordx4 v[120:123], v4, s[44:47], s53 offen offset:1024 sc1
    buffer_load_dwordx4 v[124:127], v5, s[44:47], s53 offen offset:1024 sc1
    s_add_u32 s53, s53, 2048
    s_sub_u32 s54, s53, 18432
    s_cmp_eq_u32 s53, s69
    s_cselect_b32 s53, s54, s53
    ds_read_b64_tr_b16 v[20:21], v7 offset:224
    ds_read_b64_tr_b16 v[22:23], v7 offset:4832
    s_waitcnt lgkmcnt(6)
    v_mfma_f32_16x16x32_bf16 v[144:147], v[24:27], v[80:83], v[144:147]
    v_mfma_f32_16x16x32_bf16 v[180:183], v[24:27], v[84:87], v[180:183]
    ds_read_b64_tr_b16 v[24:25], v7 offset:256
    ds_read_b64_tr_b16 v[26:27], v7 offset:4864
    s_waitcnt lgkmcnt(6)
    v_mfma_f32_16x16x32_bf16 v[148:151], v[28:31], v[80:83], v[148:151]
    v_mfma_f32_16x16x32_bf16 v[184:187], v[28:31], v[84:87], v[184:187]
    s_cmp_lg_u32 s65, 0
    s_cbranch_scc1 L_k2_nx8_0
    s_add_u32 m0, s64, 55296
    s_nop 0
    buffer_load_dwordx4 v6, s[28:31], s52 offen lds
L_k2_nx8_0:
    s_add_u32 m0, s59, 55296
    s_nop 0
    buffer_load_dwordx4 v2, s[28:31], s52 offen lds
    ds_read_b64_tr_b16 v[28:29], v7 offset:9216
    ds_read_b64_tr_b16 v[30:31], v7 offset:13824
    s_waitcnt lgkmcnt(6)
    v_mfma_f32_16x16x32_bf16 v[152:155], v[16:19], v[80:83], v[152:155]
    v_mfma_f32_16x16x32_bf16 v[188:191], v[16:19], v[84:87], v[188:191]
    ds_read_b64_tr_b16 v[16:17], v7 offset:9248
    ds_read_b64_tr_b16 v[18:19], v7 offset:13856
    s_waitcnt lgkmcnt(6)
    v_mfma_f32_16x16x32_bf16 v[156:159], v[20:23], v[80:83], v[156:159]
    v_mfma_f32_16x16x32_bf16 v[192:195], v[20:23], v[84:87], v[192:195]
    s_add_u32 m0, s59, 56320
    s_nop 0
    buffer_load_dwordx4 v3, s[28:31], s52 offen lds
    s_add_u32 s52, s52, 73728
    s_sub_u32 s54, s52, 663552
    s_cmp_eq_u32 s52, s68
    s_cselect_b32 s52, s54, s52
    ds_read_b64_tr_b16 v[20:21], v7 offset:9280
    ds_read_b64_tr_b16 v[22:23], v7 offset:13888
    s_waitcnt lgkmcnt(6)
    v_mfma_f32_16x16x32_bf16 v[160:163], v[24:27], v[80:83], v[160:163]
    v_mfma_f32_16x16x32_bf16 v[196:199], v[24:27], v[84:87], v[196:199]
    ds_read_b64_tr_b16 v[24:25], v7 offset:9312
    ds_read_b64_tr_b16 v[26:27], v7 offset:13920
    s_waitcnt lgkmcnt(6)
    v_mfma_f32_16x16x32_bf16 v[128:131], v[28:31], v[88:91], v[128:131]
    v_mfma_f32_16x16x32_bf16 v[164:167], v[28:31], v[92:95], v[164:167]
    s_add_u32 m0, s59, 92160
    s_nop 0
    buffer_load_dwordx4 v2, s[32:35], s77 offen lds
    s_add_u32 m0, s59, 93184
    s_nop 0
    buffer_load_dwordx4 v3, s[32:35], s77 offen lds
    ds_read_b64_tr_b16 v[28:29], v7 offset:9344
    ds_read_b64_tr_b16 v[30:31], v7 offset:13952
    s_waitcnt lgkmcnt(6)
    v_mfma_f32_16x16x32_bf16 v[132:135], v[16:19], v[88:91], v[132:135]
    v_mfma_f32_16x16x32_bf16 v[168:171], v[16:19], v[92:95], v[168:171]
    ds_read_b64_tr_b16 v[16:17], v7 offset:9376
    ds_read_b64_tr_b16 v[18:19], v7 offset:13984
    s_waitcnt lgkmcnt(6)
    v_mfma_f32_16x16x32_bf16 v[136:139], v[20:23], v[88:91], v[136:139]
    v_mfma_f32_16x16x32_bf16 v[172:175], v[20:23], v[92:95], v[172:175]
    s_lshl_b32 s25, s67, 10
    s_add_u32 m0, s25, 92160
    s_nop 0
    buffer_load_dwordx4 v62, s[32:35], s77 offen lds
    s_lshl_b32 s25, s22, 10
    s_add_u32 m0, s25, 113664
    s_nop 0
    buffer_load_dwordx4 v4, s[44:47], s78 offen sc1 lds
    ds_read_b64_tr_b16 v[20:21], v7 offset:9408
    ds_read_b64_tr_b16 v[22:23], v7 offset:14016
    s_waitcnt lgkmcnt(6)
    v_mfma_f32_16x16x32_bf16 v[140:143], v[24:27], v[88:91], v[140:143]
    v_mfma_f32_16x16x32_bf16 v[176:179], v[24:27], v[92:95], v[176:179]
    ds_read_b64_tr_b16 v[24:25], v7 offset:9440
    ds_read_b64_tr_b16 v[26:27], v7 offset:14048
    s_waitcnt lgkmcnt(6)
    v_mfma_f32_16x16x32_bf16 v[144:147], v[28:31], v[88:91], v[144:147]
    v_mfma_f32_16x16x32_bf16 v[180:183], v[28:31], v[92:95], v[180:183]
    buffer_load_dwordx4 v[200:203], v4, s[44:47], s72 offen offset:0 sc1
    buffer_load_dwordx4 v[208:211], v4, s[44:47], s72 offen offset:1024 sc1
    buffer_load_dwordx4 v[216:219], v4, s[44:47], s72 offen offset:2048 sc1
    buffer_load_dwordx4 v[224:227], v4, s[44:47], s72 offen offset:3072 sc1
    ds_read_b64_tr_b16 v[28:29], v7 offset:9472
    ds_read_b64_tr_b16 v[30:31], v7 offset:14080
    s_waitcnt lgkmcnt(6)
    v_mfma_f32_16x16x32_bf16 v[148:151], v[16:19], v[88:91], v[148:151]
    v_mfma_f32_16x16x32_bf16 v[184:187], v[16:19], v[92:95], v[184:187]
    ds_read_b64_tr_b16 v[16:17], v7 offset:18432
    ds_read_b64_tr_b16 v[18:19], v7 offset:23040
    s_waitcnt lgkmcnt(6)
    v_mfma_f32_16x16x32_bf16 v[152:155], v[20:23], v[88:91], v[152:155]
    v_mfma_f32_16x16x32_bf16 v[188:191], v[20:23], v[92:95], v[188:191]
    s_mov_b32 m0, s75
    s_nop 0
    buffer_load_dwordx4 v4, s[44:47], s74 offen sc1 lds
    ds_read_b64_tr_b16 v[20:21], v7 offset:18464
    ds_read_b64_tr_b16 v[22:23], v7 offset:23072
    s_waitcnt lgkmcnt(6)
    v_mfma_f32_16x16x32_bf16 v[156:159], v[24:27], v[88:91], v[156:159]
    v_mfma_f32_16x16x32_bf16 v[192:195], v[24:27], v[92:95], v[192:195]
    ds_read_b64_tr_b16 v[24:25], v7 offset:18496
    ds_read_b64_tr_b16 v[26:27], v7 offset:23104
    s_waitcnt lgkmcnt(6)
    v_mfma_f32_16x16x32_bf16 v[160:163], v[28:31], v[88:91], v[160:163]
    v_mfma_f32_16x16x32_bf16 v[196:199], v[28:31], v[92:95], v[196:199]
    s_waitcnt vmcnt(15)
    s_barrier
    ds_read_b64_tr_b16 v[28:29], v7 offset:18528
    ds_read_b64_tr_b16 v[30:31], v7 offset:23136
    s_waitcnt lgkmcnt(6)
    v_mfma_f32_16x16x32_bf16 v[128:131], v[16:19], v[96:99], v[128:131]
    v_mfma_f32_16x16x32_bf16 v[164:167], v[16:19], v[100:103], v[164:167]
    ds_read_b64_tr_b16 v[16:17], v7 offset:18560
    ds_read_b64_tr_b16 v[18:19], v7 offset:23168
    s_waitcnt lgkmcnt(6)
    v_mfma_f32_16x16x32_bf16 v[132:135], v[20:23], v[96:99], v[132:135]
    v_mfma_f32_16x16x32_bf16 v[168:171], v[20:23], v[100:103], v[168:171]
    buffer_load_dwordx4 v[64:67], v4, s[44:47], s53 offen offset:0 sc1
    buffer_load_dwordx4 v[68:71], v5, s[44:47], s53 offen offset:0 sc1
    ds_read_b64_tr_b16 v[20:21], v7 offset:18592
    ds_read_b64_tr_b16 v[22:23], v7 offset:23200
    s_waitcnt lgkmcnt(6)
    v_mfma_f32_16x16x32_bf16 v[136:139], v[24:27], v[96:99], v[136:139]
    v_mfma_f32_16x16x32_bf16 v[172:175], v[24:27], v[100:103], v[172:175]
    ds_read_b64_tr_b16 v[24:25], v7 offset:18624
    ds_read_b64_tr_b16 v[26:27], v7 offset:23232
    s_waitcnt lgkmcnt(6)
    v_mfma_f32_16x16x32_bf16 v[140:143], v[28:31], v[96:99], v[140:143]
    v_mfma_f32_16x16x32_bf16 v[176:179], v[28:31], v[100:103], v[176:179]
    buffer_load_dwordx4 v[72:75], v4, s[44:47], s53 offen offset:1024 sc1
    buffer_load_dwordx4 v[76:79], v5, s[44:47], s53 offen offset:1024 sc1
    s_add_u32 s53, s53, 2048
    s_sub_u32 s54, s53, 18432
    s_cmp_eq_u32 s53, s69
    s_cselect_b32 s53, s54, s53
    ds_read_b64_tr_b16 v[28:29], v7 offset:18656
    ds_read_b64_tr_b16 v[30:31], v7 offset:23264
    s_waitcnt lgkmcnt(6)
    v_mfma_f32_16x16x32_bf16 v[144:147], v[16:19], v[96:99], v[144:147]
    v_mfma_f32_16x16x32_bf16 v[180:183], v[16:19], v[100:103], v[180:183]
    ds_read_b64_tr_b16 v[16:17], v7 offset:18688
    ds_read_b64_tr_b16 v[18:19], v7 offset:23296
    s_waitcnt lgkmcnt(6)
    v_mfma_f32_16x16x32_bf16 v[148:151], v[20:23], v[96:99], v[148:151]
    v_mfma_f32_16x16x32_bf16 v[184:187], v[20:23], v[100:103], v[184:187]
    ds_read_b64_tr_b16 v[20:21], v7 offset:27648
    ds_read_b64_tr_b16 v[22:23], v7 offset:32256
    s_waitcnt lgkmcnt(6)
    v_mfma_f32_16x16x32_bf16 v[152:155], v[24:27], v[96:99], v[152:155]
    v_mfma_f32_16x16x32_bf16 v[188:191], v[24:27], v[100:103], v[188:191]
    ds_read_b64_tr_b16 v[24:25], v7 offset:27680
    ds_read_b64_tr_b16 v[26:27], v7 offset:32288
    s_waitcnt lgkmcnt(6)
    v_mfma_f32_16x16x32_bf16 v[156:159], v[28:31], v[96:99], v[156:159]
    v_mfma_f32_16x16x32_bf16 v[192:195], v[28:31], v[100:103], v[192:195]
    ds_read_b64_tr_b16 v[28:29], v7 offset:27712
    ds_read_b64_tr_b16 v[30:31], v7 offset:32320
    s_waitcnt lgkmcnt(6)
    v_mfma_f32_16x16x32_bf16 v[160:163], v[16:19], v[96:99], v[160:163]
    v_mfma_f32_16x16x32_bf16 v[196:199], v[16:19], v[100:103], v[196:199]
    ds_read_b64_tr_b16 v[16:17], v7 offset:27744
    ds_read_b64_tr_b16 v[18:19], v7 offset:32352
    s_waitcnt lgkmcnt(6)
    v_mfma_f32_16x16x32_bf16 v[128:131], v[20:23], v[104:107], v[128:131]
    v_mfma_f32_16x16x32_bf16 v[164:167], v[20:23], v[108:111], v[164:167]
    ds_read_b64_tr_b16 v[20:21], v7 offset:27776
    ds_read_b64_tr_b16 v[22:23], v7 offset:32384
    s_waitcnt lgkmcnt(6)
    v_mfma_f32_16x16x32_bf16 v[132:135], v[24:27], v[104:107], v[132:135]
    v_mfma_f32_16x16x32_bf16 v[168:171], v[24:27], v[108:111], v[168:171]
    ds_read_b64_tr_b16 v[24:25], v7 offset:27808
    ds_read_b64_tr_b16 v[26:27], v7 offset:32416
    s_waitcnt lgkmcnt(6)
    v_mfma_f32_16x16x32_bf16 v[136:139], v[28:31], v[104:107], v[136:139]
    v_mfma_f32_16x16x32_bf16 v[172:175], v[28:31], v[108:111], v[172:175]
    ds_read_b64_tr_b16 v[28:29], v7 offset:27840
    ds_read_b64_tr_b16 v[30:31], v7 offset:32448
    s_waitcnt lgkmcnt(6)
    v_mfma_f32_16x16x32_bf16 v[140:143], v[16:19], v[104:107], v[140:143]
    v_mfma_f32_16x16x32_bf16 v[176:179], v[16:19], v[108:111], v[176:179]
    ds_read_b64_tr_b16 v[16:17], v7 offset:27872
    ds_read_b64_tr_b16 v[18:19], v7 offset:32480
    s_waitcnt lgkmcnt(6)
    v_mfma_f32_16x16x32_bf16 v[144:147], v[20:23], v[104:107], v[144:147]
    v_mfma_f32_16x16x32_bf16 v[180:183], v[20:23], v[108:111], v[180:183]
    ds_read_b64_tr_b16 v[20:21], v7 offset:27904
    ds_read_b64_tr_b16 v[22:23], v7 offset:32512
    s_waitcnt lgkmcnt(6)
    v_mfma_f32_16x16x32_bf16 v[148:151], v[24:27], v[104:107], v[148:151]
    v_mfma_f32_16x16x32_bf16 v[184:187], v[24:27], v[108:111], v[184:187]
    ds_read_b64_tr_b16 v[24:25], v7 offset:36864
    ds_read_b64_tr_b16 v[26:27], v7 offset:41472
    s_waitcnt lgkmcnt(6)
    v_mfma_f32_16x16x32_bf16 v[152:155], v[28:31], v[104:107], v[152:155]
    v_mfma_f32_16x16x32_bf16 v[188:191], v[28:31], v[108:111], v[188:191]
    ds_read_b64_tr_b16 v[28:29], v7 offset:36896
    ds_read_b64_tr_b16 v[30:31], v7 offset:41504
    s_waitcnt lgkmcnt(6)
    v_mfma_f32_16x16x32_bf16 v[156:159], v[16:19], v[104:107], v[156:159]
    v_mfma_f32_16x16x32_bf16 v[192:195], v[16:19], v[108:111], v[192:195]
    ds_read_b64_tr_b16 v[16:17], v7 offset:36928
    ds_read_b64_tr_b16 v[18:19], v7 offset:41536
    s_waitcnt lgkmcnt(6)
    v_mfma_f32_16x16x32_bf16 v[160:163], v[20:23], v[104:107], v[160:163]
    v_mfma_f32_16x16x32_bf16 v[196:199], v[20:23], v[108:111], v[196:199]
    s_waitcnt vmcnt(13)
    s_waitcnt vmcnt(4)
    s_barrier
    v_mov_b32 v204, v202
    v_mov_b32 v205, v203
    v_mov_b32 v212, v210
    v_mov_b32 v213, v211
    v_mov_b32 v220, v218
    v_mov_b32 v221, v219
    v_mov_b32 v228, v226
    v_mov_b32 v229, v227
    ds_read_b32 v202, v59 offset:0
    ds_read_b32 v206, v59 offset:64
    ds_read_b32 v210, v59 offset:1024
    ds_read_b32 v214, v59 offset:1088
    ds_read_b32 v218, v59 offset:2048
    ds_read_b32 v222, v59 offset:2112
    ds_read_b32 v226, v59 offset:3072
    ds_read_b32 v230, v59 offset:3136
    ds_read_b32 v60, v59 offset:4096
    ds_read_b32 v61, v59 offset:4160
    ds_read_b32 v9, v59 offset:5120
    ds_read_b32 v10, v59 offset:5184
    s_waitcnt lgkmcnt(0)
    v_cndmask_b32 v202, 0, v202, s[82:83]
    v_cndmask_b32 v206, 0, v206, s[82:83]
    v_mov_b32 v203, 0
    v_cndmask_b32 v210, 0, v210, s[82:83]
    v_cndmask_b32 v214, 0, v214, s[82:83]
    v_mov_b32 v211, 0
    v_cndmask_b32 v218, 0, v218, s[82:83]
    v_cndmask_b32 v222, 0, v222, s[82:83]
    v_mov_b32 v219, 0
    v_cndmask_b32 v226, 0, v226, s[82:83]
    v_cndmask_b32 v230, 0, v230, s[82:83]
    v_mov_b32 v227, 0
    ds_read_b128 v[32:35], v58 offset:0
    ds_read_b128 v[36:39], v58 offset:1024
    ds_read_b64_tr_b16 v[20:21], v7 offset:36960
    ds_read_b64_tr_b16 v[22:23], v7 offset:41568
    v_mfma_f32_16x16x32_bf16 v[128:131], v[24:27], v[112:115], v[128:131]
    v_mfma_f32_16x16x32_bf16 v[164:167], v[24:27], v[116:119], v[164:167]
    ds_read_b64_tr_b16 v[24:25], v7 offset:36992
    ds_read_b64_tr_b16 v[26:27], v7 offset:41600
    v_mfma_f32_16x16x32_bf16 v[132:135], v[28:31], v[112:115], v[132:135]
    v_mfma_f32_16x16x32_bf16 v[168:171], v[28:31], v[116:119], v[168:171]
    s_waitcnt lgkmcnt(4)
    ds_read_b64_tr_b16 v[28:29], v7 offset:37024
    ds_read_b64_tr_b16 v[30:31], v7 offset:41632
    v_mfma_f32_16x16x32_bf16 v[136:139], v[16:19], v[112:115], v[136:139]
    v_mfma_f32_16x16x32_bf16 v[48:51], v[32:35], v[200:203], 0
    v_mfma_f32_16x16x32_bf16 v[52:55], v[36:39], v[200:203], 0
    v_mfma_f32_16x16x32_bf16 v[240:243], v[32:35], v[204:207], 0
    v_mfma_f32_16x16x32_bf16 v[172:175], v[16:19], v[116:119], v[172:175]
    v_mfma_f32_16x16x32_bf16 v[244:247], v[36:39], v[204:207], 0
    s_nop 4
    v_add_f32 v54, s79, v54
    v_rcp_f32 v54, v54
    ds_read_b64_tr_b16 v[16:17], v7 offset:37056
    ds_read_b64_tr_b16 v[18:19], v7 offset:41664
    s_waitcnt lgkmcnt(6)
    v_mfma_f32_16x16x32_bf16 v[140:143], v[20:23], v[112:115], v[140:143]
    v_mul_f32 v54, v60, v54
    v_mul_f32 v48, v54, v48
    v_mul_f32 v49, v54, v49
    v_mfma_f32_16x16x32_bf16 v[176:179], v[20:23], v[116:119], v[176:179]
    v_mul_f32 v50, v54, v50
    v_mul_f32 v51, v54, v51
    v_mul_f32 v52, v54, v52
    ds_read_b64_tr_b16 v[20:21], v7 offset:37088
    ds_read_b64_tr_b16 v[22:23], v7 offset:41696
    s_waitcnt lgkmcnt(6)
    v_mfma_f32_16x16x32_bf16 v[144:147], v[24:27], v[112:115], v[144:147]
    v_mul_f32 v53, v54, v53
    v_cvt_pk_bf16_f32 v40, v48, v49
    v_cvt_pk_bf16_f32 v41, v50, v51
    v_mfma_f32_16x16x32_bf16 v[180:183], v[24:27], v[116:119], v[180:183]
    v_cvt_pk_bf16_f32 v42, v52, v53
    v_cndmask_b32 v42, 0, v42, s[80:81]
    v_mov_b32 v43, 0
    ds_read_b128 v[32:35], v58 offset:2048
    ds_read_b128 v[36:39], v58 offset:3072
    ds_read_b64_tr_b16 v[24:25], v7 offset:37120
    ds_read_b64_tr_b16 v[26:27], v7 offset:41728
    s_waitcnt lgkmcnt(8)
    v_mfma_f32_16x16x32_bf16 v[148:151], v[28:31], v[112:115], v[148:151]
    v_add_f32 v246, s79, v246
    v_rcp_f32 v246, v246
    s_nop 0
    v_mul_f32 v246, v61, v246
    v_mfma_f32_16x16x32_bf16 v[184:187], v[28:31], v[116:119], v[184:187]
    v_mul_f32 v240, v246, v240
    v_mul_f32 v241, v246, v241
    v_mul_f32 v242, v246, v242
    ds_read_b64_tr_b16 v[28:29], v7 offset:46080
    ds_read_b64_tr_b16 v[30:31], v7 offset:50688
    s_waitcnt lgkmcnt(8)
    v_mfma_f32_16x16x32_bf16 v[152:155], v[16:19], v[112:115], v[152:155]
    v_mul_f32 v243, v246, v243
    v_mul_f32 v244, v246, v244
    v_mul_f32 v245, v246, v245
    v_mfma_f32_16x16x32_bf16 v[188:191], v[16:19], v[116:119], v[188:191]
    v_cvt_pk_bf16_f32 v44, v240, v241
    v_cvt_pk_bf16_f32 v45, v242, v243
    v_cvt_pk_bf16_f32 v46, v244, v245
    ds_read_b64_tr_b16 v[16:17], v7 offset:46112
    ds_read_b64_tr_b16 v[18:19], v7 offset:50720
    s_waitcnt lgkmcnt(8)
    v_mfma_f32_16x16x32_bf16 v[156:159], v[20:23], v[112:115], v[156:159]
    v_cndmask_b32 v46, 0, v46, s[80:81]
    v_mov_b32 v47, 0
    v_mfma_f32_16x16x32_bf16 v[192:195], v[20:23], v[116:119], v[192:195]
    s_waitcnt lgkmcnt(6)
    ds_read_b64_tr_b16 v[20:21], v7 offset:46144
    ds_read_b64_tr_b16 v[22:23], v7 offset:50752
    s_waitcnt lgkmcnt(6)
    v_mfma_f32_16x16x32_bf16 v[160:163], v[24:27], v[112:115], v[160:163]
    v_mfma_f32_16x16x32_bf16 v[48:51], v[32:35], v[208:211], 0
    v_mfma_f32_16x16x32_bf16 v[52:55], v[36:39], v[208:211], 0
    v_mfma_f32_16x16x32_bf16 v[240:243], v[32:35], v[212:215], 0
    v_mfma_f32_16x16x32_bf16 v[196:199], v[24:27], v[116:119], v[196:199]
    v_mfma_f32_16x16x32_bf16 v[244:247], v[36:39], v[212:215], 0
    s_nop 4
    v_add_f32 v54, s79, v54
    v_rcp_f32 v54, v54
    ds_read_b64_tr_b16 v[24:25], v7 offset:46176
    ds_read_b64_tr_b16 v[26:27], v7 offset:50784
    s_waitcnt lgkmcnt(6)
    v_mfma_f32_16x16x32_bf16 v[128:131], v[28:31], v[120:123], v[128:131]
    v_mul_f32 v54, v60, v54
    v_mul_f32 v48, v54, v48
    v_mul_f32 v49, v54, v49
    v_mfma_f32_16x16x32_bf16 v[164:167], v[28:31], v[124:127], v[164:167]
    v_mul_f32 v50, v54, v50
    v_mul_f32 v51, v54, v51
    v_mul_f32 v52, v54, v52
    ds_read_b64_tr_b16 v[28:29], v7 offset:46208
    ds_read_b64_tr_b16 v[30:31], v7 offset:50816
    s_waitcnt lgkmcnt(6)
    v_mfma_f32_16x16x32_bf16 v[132:135], v[16:19], v[120:123], v[132:135]
    v_mul_f32 v53, v54, v53
    v_cvt_pk_bf16_f32 v232, v48, v49
    v_cvt_pk_bf16_f32 v233, v50, v51
    v_mfma_f32_16x16x32_bf16 v[168:171], v[16:19], v[124:127], v[168:171]
    v_cvt_pk_bf16_f32 v234, v52, v53
    v_cndmask_b32 v234, 0, v234, s[80:81]
    v_mov_b32 v235, 0
    ds_read_b128 v[32:35], v58 offset:4096
    ds_read_b128 v[36:39], v58 offset:5120
    ds_read_b64_tr_b16 v[16:17], v7 offset:46240
    ds_read_b64_tr_b16 v[18:19], v7 offset:50848
    s_waitcnt lgkmcnt(8)
    v_mfma_f32_16x16x32_bf16 v[136:139], v[20:23], v[120:123], v[136:139]
    v_add_f32 v246, s79, v246
    v_rcp_f32 v246, v246
    s_nop 0
    v_mul_f32 v246, v61, v246
    v_mfma_f32_16x16x32_bf16 v[172:175], v[20:23], v[124:127], v[172:175]
    v_mul_f32 v240, v246, v240
    v_mul_f32 v241, v246, v241
    v_mul_f32 v242, v246, v242
    ds_read_b64_tr_b16 v[20:21], v7 offset:46272
    ds_read_b64_tr_b16 v[22:23], v7 offset:50880
    s_waitcnt lgkmcnt(8)
    v_mfma_f32_16x16x32_bf16 v[140:143], v[24:27], v[120:123], v[140:143]
    v_mul_f32 v243, v246, v243
    v_mul_f32 v244, v246, v244
    v_mul_f32 v245, v246, v245
    v_mfma_f32_16x16x32_bf16 v[176:179], v[24:27], v[124:127], v[176:179]
    v_cvt_pk_bf16_f32 v236, v240, v241
    v_cvt_pk_bf16_f32 v237, v242, v243
    v_cvt_pk_bf16_f32 v238, v244, v245
    ds_read_b64_tr_b16 v[24:25], v7 offset:46304
    ds_read_b64_tr_b16 v[26:27], v7 offset:50912
    s_waitcnt lgkmcnt(8)
    v_mfma_f32_16x16x32_bf16 v[144:147], v[28:31], v[120:123], v[144:147]
    v_cndmask_b32 v238, 0, v238, s[80:81]
    v_mov_b32 v239, 0
    v_mfma_f32_16x16x32_bf16 v[180:183], v[28:31], v[124:127], v[180:183]
    s_waitcnt lgkmcnt(6)
    ds_read_b64_tr_b16 v[28:29], v7 offset:46336
    ds_read_b64_tr_b16 v[30:31], v7 offset:50944
    s_waitcnt lgkmcnt(6)
    v_mfma_f32_16x16x32_bf16 v[148:151], v[16:19], v[120:123], v[148:151]
    v_mfma_f32_16x16x32_bf16 v[48:51], v[32:35], v[216:219], 0
    v_mfma_f32_16x16x32_bf16 v[52:55], v[36:39], v[216:219], 0
    v_mfma_f32_16x16x32_bf16 v[240:243], v[32:35], v[220:223], 0
    v_mfma_f32_16x16x32_bf16 v[184:187], v[16:19], v[124:127], v[184:187]
    v_mfma_f32_16x16x32_bf16 v[244:247], v[36:39], v[220:223], 0
    s_nop 4
    v_add_f32 v54, s79, v54
    v_rcp_f32 v54, v54
    ds_read_b64_tr_b16 v[16:17], v8 offset:0
    ds_read_b64_tr_b16 v[18:19], v8 offset:4608
    s_waitcnt lgkmcnt(6)
    v_mfma_f32_16x16x32_bf16 v[152:155], v[20:23], v[120:123], v[152:155]
    v_mul_f32 v54, v60, v54
    v_mul_f32 v48, v54, v48
    v_mul_f32 v49, v54, v49
    v_mfma_f32_16x16x32_bf16 v[188:191], v[20:23], v[124:127], v[188:191]
    v_mul_f32 v50, v54, v50
    v_mul_f32 v51, v54, v51
    v_mul_f32 v52, v54, v52
    ds_read_b64_tr_b16 v[20:21], v8 offset:32
    ds_read_b64_tr_b16 v[22:23], v8 offset:4640
    s_waitcnt lgkmcnt(6)
    v_mfma_f32_16x16x32_bf16 v[156:159], v[24:27], v[120:123], v[156:159]
    v_mul_f32 v53, v54, v53
    v_cvt_pk_bf16_f32 v96, v48, v49
    v_cvt_pk_bf16_f32 v97, v50, v51
    v_mfma_f32_16x16x32_bf16 v[192:195], v[24:27], v[124:127], v[192:195]
    v_cvt_pk_bf16_f32 v98, v52, v53
    v_cndmask_b32 v98, 0, v98, s[80:81]
    v_mov_b32 v99, 0
    ds_read_b128 v[32:35], v58 offset:6144
    ds_read_b128 v[36:39], v58 offset:7168
    ds_read_b64_tr_b16 v[24:25], v8 offset:64
    ds_read_b64_tr_b16 v[26:27], v8 offset:4672
    s_waitcnt lgkmcnt(8)
    v_mfma_f32_16x16x32_bf16 v[160:163], v[28:31], v[120:123], v[160:163]
    v_add_f32 v246, s79, v246
    v_rcp_f32 v246, v246
    s_nop 0
    v_mul_f32 v246, v61, v246
    v_mfma_f32_16x16x32_bf16 v[196:199], v[28:31], v[124:127], v[196:199]
    v_mul_f32 v240, v246, v240
    v_mul_f32 v241, v246, v241
    v_mul_f32 v242, v246, v242
    s_waitcnt vmcnt(0)
    ds_read_b64_tr_b16 v[28:29], v8 offset:96
    ds_read_b64_tr_b16 v[30:31], v8 offset:4704
    s_waitcnt lgkmcnt(8)
    v_mfma_f32_16x16x32_bf16 v[128:131], v[16:19], v[64:67], v[128:131]
    v_mul_f32 v243, v246, v243
    v_mul_f32 v244, v246, v244
    v_mul_f32 v245, v246, v245
    v_mfma_f32_16x16x32_bf16 v[164:167], v[16:19], v[68:71], v[164:167]
    v_cvt_pk_bf16_f32 v100, v240, v241
    v_cvt_pk_bf16_f32 v101, v242, v243
    v_cvt_pk_bf16_f32 v102, v244, v245
    ds_read_b64_tr_b16 v[16:17], v8 offset:128
    ds_read_b64_tr_b16 v[18:19], v8 offset:4736
    s_waitcnt lgkmcnt(8)
    v_mfma_f32_16x16x32_bf16 v[132:135], v[20:23], v[64:67], v[132:135]
    v_cndmask_b32 v102, 0, v102, s[80:81]
    v_mov_b32 v103, 0
    v_mfma_f32_16x16x32_bf16 v[168:171], v[20:23], v[68:71], v[168:171]
    s_waitcnt lgkmcnt(6)
    ds_read_b64_tr_b16 v[20:21], v8 offset:160
    ds_read_b64_tr_b16 v[22:23], v8 offset:4768
    s_waitcnt lgkmcnt(6)
    v_mfma_f32_16x16x32_bf16 v[136:139], v[24:27], v[64:67], v[136:139]
    v_mfma_f32_16x16x32_bf16 v[48:51], v[32:35], v[224:227], 0
    v_mfma_f32_16x16x32_bf16 v[52:55], v[36:39], v[224:227], 0
    v_mfma_f32_16x16x32_bf16 v[240:243], v[32:35], v[228:231], 0
    v_mfma_f32_16x16x32_bf16 v[172:175], v[24:27], v[68:71], v[172:175]
    v_mfma_f32_16x16x32_bf16 v[244:247], v[36:39], v[228:231], 0
    s_nop 4
    v_add_f32 v54, s79, v54
    v_rcp_f32 v54, v54
    ds_read_b64_tr_b16 v[24:25], v8 offset:192
    ds_read_b64_tr_b16 v[26:27], v8 offset:4800
    s_waitcnt lgkmcnt(6)
    v_mfma_f32_16x16x32_bf16 v[140:143], v[28:31], v[64:67], v[140:143]
    v_mul_f32 v54, v60, v54
    v_mul_f32 v48, v54, v48
    v_mul_f32 v49, v54, v49
    v_mfma_f32_16x16x32_bf16 v[176:179], v[28:31], v[68:71], v[176:179]
    v_mul_f32 v50, v54, v50
    v_mul_f32 v51, v54, v51
    v_mul_f32 v52, v54, v52
    ds_read_b64_tr_b16 v[28:29], v8 offset:224
    ds_read_b64_tr_b16 v[30:31], v8 offset:4832
    s_waitcnt lgkmcnt(6)
    v_mfma_f32_16x16x32_bf16 v[144:147], v[16:19], v[64:67], v[144:147]
    v_mul_f32 v53, v54, v53
    v_cvt_pk_bf16_f32 v104, v48, v49
    v_cvt_pk_bf16_f32 v105, v50, v51
    v_mfma_f32_16x16x32_bf16 v[180:183], v[16:19], v[68:71], v[180:183]
    v_cvt_pk_bf16_f32 v106, v52, v53
    v_cndmask_b32 v106, 0, v106, s[80:81]
    v_mov_b32 v107, 0
    ds_read_b64_tr_b16 v[16:17], v8 offset:256
    ds_read_b64_tr_b16 v[18:19], v8 offset:4864
    s_waitcnt lgkmcnt(6)
    v_mfma_f32_16x16x32_bf16 v[148:151], v[20:23], v[64:67], v[148:151]
    v_add_f32 v246, s79, v246
    v_rcp_f32 v246, v246
    s_nop 0
    v_mul_f32 v246, v61, v246
    v_mfma_f32_16x16x32_bf16 v[184:187], v[20:23], v[68:71], v[184:187]
    v_mul_f32 v240, v246, v240
    v_mul_f32 v241, v246, v241
    v_mul_f32 v242, v246, v242
    ds_read_b64_tr_b16 v[20:21], v8 offset:9216
    ds_read_b64_tr_b16 v[22:23], v8 offset:13824
    s_waitcnt lgkmcnt(6)
    v_mfma_f32_16x16x32_bf16 v[152:155], v[24:27], v[64:67], v[152:155]
    v_mul_f32 v243, v246, v243
    v_mul_f32 v244, v246, v244
    v_mul_f32 v245, v246, v245
    v_mfma_f32_16x16x32_bf16 v[188:191], v[24:27], v[68:71], v[188:191]
    v_cvt_pk_bf16_f32 v108, v240, v241
    v_cvt_pk_bf16_f32 v109, v242, v243
    v_cvt_pk_bf16_f32 v110, v244, v245
    ds_read_b64_tr_b16 v[24:25], v8 offset:9248
    ds_read_b64_tr_b16 v[26:27], v8 offset:13856
    s_waitcnt lgkmcnt(6)
    v_mfma_f32_16x16x32_bf16 v[156:159], v[28:31], v[64:67], v[156:159]
    v_cndmask_b32 v110, 0, v110, s[80:81]
    v_mov_b32 v111, 0
    v_mfma_f32_16x16x32_bf16 v[192:195], v[28:31], v[68:71], v[192:195]
    ds_read_b64_tr_b16 v[28:29], v8 offset:9280
    ds_read_b64_tr_b16 v[30:31], v8 offset:13888
    s_waitcnt lgkmcnt(6)
    v_mfma_f32_16x16x32_bf16 v[160:163], v[16:19], v[64:67], v[160:163]
    v_mfma_f32_16x16x32_bf16 v[196:199], v[16:19], v[68:71], v[196:199]
    ds_read_b64_tr_b16 v[16:17], v8 offset:9312
    ds_read_b64_tr_b16 v[18:19], v8 offset:13920
    s_waitcnt lgkmcnt(6)
    v_mfma_f32_16x16x32_bf16 v[128:131], v[20:23], v[72:75], v[128:131]
    v_mfma_f32_16x16x32_bf16 v[164:167], v[20:23], v[76:79], v[164:167]
    ds_read_b64_tr_b16 v[20:21], v8 offset:9344
    ds_read_b64_tr_b16 v[22:23], v8 offset:13952
    s_waitcnt lgkmcnt(6)
    v_mfma_f32_16x16x32_bf16 v[132:135], v[24:27], v[72:75], v[132:135]
    v_mfma_f32_16x16x32_bf16 v[168:171], v[24:27], v[76:79], v[168:171]
    ds_read_b64_tr_b16 v[24:25], v8 offset:9376
    ds_read_b64_tr_b16 v[26:27], v8 offset:13984
    s_waitcnt lgkmcnt(6)
    v_mfma_f32_16x16x32_bf16 v[136:139], v[28:31], v[72:75], v[136:139]
    v_mfma_f32_16x16x32_bf16 v[172:175], v[28:31], v[76:79], v[172:175]
    v_mul_f32 v128, v9, v128
    v_mul_f32 v129, v9, v129
    v_mul_f32 v130, v9, v130
    v_mul_f32 v131, v9, v131
    v_mul_f32 v164, v10, v164
    v_mul_f32 v165, v10, v165
    v_mul_f32 v166, v10, v166
    v_mul_f32 v167, v10, v167
    ds_read_b64_tr_b16 v[28:29], v8 offset:9408
    ds_read_b64_tr_b16 v[30:31], v8 offset:14016
    s_waitcnt lgkmcnt(6)
    v_mfma_f32_16x16x32_bf16 v[140:143], v[16:19], v[72:75], v[140:143]
    v_mfma_f32_16x16x32_bf16 v[176:179], v[16:19], v[76:79], v[176:179]
    v_mul_f32 v132, v9, v132
    v_mul_f32 v133, v9, v133
    v_mul_f32 v134, v9, v134
    v_mul_f32 v135, v9, v135
    v_mul_f32 v168, v10, v168
    v_mul_f32 v169, v10, v169
    v_mul_f32 v170, v10, v170
    v_mul_f32 v171, v10, v171
    ds_read_b64_tr_b16 v[16:17], v8 offset:9440
    ds_read_b64_tr_b16 v[18:19], v8 offset:14048
    s_waitcnt lgkmcnt(6)
    v_mfma_f32_16x16x32_bf16 v[144:147], v[20:23], v[72:75], v[144:147]
    v_mfma_f32_16x16x32_bf16 v[180:183], v[20:23], v[76:79], v[180:183]
    v_mul_f32 v136, v9, v136
    v_mul_f32 v137, v9, v137
    v_mul_f32 v138, v9, v138
    v_mul_f32 v139, v9, v139
    v_mul_f32 v172, v10, v172
    v_mul_f32 v173, v10, v173
    v_mul_f32 v174, v10, v174
    v_mul_f32 v175, v10, v175
    ds_read_b64_tr_b16 v[20:21], v8 offset:9472
    ds_read_b64_tr_b16 v[22:23], v8 offset:14080
    s_waitcnt lgkmcnt(6)
    v_mfma_f32_16x16x32_bf16 v[148:151], v[24:27], v[72:75], v[148:151]
    v_mfma_f32_16x16x32_bf16 v[184:187], v[24:27], v[76:79], v[184:187]
    v_mul_f32 v140, v9, v140
    v_mul_f32 v141, v9, v141
    v_mul_f32 v142, v9, v142
    v_mul_f32 v143, v9, v143
    v_mul_f32 v176, v10, v176
    v_mul_f32 v177, v10, v177
    v_mul_f32 v178, v10, v178
    v_mul_f32 v179, v10, v179
    ds_read_b64_tr_b16 v[24:25], v56 offset:0
    ds_read_b64_tr_b16 v[26:27], v57 offset:0
    s_waitcnt lgkmcnt(6)
    v_mfma_f32_16x16x32_bf16 v[152:155], v[28:31], v[72:75], v[152:155]
    v_mfma_f32_16x16x32_bf16 v[188:191], v[28:31], v[76:79], v[188:191]
    v_mul_f32 v144, v9, v144
    v_mul_f32 v145, v9, v145
    v_mul_f32 v146, v9, v146
    v_mul_f32 v147, v9, v147
    v_mul_f32 v180, v10, v180
    v_mul_f32 v181, v10, v181
    v_mul_f32 v182, v10, v182
    v_mul_f32 v183, v10, v183
    ds_read_b64_tr_b16 v[28:29], v56 offset:5184
    ds_read_b64_tr_b16 v[30:31], v57 offset:5184
    s_waitcnt lgkmcnt(6)
    v_mfma_f32_16x16x32_bf16 v[156:159], v[16:19], v[72:75], v[156:159]
    v_mfma_f32_16x16x32_bf16 v[192:195], v[16:19], v[76:79], v[192:195]
    v_mul_f32 v148, v9, v148
    v_mul_f32 v149, v9, v149
    v_mul_f32 v150, v9, v150
    v_mul_f32 v151, v9, v151
    v_mul_f32 v184, v10, v184
    v_mul_f32 v185, v10, v185
    v_mul_f32 v186, v10, v186
    v_mul_f32 v187, v10, v187
    ds_read_b64_tr_b16 v[16:17], v56 offset:10368
    ds_read_b64_tr_b16 v[18:19], v57 offset:10368
    s_waitcnt lgkmcnt(6)
    v_mfma_f32_16x16x32_bf16 v[160:163], v[20:23], v[72:75], v[160:163]
    v_mfma_f32_16x16x32_bf16 v[196:199], v[20:23], v[76:79], v[196:199]
    v_mul_f32 v152, v9, v152
    v_mul_f32 v153, v9, v153
    v_mul_f32 v154, v9, v154
    v_mul_f32 v155, v9, v155
    v_mul_f32 v188, v10, v188
    v_mul_f32 v189, v10, v189
    v_mul_f32 v190, v10, v190
    v_mul_f32 v191, v10, v191
    s_lshl_b32 s25, s20, 6
    s_lshr_b32 s26, s24, 1
    s_add_u32 s25, s25, s26
    s_mul_i32 s25, s25, 36
    s_mul_i32 s26, s21, 9
    s_add_u32 s25, s25, s26
    s_lshl_b32 s25, s25, 10
    s_add_u32 s25, s25, 33554432
    v_mul_f32 v156, v9, v156
    v_mul_f32 v157, v9, v157
    v_mul_f32 v158, v9, v158
    v_mul_f32 v159, v9, v159
    v_mul_f32 v192, v10, v192
    v_mul_f32 v193, v10, v193
    v_mul_f32 v194, v10, v194
    v_mul_f32 v195, v10, v195
    v_mul_f32 v160, v9, v160
    v_mul_f32 v161, v9, v161
    v_mul_f32 v162, v9, v162
    v_mul_f32 v163, v9, v163
    v_mul_f32 v196, v10, v196
    v_mul_f32 v197, v10, v197
    v_mul_f32 v198, v10, v198
    v_mul_f32 v199, v10, v199
    ds_read_b64_tr_b16 v[20:21], v56 offset:15552
    ds_read_b64_tr_b16 v[22:23], v57 offset:15552
    s_waitcnt lgkmcnt(6)
    v_mfma_f32_16x16x32_bf16 v[128:131], v[24:27], v[40:43], v[128:131]
    v_mfma_f32_16x16x32_bf16 v[164:167], v[24:27], v[44:47], v[164:167]
    ds_read_b64_tr_b16 v[24:25], v56 offset:32
    ds_read_b64_tr_b16 v[26:27], v57 offset:32
    s_waitcnt lgkmcnt(6)
    v_mfma_f32_16x16x32_bf16 v[128:131], v[28:31], v[232:235], v[128:131]
    v_mfma_f32_16x16x32_bf16 v[164:167], v[28:31], v[236:239], v[164:167]
    ds_read_b64_tr_b16 v[28:29], v56 offset:5216
    ds_read_b64_tr_b16 v[30:31], v57 offset:5216
    s_waitcnt lgkmcnt(6)
    v_mfma_f32_16x16x32_bf16 v[128:131], v[16:19], v[96:99], v[128:131]
    v_mfma_f32_16x16x32_bf16 v[164:167], v[16:19], v[100:103], v[164:167]
    ds_read_b64_tr_b16 v[16:17], v56 offset:10400
    ds_read_b64_tr_b16 v[18:19], v57 offset:10400
    s_waitcnt lgkmcnt(6)
    v_mfma_f32_16x16x32_bf16 v[128:131], v[20:23], v[104:107], v[128:131]
    v_mfma_f32_16x16x32_bf16 v[164:167], v[20:23], v[108:111], v[164:167]
    ds_read_b64_tr_b16 v[20:21], v56 offset:15584
    ds_read_b64_tr_b16 v[22:23], v57 offset:15584
    s_waitcnt lgkmcnt(6)
    v_mfma_f32_16x16x32_bf16 v[132:135], v[24:27], v[40:43], v[132:135]
    v_mfma_f32_16x16x32_bf16 v[168:171], v[24:27], v[44:47], v[168:171]
    ds_read_b64_tr_b16 v[24:25], v56 offset:64
    ds_read_b64_tr_b16 v[26:27], v57 offset:64
    s_waitcnt lgkmcnt(6)
    v_mfma_f32_16x16x32_bf16 v[132:135], v[28:31], v[232:235], v[132:135]
    v_mfma_f32_16x16x32_bf16 v[168:171], v[28:31], v[236:239], v[168:171]
    ds_read_b64_tr_b16 v[28:29], v56 offset:5248
    ds_read_b64_tr_b16 v[30:31], v57 offset:5248
    s_waitcnt lgkmcnt(6)
    v_mfma_f32_16x16x32_bf16 v[132:135], v[16:19], v[96:99], v[132:135]
    v_mfma_f32_16x16x32_bf16 v[168:171], v[16:19], v[100:103], v[168:171]
    v_cvt_pk_bf16_f32 v80, v128, v129
    v_cvt_pk_bf16_f32 v81, v130, v131
    v_cvt_pk_bf16_f32 v82, v164, v165
    v_cvt_pk_bf16_f32 v83, v166, v167
    buffer_store_dwordx4 v[80:83], v4, s[44:47], s25 offen offset:0 sc1
    ds_read_b64_tr_b16 v[16:17], v56 offset:10432
    ds_read_b64_tr_b16 v[18:19], v57 offset:10432
    s_waitcnt lgkmcnt(6)
    v_mfma_f32_16x16x32_bf16 v[132:135], v[20:23], v[104:107], v[132:135]
    v_mfma_f32_16x16x32_bf16 v[168:171], v[20:23], v[108:111], v[168:171]
    ds_read_b64_tr_b16 v[20:21], v56 offset:15616
    ds_read_b64_tr_b16 v[22:23], v57 offset:15616
    s_waitcnt lgkmcnt(6)
    v_mfma_f32_16x16x32_bf16 v[136:139], v[24:27], v[40:43], v[136:139]
    v_mfma_f32_16x16x32_bf16 v[172:175], v[24:27], v[44:47], v[172:175]
    ds_read_b64_tr_b16 v[24:25], v56 offset:96
    ds_read_b64_tr_b16 v[26:27], v57 offset:96
    s_waitcnt lgkmcnt(6)
    v_mfma_f32_16x16x32_bf16 v[136:139], v[28:31], v[232:235], v[136:139]
    v_mfma_f32_16x16x32_bf16 v[172:175], v[28:31], v[236:239], v[172:175]
    ds_read_b64_tr_b16 v[28:29], v56 offset:5280
    ds_read_b64_tr_b16 v[30:31], v57 offset:5280
    s_waitcnt lgkmcnt(6)
    v_mfma_f32_16x16x32_bf16 v[136:139], v[16:19], v[96:99], v[136:139]
    v_mfma_f32_16x16x32_bf16 v[172:175], v[16:19], v[100:103], v[172:175]
    v_cvt_pk_bf16_f32 v84, v132, v133
    v_cvt_pk_bf16_f32 v85, v134, v135
    v_cvt_pk_bf16_f32 v86, v168, v169
    v_cvt_pk_bf16_f32 v87, v170, v171
    buffer_store_dwordx4 v[84:87], v4, s[44:47], s25 offen offset:1024 sc1
    ds_read_b64_tr_b16 v[16:17], v56 offset:10464
    ds_read_b64_tr_b16 v[18:19], v57 offset:10464
    s_waitcnt lgkmcnt(6)
    v_mfma_f32_16x16x32_bf16 v[136:139], v[20:23], v[104:107], v[136:139]
    v_mfma_f32_16x16x32_bf16 v[172:175], v[20:23], v[108:111], v[172:175]
    ds_read_b64_tr_b16 v[20:21], v56 offset:15648
    ds_read_b64_tr_b16 v[22:23], v57 offset:15648
    s_waitcnt lgkmcnt(6)
    v_mfma_f32_16x16x32_bf16 v[140:143], v[24:27], v[40:43], v[140:143]
    v_mfma_f32_16x16x32_bf16 v[176:179], v[24:27], v[44:47], v[176:179]
    ds_read_b64_tr_b16 v[24:25], v56 offset:128
    ds_read_b64_tr_b16 v[26:27], v57 offset:128
    s_waitcnt lgkmcnt(6)
    v_mfma_f32_16x16x32_bf16 v[140:143], v[28:31], v[232:235], v[140:143]
    v_mfma_f32_16x16x32_bf16 v[176:179], v[28:31], v[236:239], v[176:179]
    ds_read_b64_tr_b16 v[28:29], v56 offset:5312
    ds_read_b64_tr_b16 v[30:31], v57 offset:5312
    s_waitcnt lgkmcnt(6)
    v_mfma_f32_16x16x32_bf16 v[140:143], v[16:19], v[96:99], v[140:143]
    v_mfma_f32_16x16x32_bf16 v[176:179], v[16:19], v[100:103], v[176:179]
    v_cvt_pk_bf16_f32 v88, v136, v137
    v_cvt_pk_bf16_f32 v89, v138, v139
    v_cvt_pk_bf16_f32 v90, v172, v173
    v_cvt_pk_bf16_f32 v91, v174, v175
    buffer_store_dwordx4 v[88:91], v4, s[44:47], s25 offen offset:2048 sc1
    s_add_u32 s25, s25, 3072
    ds_read_b64_tr_b16 v[16:17], v56 offset:10496
    ds_read_b64_tr_b16 v[18:19], v57 offset:10496
    s_waitcnt lgkmcnt(6)
    v_mfma_f32_16x16x32_bf16 v[140:143], v[20:23], v[104:107], v[140:143]
    v_mfma_f32_16x16x32_bf16 v[176:179], v[20:23], v[108:111], v[176:179]
    ds_read_b64_tr_b16 v[20:21], v56 offset:15680
    ds_read_b64_tr_b16 v[22:23], v57 offset:15680
    s_waitcnt lgkmcnt(6)
    v_mfma_f32_16x16x32_bf16 v[144:147], v[24:27], v[40:43], v[144:147]
    v_mfma_f32_16x16x32_bf16 v[180:183], v[24:27], v[44:47], v[180:183]
    ds_read_b64_tr_b16 v[24:25], v56 offset:160
    ds_read_b64_tr_b16 v[26:27], v57 offset:160
    s_waitcnt lgkmcnt(6)
    v_mfma_f32_16x16x32_bf16 v[144:147], v[28:31], v[232:235], v[144:147]
    v_mfma_f32_16x16x32_bf16 v[180:183], v[28:31], v[236:239], v[180:183]
    ds_read_b64_tr_b16 v[28:29], v56 offset:5344
    ds_read_b64_tr_b16 v[30:31], v57 offset:5344
    s_waitcnt lgkmcnt(6)
    v_mfma_f32_16x16x32_bf16 v[144:147], v[16:19], v[96:99], v[144:147]
    v_mfma_f32_16x16x32_bf16 v[180:183], v[16:19], v[100:103], v[180:183]
    v_cvt_pk_bf16_f32 v92, v140, v141
    v_cvt_pk_bf16_f32 v93, v142, v143
    v_cvt_pk_bf16_f32 v94, v176, v177
    v_cvt_pk_bf16_f32 v95, v178, v179
    buffer_store_dwordx4 v[92:95], v4, s[44:47], s25 offen offset:0 sc1
    ds_read_b64_tr_b16 v[16:17], v56 offset:10528
    ds_read_b64_tr_b16 v[18:19], v57 offset:10528
    s_waitcnt lgkmcnt(6)
    v_mfma_f32_16x16x32_bf16 v[144:147], v[20:23], v[104:107], v[144:147]
    v_mfma_f32_16x16x32_bf16 v[180:183], v[20:23], v[108:111], v[180:183]
    ds_read_b64_tr_b16 v[20:21], v56 offset:15712
    ds_read_b64_tr_b16 v[22:23], v57 offset:15712
    s_waitcnt lgkmcnt(6)
    v_mfma_f32_16x16x32_bf16 v[148:151], v[24:27], v[40:43], v[148:151]
    v_mfma_f32_16x16x32_bf16 v[184:187], v[24:27], v[44:47], v[184:187]
    ds_read_b64_tr_b16 v[24:25], v56 offset:192
    ds_read_b64_tr_b16 v[26:27], v57 offset:192
    s_waitcnt lgkmcnt(6)
    v_mfma_f32_16x16x32_bf16 v[148:151], v[28:31], v[232:235], v[148:151]
    v_mfma_f32_16x16x32_bf16 v[184:187], v[28:31], v[236:239], v[184:187]
    ds_read_b64_tr_b16 v[28:29], v56 offset:5376
    ds_read_b64_tr_b16 v[30:31], v57 offset:5376
    s_waitcnt lgkmcnt(6)
    v_mfma_f32_16x16x32_bf16 v[148:151], v[16:19], v[96:99], v[148:151]
    v_mfma_f32_16x16x32_bf16 v[184:187], v[16:19], v[100:103], v[184:187]
    v_cvt_pk_bf16_f32 v80, v144, v145
    v_cvt_pk_bf16_f32 v81, v146, v147
    v_cvt_pk_bf16_f32 v82, v180, v181
    v_cvt_pk_bf16_f32 v83, v182, v183
    buffer_store_dwordx4 v[80:83], v4, s[44:47], s25 offen offset:1024 sc1
    ds_read_b64_tr_b16 v[16:17], v56 offset:10560
    ds_read_b64_tr_b16 v[18:19], v57 offset:10560
    s_waitcnt lgkmcnt(6)
    v_mfma_f32_16x16x32_bf16 v[148:151], v[20:23], v[104:107], v[148:151]
    v_mfma_f32_16x16x32_bf16 v[184:187], v[20:23], v[108:111], v[184:187]
    ds_read_b64_tr_b16 v[20:21], v56 offset:15744
    ds_read_b64_tr_b16 v[22:23], v57 offset:15744
    s_waitcnt lgkmcnt(6)
    v_mfma_f32_16x16x32_bf16 v[152:155], v[24:27], v[40:43], v[152:155]
    v_mfma_f32_16x16x32_bf16 v[188:191], v[24:27], v[44:47], v[188:191]
    ds_read_b64_tr_b16 v[24:25], v56 offset:224
    ds_read_b64_tr_b16 v[26:27], v57 offset:224
    s_waitcnt lgkmcnt(6)
    v_mfma_f32_16x16x32_bf16 v[152:155], v[28:31], v[232:235], v[152:155]
    v_mfma_f32_16x16x32_bf16 v[188:191], v[28:31], v[236:239], v[188:191]
    ds_read_b64_tr_b16 v[28:29], v56 offset:5408
    ds_read_b64_tr_b16 v[30:31], v57 offset:5408
    s_waitcnt lgkmcnt(6)
    v_mfma_f32_16x16x32_bf16 v[152:155], v[16:19], v[96:99], v[152:155]
    v_mfma_f32_16x16x32_bf16 v[188:191], v[16:19], v[100:103], v[188:191]
    v_cvt_pk_bf16_f32 v84, v148, v149
    v_cvt_pk_bf16_f32 v85, v150, v151
    v_cvt_pk_bf16_f32 v86, v184, v185
    v_cvt_pk_bf16_f32 v87, v186, v187
    buffer_store_dwordx4 v[84:87], v4, s[44:47], s25 offen offset:2048 sc1
    s_add_u32 s25, s25, 3072
    ds_read_b64_tr_b16 v[16:17], v56 offset:10592
    ds_read_b64_tr_b16 v[18:19], v57 offset:10592
    s_waitcnt lgkmcnt(6)
    v_mfma_f32_16x16x32_bf16 v[152:155], v[20:23], v[104:107], v[152:155]
    v_mfma_f32_16x16x32_bf16 v[188:191], v[20:23], v[108:111], v[188:191]
    ds_read_b64_tr_b16 v[20:21], v56 offset:15776
    ds_read_b64_tr_b16 v[22:23], v57 offset:15776
    s_waitcnt lgkmcnt(6)
    v_mfma_f32_16x16x32_bf16 v[156:159], v[24:27], v[40:43], v[156:159]
    v_mfma_f32_16x16x32_bf16 v[192:195], v[24:27], v[44:47], v[192:195]
    ds_read_b64_tr_b16 v[24:25], v56 offset:256
    ds_read_b64_tr_b16 v[26:27], v57 offset:256
    s_waitcnt lgkmcnt(6)
    v_mfma_f32_16x16x32_bf16 v[156:159], v[28:31], v[232:235], v[156:159]
    v_mfma_f32_16x16x32_bf16 v[192:195], v[28:31], v[236:239], v[192:195]
    ds_read_b64_tr_b16 v[28:29], v56 offset:5440
    ds_read_b64_tr_b16 v[30:31], v57 offset:5440
    s_waitcnt lgkmcnt(6)
    v_mfma_f32_16x16x32_bf16 v[156:159], v[16:19], v[96:99], v[156:159]
    v_mfma_f32_16x16x32_bf16 v[192:195], v[16:19], v[100:103], v[192:195]
    v_cvt_pk_bf16_f32 v88, v152, v153
    v_cvt_pk_bf16_f32 v89, v154, v155
    v_cvt_pk_bf16_f32 v90, v188, v189
    v_cvt_pk_bf16_f32 v91, v190, v191
    buffer_store_dwordx4 v[88:91], v4, s[44:47], s25 offen offset:0 sc1
    ds_read_b64_tr_b16 v[16:17], v56 offset:10624
    ds_read_b64_tr_b16 v[18:19], v57 offset:10624
    s_waitcnt lgkmcnt(6)
    v_mfma_f32_16x16x32_bf16 v[156:159], v[20:23], v[104:107], v[156:159]
    v_mfma_f32_16x16x32_bf16 v[192:195], v[20:23], v[108:111], v[192:195]
    ds_read_b64_tr_b16 v[20:21], v56 offset:15808
    ds_read_b64_tr_b16 v[22:23], v57 offset:15808
    s_waitcnt lgkmcnt(6)
    v_mfma_f32_16x16x32_bf16 v[160:163], v[24:27], v[40:43], v[160:163]
    v_mfma_f32_16x16x32_bf16 v[196:199], v[24:27], v[44:47], v[196:199]
    s_waitcnt lgkmcnt(4)
    v_mfma_f32_16x16x32_bf16 v[160:163], v[28:31], v[232:235], v[160:163]
    v_mfma_f32_16x16x32_bf16 v[196:199], v[28:31], v[236:239], v[196:199]
    s_waitcnt lgkmcnt(2)
    v_mfma_f32_16x16x32_bf16 v[160:163], v[16:19], v[96:99], v[160:163]
    v_mfma_f32_16x16x32_bf16 v[196:199], v[16:19], v[100:103], v[196:199]
    v_cvt_pk_bf16_f32 v92, v156, v157
    v_cvt_pk_bf16_f32 v93, v158, v159
    v_cvt_pk_bf16_f32 v94, v192, v193
    v_cvt_pk_bf16_f32 v95, v194, v195
    buffer_store_dwordx4 v[92:95], v4, s[44:47], s25 offen offset:1024 sc1
    s_waitcnt lgkmcnt(0)
    v_mfma_f32_16x16x32_bf16 v[160:163], v[20:23], v[104:107], v[160:163]
    v_mfma_f32_16x16x32_bf16 v[196:199], v[20:23], v[108:111], v[196:199]
    s_nop 6
    v_cvt_pk_bf16_f32 v80, v160, v161
    v_cvt_pk_bf16_f32 v81, v162, v163
    v_cvt_pk_bf16_f32 v82, v196, v197
    v_cvt_pk_bf16_f32 v83, v198, v199
    buffer_store_dwordx4 v[80:83], v4, s[44:47], s25 offen offset:2048 sc1
    s_add_u32 s25, s25, 3072
    s_branch L_phase3
L_k2_ph1:
    s_waitcnt vmcnt(4)
    s_barrier
    buffer_load_dwordx4 v[80:83], v4, s[44:47], s53 offen offset:0 sc1
    buffer_load_dwordx4 v[84:87], v5, s[44:47], s53 offen offset:0 sc1
    buffer_load_dwordx4 v[88:91], v4, s[44:47], s53 offen offset:1024 sc1
    buffer_load_dwordx4 v[92:95], v5, s[44:47], s53 offen offset:1024 sc1
    s_add_u32 s53, s53, 2048
    s_sub_u32 s54, s53, 18432
    s_cmp_eq_u32 s53, s69
    s_cselect_b32 s53, s54, s53
    ds_read_b64_tr_b16 v[16:17], v7 offset:0
    ds_read_b64_tr_b16 v[18:19], v7 offset:4608
    ds_read_b64_tr_b16 v[20:21], v7 offset:32
    ds_read_b64_tr_b16 v[22:23], v7 offset:4640
    ds_read_b64_tr_b16 v[24:25], v7 offset:64
    ds_read_b64_tr_b16 v[26:27], v7 offset:4672
    s_waitcnt vmcnt(4)
    s_barrier
    ds_read_b64_tr_b16 v[28:29], v7 offset:96
    ds_read_b64_tr_b16 v[30:31], v7 offset:4704
    s_waitcnt lgkmcnt(6)
    v_mfma_f32_16x16x32_bf16 v[128:131], v[16:19], v[64:67], 0
    v_mfma_f32_16x16x32_bf16 v[164:167], v[16:19], v[68:71], 0
    ds_read_b64_tr_b16 v[16:17], v7 offset:128
    ds_read_b64_tr_b16 v[18:19], v7 offset:4736
    s_waitcnt lgkmcnt(6)
    v_mfma_f32_16x16x32_bf16 v[132:135], v[20:23], v[64:67], 0
    v_mfma_f32_16x16x32_bf16 v[168:171], v[20:23], v[68:71], 0
    s_cmp_lg_u32 s65, 2
    s_cbranch_scc1 L_k2_nx2_1
    s_add_u32 m0, s64, 36864
    s_nop 0
    buffer_load_dwordx4 v6, s[28:31], s52 offen lds
L_k2_nx2_1:
    s_add_u32 m0, s59, 36864
    s_nop 0
    buffer_load_dwordx4 v2, s[28:31], s52 offen lds
    ds_read_b64_tr_b16 v[20:21], v7 offset:160
    ds_read_b64_tr_b16 v[22:23], v7 offset:4768
    s_waitcnt lgkmcnt(6)
    v_mfma_f32_16x16x32_bf16 v[136:139], v[24:27], v[64:67], 0
    v_mfma_f32_16x16x32_bf16 v[172:175], v[24:27], v[68:71], 0
    ds_read_b64_tr_b16 v[24:25], v7 offset:192
    ds_read_b64_tr_b16 v[26:27], v7 offset:4800
    s_waitcnt lgkmcnt(6)
    v_mfma_f32_16x16x32_bf16 v[140:143], v[28:31], v[64:67], 0
    v_mfma_f32_16x16x32_bf16 v[176:179], v[28:31], v[68:71], 0
    s_add_u32 m0, s59, 37888
    s_nop 0
    buffer_load_dwordx4 v3, s[28:31], s52 offen lds
    s_add_u32 s52, s52, 73728
    s_sub_u32 s54, s52, 663552
    s_cmp_eq_u32 s52, s68
    s_cselect_b32 s52, s54, s52
    ds_read_b64_tr_b16 v[28:29], v7 offset:224
    ds_read_b64_tr_b16 v[30:31], v7 offset:4832
    s_waitcnt lgkmcnt(6)
    v_mfma_f32_16x16x32_bf16 v[144:147], v[16:19], v[64:67], 0
    v_mfma_f32_16x16x32_bf16 v[180:183], v[16:19], v[68:71], 0
    ds_read_b64_tr_b16 v[16:17], v7 offset:256
    ds_read_b64_tr_b16 v[18:19], v7 offset:4864
    s_waitcnt lgkmcnt(6)
    v_mfma_f32_16x16x32_bf16 v[148:151], v[20:23], v[64:67], 0
    v_mfma_f32_16x16x32_bf16 v[184:187], v[20:23], v[68:71], 0
    buffer_load_dwordx4 v[96:99], v4, s[44:47], s53 offen offset:0 sc1
    buffer_load_dwordx4 v[100:103], v5, s[44:47], s53 offen offset:0 sc1
    ds_read_b64_tr_b16 v[20:21], v7 offset:9216
    ds_read_b64_tr_b16 v[22:23], v7 offset:13824
    s_waitcnt lgkmcnt(6)
    v_mfma_f32_16x16x32_bf16 v[152:155], v[24:27], v[64:67], 0
    v_mfma_f32_16x16x32_bf16 v[188:191], v[24:27], v[68:71], 0
    ds_read_b64_tr_b16 v[24:25], v7 offset:9248
    ds_read_b64_tr_b16 v[26:27], v7 offset:13856
    s_waitcnt lgkmcnt(6)
    v_mfma_f32_16x16x32_bf16 v[156:159], v[28:31], v[64:67], 0
    v_mfma_f32_16x16x32_bf16 v[192:195], v[28:31], v[68:71], 0
    buffer_load_dwordx4 v[104:107], v4, s[44:47], s53 offen offset:1024 sc1
    buffer_load_dwordx4 v[108:111], v5, s[44:47], s53 offen offset:1024 sc1
    s_add_u32 s53, s53, 2048
    s_sub_u32 s54, s53, 18432
    s_cmp_eq_u32 s53, s69
    s_cselect_b32 s53, s54, s53
    ds_read_b64_tr_b16 v[28:29], v7 offset:9280
    ds_read_b64_tr_b16 v[30:31], v7 offset:13888
    s_waitcnt lgkmcnt(6)
    v_mfma_f32_16x16x32_bf16 v[160:163], v[16:19], v[64:67], 0
    v_mfma_f32_16x16x32_bf16 v[196:199], v[16:19], v[68:71], 0
    ds_read_b64_tr_b16 v[16:17], v7 offset:9312
    ds_read_b64_tr_b16 v[18:19], v7 offset:13920
    s_waitcnt lgkmcnt(6)
    v_mfma_f32_16x16x32_bf16 v[128:131], v[20:23], v[72:75], v[128:131]
    v_mfma_f32_16x16x32_bf16 v[164:167], v[20:23], v[76:79], v[164:167]
    s_cmp_lg_u32 s65, 3
    s_cbranch_scc1 L_k2_nx3_1
    s_add_u32 m0, s64, 55296
    s_nop 0
    buffer_load_dwordx4 v6, s[28:31], s52 offen lds
L_k2_nx3_1:
    s_add_u32 m0, s59, 55296
    s_nop 0
    buffer_load_dwordx4 v2, s[28:31], s52 offen lds
    ds_read_b64_tr_b16 v[20:21], v7 offset:9344
    ds_read_b64_tr_b16 v[22:23], v7 offset:13952
    s_waitcnt lgkmcnt(6)
    v_mfma_f32_16x16x32_bf16 v[132:135], v[24:27], v[72:75], v[132:135]
    v_mfma_f32_16x16x32_bf16 v[168:171], v[24:27], v[76:79], v[168:171]
    ds_read_b64_tr_b16 v[24:25], v7 offset:9376
    ds_read_b64_tr_b16 v[26:27], v7 offset:13984
    s_waitcnt lgkmcnt(6)
    v_mfma_f32_16x16x32_bf16 v[136:139], v[28:31], v[72:75], v[136:139]
    v_mfma_f32_16x16x32_bf16 v[172:175], v[28:31], v[76:79], v[172:175]
    s_add_u32 m0, s59, 56320
    s_nop 0
    buffer_load_dwordx4 v3, s[28:31], s52 offen lds
    s_add_u32 s52, s52, 73728
    s_sub_u32 s54, s52, 663552
    s_cmp_eq_u32 s52, s68
    s_cselect_b32 s52, s54, s52
    ds_read_b64_tr_b16 v[28:29], v7 offset:9408
    ds_read_b64_tr_b16 v[30:31], v7 offset:14016
    s_waitcnt lgkmcnt(6)
    v_mfma_f32_16x16x32_bf16 v[140:143], v[16:19], v[72:75], v[140:143]
    v_mfma_f32_16x16x32_bf16 v[176:179], v[16:19], v[76:79], v[176:179]
    ds_read_b64_tr_b16 v[16:17], v7 offset:9440
    ds_read_b64_tr_b16 v[18:19], v7 offset:14048
    s_waitcnt lgkmcnt(6)
    v_mfma_f32_16x16x32_bf16 v[144:147], v[20:23], v[72:75], v[144:147]
    v_mfma_f32_16x16x32_bf16 v[180:183], v[20:23], v[76:79], v[180:183]
    ds_read_b64_tr_b16 v[20:21], v7 offset:9472
    ds_read_b64_tr_b16 v[22:23], v7 offset:14080
    s_waitcnt lgkmcnt(6)
    v_mfma_f32_16x16x32_bf16 v[148:151], v[24:27], v[72:75], v[148:151]
    v_mfma_f32_16x16x32_bf16 v[184:187], v[24:27], v[76:79], v[184:187]
    ds_read_b64_tr_b16 v[24:25], v7 offset:18432
    ds_read_b64_tr_b16 v[26:27], v7 offset:23040
    s_waitcnt lgkmcnt(6)
    v_mfma_f32_16x16x32_bf16 v[152:155], v[28:31], v[72:75], v[152:155]
    v_mfma_f32_16x16x32_bf16 v[188:191], v[28:31], v[76:79], v[188:191]
    ds_read_b64_tr_b16 v[28:29], v7 offset:18464
    ds_read_b64_tr_b16 v[30:31], v7 offset:23072
    s_waitcnt lgkmcnt(6)
    v_mfma_f32_16x16x32_bf16 v[156:159], v[16:19], v[72:75], v[156:159]
    v_mfma_f32_16x16x32_bf16 v[192:195], v[16:19], v[76:79], v[192:195]
    ds_read_b64_tr_b16 v[16:17], v7 offset:18496
    ds_read_b64_tr_b16 v[18:19], v7 offset:23104
    s_waitcnt lgkmcnt(6)
    v_mfma_f32_16x16x32_bf16 v[160:163], v[20:23], v[72:75], v[160:163]
    v_mfma_f32_16x16x32_bf16 v[196:199], v[20:23], v[76:79], v[196:199]
    s_waitcnt vmcnt(6)
    s_barrier
    ds_read_b64_tr_b16 v[20:21], v7 offset:18528
    ds_read_b64_tr_b16 v[22:23], v7 offset:23136
    s_waitcnt lgkmcnt(6)
    v_mfma_f32_16x16x32_bf16 v[128:131], v[24:27], v[80:83], v[128:131]
    v_mfma_f32_16x16x32_bf16 v[164:167], v[24:27], v[84:87], v[164:167]
    ds_read_b64_tr_b16 v[24:25], v7 offset:18560
    ds_read_b64_tr_b16 v[26:27], v7 offset:23168
    s_waitcnt lgkmcnt(6)
    v_mfma_f32_16x16x32_bf16 v[132:135], v[28:31], v[80:83], v[132:135]
    v_mfma_f32_16x16x32_bf16 v[168:171], v[28:31], v[84:87], v[168:171]
    ds_read_b64_tr_b16 v[28:29], v7 offset:18592
    ds_read_b64_tr_b16 v[30:31], v7 offset:23200
    s_waitcnt lgkmcnt(6)
    v_mfma_f32_16x16x32_bf16 v[136:139], v[16:19], v[80:83], v[136:139]
    v_mfma_f32_16x16x32_bf16 v[172:175], v[16:19], v[84:87], v[172:175]
    ds_read_b64_tr_b16 v[16:17], v7 offset:18624
    ds_read_b64_tr_b16 v[18:19], v7 offset:23232
    s_waitcnt lgkmcnt(6)
    v_mfma_f32_16x16x32_bf16 v[140:143], v[20:23], v[80:83], v[140:143]
    v_mfma_f32_16x16x32_bf16 v[176:179], v[20:23], v[84:87], v[176:179]
    ds_read_b64_tr_b16 v[20:21], v7 offset:18656
    ds_read_b64_tr_b16 v[22:23], v7 offset:23264
    s_waitcnt lgkmcnt(6)
    v_mfma_f32_16x16x32_bf16 v[144:147], v[24:27], v[80:83], v[144:147]
    v_mfma_f32_16x16x32_bf16 v[180:183], v[24:27], v[84:87], v[180:183]
    ds_read_b64_tr_b16 v[24:25], v7 offset:18688
    ds_read_b64_tr_b16 v[26:27], v7 offset:23296
    s_waitcnt lgkmcnt(6)
    v_mfma_f32_16x16x32_bf16 v[148:151], v[28:31], v[80:83], v[148:151]
    v_mfma_f32_16x16x32_bf16 v[184:187], v[28:31], v[84:87], v[184:187]
    ds_read_b64_tr_b16 v[28:29], v7 offset:27648
    ds_read_b64_tr_b16 v[30:31], v7 offset:32256
    s_waitcnt lgkmcnt(6)
    v_mfma_f32_16x16x32_bf16 v[152:155], v[16:19], v[80:83], v[152:155]
    v_mfma_f32_16x16x32_bf16 v[188:191], v[16:19], v[84:87], v[188:191]
    ds_read_b64_tr_b16 v[16:17], v7 offset:27680
    ds_read_b64_tr_b16 v[18:19], v7 offset:32288
    s_waitcnt lgkmcnt(6)
    v_mfma_f32_16x16x32_bf16 v[156:159], v[20:23], v[80:83], v[156:159]
    v_mfma_f32_16x16x32_bf16 v[192:195], v[20:23], v[84:87], v[192:195]
    ds_read_b64_tr_b16 v[20:21], v7 offset:27712
    ds_read_b64_tr_b16 v[22:23], v7 offset:32320
    s_waitcnt lgkmcnt(6)
    v_mfma_f32_16x16x32_bf16 v[160:163], v[24:27], v[80:83], v[160:163]
    v_mfma_f32_16x16x32_bf16 v[196:199], v[24:27], v[84:87], v[196:199]
    ds_read_b64_tr_b16 v[24:25], v7 offset:27744
    ds_read_b64_tr_b16 v[26:27], v7 offset:32352
    s_waitcnt lgkmcnt(6)
    v_mfma_f32_16x16x32_bf16 v[128:131], v[28:31], v[88:91], v[128:131]
    v_mfma_f32_16x16x32_bf16 v[164:167], v[28:31], v[92:95], v[164:167]
    buffer_load_dwordx4 v[112:115], v4, s[44:47], s53 offen offset:0 sc1
    buffer_load_dwordx4 v[116:119], v5, s[44:47], s53 offen offset:0 sc1
    ds_read_b64_tr_b16 v[28:29], v7 offset:27776
    ds_read_b64_tr_b16 v[30:31], v7 offset:32384
    s_waitcnt lgkmcnt(6)
    v_mfma_f32_16x16x32_bf16 v[132:135], v[16:19], v[88:91], v[132:135]
    v_mfma_f32_16x16x32_bf16 v[168:171], v[16:19], v[92:95], v[168:171]
    ds_read_b64_tr_b16 v[16:17], v7 offset:27808
    ds_read_b64_tr_b16 v[18:19], v7 offset:32416
    s_waitcnt lgkmcnt(6)
    v_mfma_f32_16x16x32_bf16 v[136:139], v[20:23], v[88:91], v[136:139]
    v_mfma_f32_16x16x32_bf16 v[172:175], v[20:23], v[92:95], v[172:175]
    buffer_load_dwordx4 v[120:123], v4, s[44:47], s53 offen offset:1024 sc1
    buffer_load_dwordx4 v[124:127], v5, s[44:47], s53 offen offset:1024 sc1
    s_add_u32 s53, s53, 2048
    s_sub_u32 s54, s53, 18432
    s_cmp_eq_u32 s53, s69
    s_cselect_b32 s53, s54, s53
    ds_read_b64_tr_b16 v[20:21], v7 offset:27840
    ds_read_b64_tr_b16 v[22:23], v7 offset:32448
    s_waitcnt lgkmcnt(6)
    v_mfma_f32_16x16x32_bf16 v[140:143], v[24:27], v[88:91], v[140:143]
    v_mfma_f32_16x16x32_bf16 v[176:179], v[24:27], v[92:95], v[176:179]
    ds_read_b64_tr_b16 v[24:25], v7 offset:27872
    ds_read_b64_tr_b16 v[26:27], v7 offset:32480
    s_waitcnt lgkmcnt(6)
    v_mfma_f32_16x16x32_bf16 v[144:147], v[28:31], v[88:91], v[144:147]
    v_mfma_f32_16x16x32_bf16 v[180:183], v[28:31], v[92:95], v[180:183]
    s_cmp_lg_u32 s65, 0
    s_cbranch_scc1 L_k2_nx4_1
    s_add_u32 m0, s64, 73728
    s_nop 0
    buffer_load_dwordx4 v6, s[28:31], s52 offen lds
L_k2_nx4_1:
    s_add_u32 m0, s59, 73728
    s_nop 0
    buffer_load_dwordx4 v2, s[28:31], s52 offen lds
    ds_read_b64_tr_b16 v[28:29], v7 offset:27904
    ds_read_b64_tr_b16 v[30:31], v7 offset:32512
    s_waitcnt lgkmcnt(6)
    v_mfma_f32_16x16x32_bf16 v[148:151], v[16:19], v[88:91], v[148:151]
    v_mfma_f32_16x16x32_bf16 v[184:187], v[16:19], v[92:95], v[184:187]
    ds_read_b64_tr_b16 v[16:17], v7 offset:36864
    ds_read_b64_tr_b16 v[18:19], v7 offset:41472
    s_waitcnt lgkmcnt(6)
    v_mfma_f32_16x16x32_bf16 v[152:155], v[20:23], v[88:91], v[152:155]
    v_mfma_f32_16x16x32_bf16 v[188:191], v[20:23], v[92:95], v[188:191]
    s_add_u32 m0, s59, 74752
    s_nop 0
    buffer_load_dwordx4 v3, s[28:31], s52 offen lds
    s_add_u32 s52, s52, 73728
    s_sub_u32 s54, s52, 663552
    s_cmp_eq_u32 s52, s68
    s_cselect_b32 s52, s54, s52
    ds_read_b64_tr_b16 v[20:21], v7 offset:36896
    ds_read_b64_tr_b16 v[22:23], v7 offset:41504
    s_waitcnt lgkmcnt(6)
    v_mfma_f32_16x16x32_bf16 v[156:159], v[24:27], v[88:91], v[156:159]
    v_mfma_f32_16x16x32_bf16 v[192:195], v[24:27], v[92:95], v[192:195]
    ds_read_b64_tr_b16 v[24:25], v7 offset:36928
    ds_read_b64_tr_b16 v[26:27], v7 offset:41536
    s_waitcnt lgkmcnt(6)
    v_mfma_f32_16x16x32_bf16 v[160:163], v[28:31], v[88:91], v[160:163]
    v_mfma_f32_16x16x32_bf16 v[196:199], v[28:31], v[92:95], v[196:199]
    s_waitcnt vmcnt(6)
    s_barrier
    ds_read_b64_tr_b16 v[28:29], v7 offset:36960
    ds_read_b64_tr_b16 v[30:31], v7 offset:41568
    s_waitcnt lgkmcnt(6)
    v_mfma_f32_16x16x32_bf16 v[128:131], v[16:19], v[96:99], v[128:131]
    v_mfma_f32_16x16x32_bf16 v[164:167], v[16:19], v[100:103], v[164:167]
    ds_read_b64_tr_b16 v[16:17], v7 offset:36992
    ds_read_b64_tr_b16 v[18:19], v7 offset:41600
    s_waitcnt lgkmcnt(6)
    v_mfma_f32_16x16x32_bf16 v[132:135], v[20:23], v[96:99], v[132:135]
    v_mfma_f32_16x16x32_bf16 v[168:171], v[20:23], v[100:103], v[168:171]
    ds_read_b64_tr_b16 v[20:21], v7 offset:37024
    ds_read_b64_tr_b16 v[22:23], v7 offset:41632
    s_waitcnt lgkmcnt(6)
    v_mfma_f32_16x16x32_bf16 v[136:139], v[24:27], v[96:99], v[136:139]
    v_mfma_f32_16x16x32_bf16 v[172:175], v[24:27], v[100:103], v[172:175]
    ds_read_b64_tr_b16 v[24:25], v7 offset:37056
    ds_read_b64_tr_b16 v[26:27], v7 offset:41664
    s_waitcnt lgkmcnt(6)
    v_mfma_f32_16x16x32_bf16 v[140:143], v[28:31], v[96:99], v[140:143]
    v_mfma_f32_16x16x32_bf16 v[176:179], v[28:31], v[100:103], v[176:179]
    ds_read_b64_tr_b16 v[28:29], v7 offset:37088
    ds_read_b64_tr_b16 v[30:31], v7 offset:41696
    s_waitcnt lgkmcnt(6)
    v_mfma_f32_16x16x32_bf16 v[144:147], v[16:19], v[96:99], v[144:147]
    v_mfma_f32_16x16x32_bf16 v[180:183], v[16:19], v[100:103], v[180:183]
    ds_read_b64_tr_b16 v[16:17], v7 offset:37120
    ds_read_b64_tr_b16 v[18:19], v7 offset:41728
    s_waitcnt lgkmcnt(6)
    v_mfma_f32_16x16x32_bf16 v[148:151], v[20:23], v[96:99], v[148:151]
    v_mfma_f32_16x16x32_bf16 v[184:187], v[20:23], v[100:103], v[184:187]
    ds_read_b64_tr_b16 v[20:21], v7 offset:46080
    ds_read_b64_tr_b16 v[22:23], v7 offset:50688
    s_waitcnt lgkmcnt(6)
    v_mfma_f32_16x16x32_bf16 v[152:155], v[24:27], v[96:99], v[152:155]
    v_mfma_f32_16x16x32_bf16 v[188:191], v[24:27], v[100:103], v[188:191]
    ds_read_b64_tr_b16 v[24:25], v7 offset:46112
    ds_read_b64_tr_b16 v[26:27], v7 offset:50720
    s_waitcnt lgkmcnt(6)
    v_mfma_f32_16x16x32_bf16 v[156:159], v[28:31], v[96:99], v[156:159]
    v_mfma_f32_16x16x32_bf16 v[192:195], v[28:31], v[100:103], v[192:195]
    ds_read_b64_tr_b16 v[28:29], v7 offset:46144
    ds_read_b64_tr_b16 v[30:31], v7 offset:50752
    s_waitcnt lgkmcnt(6)
    v_mfma_f32_16x16x32_bf16 v[160:163], v[16:19], v[96:99], v[160:163]
    v_mfma_f32_16x16x32_bf16 v[196:199], v[16:19], v[100:103], v[196:199]
    ds_read_b64_tr_b16 v[16:17], v7 offset:46176
    ds_read_b64_tr_b16 v[18:19], v7 offset:50784
    s_waitcnt lgkmcnt(6)
    v_mfma_f32_16x16x32_bf16 v[128:131], v[20:23], v[104:107], v[128:131]
    v_mfma_f32_16x16x32_bf16 v[164:167], v[20:23], v[108:111], v[164:167]
    buffer_load_dwordx4 v[64:67], v4, s[44:47], s53 offen offset:0 sc1
    buffer_load_dwordx4 v[68:71], v5, s[44:47], s53 offen offset:0 sc1
    ds_read_b64_tr_b16 v[20:21], v7 offset:46208
    ds_read_b64_tr_b16 v[22:23], v7 offset:50816
    s_waitcnt lgkmcnt(6)
    v_mfma_f32_16x16x32_bf16 v[132:135], v[24:27], v[104:107], v[132:135]
    v_mfma_f32_16x16x32_bf16 v[168:171], v[24:27], v[108:111], v[168:171]
    ds_read_b64_tr_b16 v[24:25], v7 offset:46240
    ds_read_b64_tr_b16 v[26:27], v7 offset:50848
    s_waitcnt lgkmcnt(6)
    v_mfma_f32_16x16x32_bf16 v[136:139], v[28:31], v[104:107], v[136:139]
    v_mfma_f32_16x16x32_bf16 v[172:175], v[28:31], v[108:111], v[172:175]
    buffer_load_dwordx4 v[72:75], v4, s[44:47], s53 offen offset:1024 sc1
    buffer_load_dwordx4 v[76:79], v5, s[44:47], s53 offen offset:1024 sc1
    s_add_u32 s53, s53, 2048
    s_sub_u32 s54, s53, 18432
    s_cmp_eq_u32 s53, s69
    s_cselect_b32 s53, s54, s53
    ds_read_b64_tr_b16 v[28:29], v7 offset:46272
    ds_read_b64_tr_b16 v[30:31], v7 offset:50880
    s_waitcnt lgkmcnt(6)
    v_mfma_f32_16x16x32_bf16 v[140:143], v[16:19], v[104:107], v[140:143]
    v_mfma_f32_16x16x32_bf16 v[176:179], v[16:19], v[108:111], v[176:179]
    ds_read_b64_tr_b16 v[16:17], v7 offset:46304
    ds_read_b64_tr_b16 v[18:19], v7 offset:50912
    s_waitcnt lgkmcnt(6)
    v_mfma_f32_16x16x32_bf16 v[144:147], v[20:23], v[104:107], v[144:147]
    v_mfma_f32_16x16x32_bf16 v[180:183], v[20:23], v[108:111], v[180:183]
    s_cmp_lg_u32 s65, 1
    s_cbranch_scc1 L_k2_nx5_1
    s_add_u32 m0, s64, 0
    s_nop 0
    buffer_load_dwordx4 v6, s[28:31], s52 offen lds
L_k2_nx5_1:
    s_add_u32 m0, s59, 0
    s_nop 0
    buffer_load_dwordx4 v2, s[28:31], s52 offen lds
    ds_read_b64_tr_b16 v[20:21], v7 offset:46336
    ds_read_b64_tr_b16 v[22:23], v7 offset:50944
    s_waitcnt lgkmcnt(6)
    v_mfma_f32_16x16x32_bf16 v[148:151], v[24:27], v[104:107], v[148:151]
    v_mfma_f32_16x16x32_bf16 v[184:187], v[24:27], v[108:111], v[184:187]
    ds_read_b64_tr_b16 v[24:25], v8 offset:0
    ds_read_b64_tr_b16 v[26:27], v8 offset:4608
    s_waitcnt lgkmcnt(6)
    v_mfma_f32_16x16x32_bf16 v[152:155], v[28:31], v[104:107], v[152:155]
    v_mfma_f32_16x16x32_bf16 v[188:191], v[28:31], v[108:111], v[188:191]
    s_add_u32 m0, s59, 1024
    s_nop 0
    buffer_load_dwordx4 v3, s[28:31], s52 offen lds
    s_add_u32 s52, s52, 73728
    s_sub_u32 s54, s52, 663552
    s_cmp_eq_u32 s52, s68
    s_cselect_b32 s52, s54, s52
    ds_read_b64_tr_b16 v[28:29], v8 offset:32
    ds_read_b64_tr_b16 v[30:31], v8 offset:4640
    s_waitcnt lgkmcnt(6)
    v_mfma_f32_16x16x32_bf16 v[156:159], v[16:19], v[104:107], v[156:159]
    v_mfma_f32_16x16x32_bf16 v[192:195], v[16:19], v[108:111], v[192:195]
    ds_read_b64_tr_b16 v[16:17], v8 offset:64
    ds_read_b64_tr_b16 v[18:19], v8 offset:4672
    s_waitcnt lgkmcnt(6)
    v_mfma_f32_16x16x32_bf16 v[160:163], v[20:23], v[104:107], v[160:163]
    v_mfma_f32_16x16x32_bf16 v[196:199], v[20:23], v[108:111], v[196:199]
    s_waitcnt vmcnt(6)
    s_lshl_b32 s25, s23, 7
    s_add_u32 s25, s25, 22364160
    v_lshl_add_u32 v63, v1, 2, s25
    s_lshl_b32 s25, s20, 9
    s_add_u32 s25, s25, 22361088
    v_lshl_add_u32 v13, v1, 7, s25
    v_cmp_lt_u32 vcc, 31, v1
    s_nop 1
    v_cndmask_b32 v63, v63, v13, vcc
    v_min_u32 v13, 35, v1
    v_cmp_lt_u32 vcc, 35, v1
    v_mov_b32 v13, 22364160
    s_lshl_b32 s25, s23, 7
    v_add_u32 v13, s25, v13
    v_cndmask_b32 v63, v63, v13, vcc
    buffer_load_dword v248, v63, s[44:47], 0 offen sc1
    s_barrier
    ds_read_b64_tr_b16 v[20:21], v8 offset:96
    ds_read_b64_tr_b16 v[22:23], v8 offset:4704
    s_waitcnt lgkmcnt(6)
    v_mfma_f32_16x16x32_bf16 v[128:131], v[24:27], v[112:115], v[128:131]
    v_mfma_f32_16x16x32_bf16 v[164:167], v[24:27], v[116:119], v[164:167]
    ds_read_b64_tr_b16 v[24:25], v8 offset:128
    ds_read_b64_tr_b16 v[26:27], v8 offset:4736
    s_waitcnt lgkmcnt(6)
    v_mfma_f32_16x16x32_bf16 v[132:135], v[28:31], v[112:115], v[132:135]
    v_mfma_f32_16x16x32_bf16 v[168:171], v[28:31], v[116:119], v[168:171]
    ds_read_b64_tr_b16 v[28:29], v8 offset:160
    ds_read_b64_tr_b16 v[30:31], v8 offset:4768
    s_waitcnt lgkmcnt(6)
    v_mfma_f32_16x16x32_bf16 v[136:139], v[16:19], v[112:115], v[136:139]
    v_mfma_f32_16x16x32_bf16 v[172:175], v[16:19], v[116:119], v[172:175]
    ds_read_b64_tr_b16 v[16:17], v8 offset:192
    ds_read_b64_tr_b16 v[18:19], v8 offset:4800
    s_waitcnt lgkmcnt(6)
    v_mfma_f32_16x16x32_bf16 v[140:143], v[20:23], v[112:115], v[140:143]
    v_mfma_f32_16x16x32_bf16 v[176:179], v[20:23], v[116:119], v[176:179]
    ds_read_b64_tr_b16 v[20:21], v8 offset:224
    ds_read_b64_tr_b16 v[22:23], v8 offset:4832
    s_waitcnt lgkmcnt(6)
    v_mfma_f32_16x16x32_bf16 v[144:147], v[24:27], v[112:115], v[144:147]
    v_mfma_f32_16x16x32_bf16 v[180:183], v[24:27], v[116:119], v[180:183]
    ds_read_b64_tr_b16 v[24:25], v8 offset:256
    ds_read_b64_tr_b16 v[26:27], v8 offset:4864
    s_waitcnt lgkmcnt(6)
    v_mfma_f32_16x16x32_bf16 v[148:151], v[28:31], v[112:115], v[148:151]
    v_mfma_f32_16x16x32_bf16 v[184:187], v[28:31], v[116:119], v[184:187]
    ds_read_b64_tr_b16 v[28:29], v8 offset:9216
    ds_read_b64_tr_b16 v[30:31], v8 offset:13824
    s_waitcnt lgkmcnt(6)
    v_mfma_f32_16x16x32_bf16 v[152:155], v[16:19], v[112:115], v[152:155]
    v_mfma_f32_16x16x32_bf16 v[188:191], v[16:19], v[116:119], v[188:191]
    ds_read_b64_tr_b16 v[16:17], v8 offset:9248
    ds_read_b64_tr_b16 v[18:19], v8 offset:13856
    s_waitcnt lgkmcnt(6)
    v_mfma_f32_16x16x32_bf16 v[156:159], v[20:23], v[112:115], v[156:159]
    v_mfma_f32_16x16x32_bf16 v[192:195], v[20:23], v[116:119], v[192:195]
    ds_read_b64_tr_b16 v[20:21], v8 offset:9280
    ds_read_b64_tr_b16 v[22:23], v8 offset:13888
    s_waitcnt lgkmcnt(6)
    v_mfma_f32_16x16x32_bf16 v[160:163], v[24:27], v[112:115], v[160:163]
    v_mfma_f32_16x16x32_bf16 v[196:199], v[24:27], v[116:119], v[196:199]
    ds_read_b64_tr_b16 v[24:25], v8 offset:9312
    ds_read_b64_tr_b16 v[26:27], v8 offset:13920
    s_waitcnt lgkmcnt(6)
    v_mfma_f32_16x16x32_bf16 v[128:131], v[28:31], v[120:123], v[128:131]
    v_mfma_f32_16x16x32_bf16 v[164:167], v[28:31], v[124:127], v[164:167]
    buffer_load_dwordx4 v[80:83], v4, s[44:47], s53 offen offset:0 sc1
    buffer_load_dwordx4 v[84:87], v5, s[44:47], s53 offen offset:0 sc1
    ds_read_b64_tr_b16 v[28:29], v8 offset:9344
    ds_read_b64_tr_b16 v[30:31], v8 offset:13952
    s_waitcnt lgkmcnt(6)
    v_mfma_f32_16x16x32_bf16 v[132:135], v[16:19], v[120:123], v[132:135]
    v_mfma_f32_16x16x32_bf16 v[168:171], v[16:19], v[124:127], v[168:171]
    ds_read_b64_tr_b16 v[16:17], v8 offset:9376
    ds_read_b64_tr_b16 v[18:19], v8 offset:13984
    s_waitcnt lgkmcnt(6)
    v_mfma_f32_16x16x32_bf16 v[136:139], v[20:23], v[120:123], v[136:139]
    v_mfma_f32_16x16x32_bf16 v[172:175], v[20:23], v[124:127], v[172:175]
    buffer_load_dwordx4 v[88:91], v4, s[44:47], s53 offen offset:1024 sc1
    buffer_load_dwordx4 v[92:95], v5, s[44:47], s53 offen offset:1024 sc1
    s_add_u32 s53, s53, 2048
    s_sub_u32 s54, s53, 18432
    s_cmp_eq_u32 s53, s69
    s_cselect_b32 s53, s54, s53
    ds_read_b64_tr_b16 v[20:21], v8 offset:9408
    ds_read_b64_tr_b16 v[22:23], v8 offset:14016
    s_waitcnt lgkmcnt(6)
    v_mfma_f32_16x16x32_bf16 v[140:143], v[24:27], v[120:123], v[140:143]
    v_mfma_f32_16x16x32_bf16 v[176:179], v[24:27], v[124:127], v[176:179]
    ds_read_b64_tr_b16 v[24:25], v8 offset:9440
    ds_read_b64_tr_b16 v[26:27], v8 offset:14048
    s_waitcnt lgkmcnt(6)
    v_mfma_f32_16x16x32_bf16 v[144:147], v[28:31], v[120:123], v[144:147]
    v_mfma_f32_16x16x32_bf16 v[180:183], v[28:31], v[124:127], v[180:183]
    s_cmp_lg_u32 s65, 2
    s_cbranch_scc1 L_k2_nx6_1
    s_add_u32 m0, s64, 18432
    s_nop 0
    buffer_load_dwordx4 v6, s[28:31], s52 offen lds
L_k2_nx6_1:
    s_add_u32 m0, s59, 18432
    s_nop 0
    buffer_load_dwordx4 v2, s[28:31], s52 offen lds
    ds_read_b64_tr_b16 v[28:29], v8 offset:9472
    ds_read_b64_tr_b16 v[30:31], v8 offset:14080
    s_waitcnt lgkmcnt(6)
    v_mfma_f32_16x16x32_bf16 v[148:151], v[16:19], v[120:123], v[148:151]
    v_mfma_f32_16x16x32_bf16 v[184:187], v[16:19], v[124:127], v[184:187]
    ds_read_b64_tr_b16 v[16:17], v8 offset:18432
    ds_read_b64_tr_b16 v[18:19], v8 offset:23040
    s_waitcnt lgkmcnt(6)
    v_mfma_f32_16x16x32_bf16 v[152:155], v[20:23], v[120:123], v[152:155]
    v_mfma_f32_16x16x32_bf16 v[188:191], v[20:23], v[124:127], v[188:191]
    s_add_u32 m0, s59, 19456
    s_nop 0
    buffer_load_dwordx4 v3, s[28:31], s52 offen lds
    s_add_u32 s52, s52, 73728
    s_sub_u32 s54, s52, 663552
    s_cmp_eq_u32 s52, s68
    s_cselect_b32 s52, s54, s52
    ds_read_b64_tr_b16 v[20:21], v8 offset:18464
    ds_read_b64_tr_b16 v[22:23], v8 offset:23072
    s_waitcnt lgkmcnt(6)
    v_mfma_f32_16x16x32_bf16 v[156:159], v[24:27], v[120:123], v[156:159]
    v_mfma_f32_16x16x32_bf16 v[192:195], v[24:27], v[124:127], v[192:195]
    ds_read_b64_tr_b16 v[24:25], v8 offset:18496
    ds_read_b64_tr_b16 v[26:27], v8 offset:23104
    s_waitcnt lgkmcnt(6)
    v_mfma_f32_16x16x32_bf16 v[160:163], v[28:31], v[120:123], v[160:163]
    v_mfma_f32_16x16x32_bf16 v[196:199], v[28:31], v[124:127], v[196:199]
    s_waitcnt vmcnt(7)
    s_barrier
    ds_read_b64_tr_b16 v[28:29], v8 offset:18528
    ds_read_b64_tr_b16 v[30:31], v8 offset:23136
    s_waitcnt lgkmcnt(6)
    v_mfma_f32_16x16x32_bf16 v[128:131], v[16:19], v[64:67], v[128:131]
    v_mfma_f32_16x16x32_bf16 v[164:167], v[16:19], v[68:71], v[164:167]
    ds_read_b64_tr_b16 v[16:17], v8 offset:18560
    ds_read_b64_tr_b16 v[18:19], v8 offset:23168
    s_waitcnt lgkmcnt(6)
    v_mfma_f32_16x16x32_bf16 v[132:135], v[20:23], v[64:67], v[132:135]
    v_mfma_f32_16x16x32_bf16 v[168:171], v[20:23], v[68:71], v[168:171]
    ds_read_b64_tr_b16 v[20:21], v8 offset:18592
    ds_read_b64_tr_b16 v[22:23], v8 offset:23200
    s_waitcnt lgkmcnt(6)
    v_mfma_f32_16x16x32_bf16 v[136:139], v[24:27], v[64:67], v[136:139]
    v_mfma_f32_16x16x32_bf16 v[172:175], v[24:27], v[68:71], v[172:175]
    ds_read_b64_tr_b16 v[24:25], v8 offset:18624
    ds_read_b64_tr_b16 v[26:27], v8 offset:23232
    s_waitcnt lgkmcnt(6)
    v_mfma_f32_16x16x32_bf16 v[140:143], v[28:31], v[64:67], v[140:143]
    v_mfma_f32_16x16x32_bf16 v[176:179], v[28:31], v[68:71], v[176:179]
    ds_read_b64_tr_b16 v[28:29], v8 offset:18656
    ds_read_b64_tr_b16 v[30:31], v8 offset:23264
    s_waitcnt lgkmcnt(6)
    v_mfma_f32_16x16x32_bf16 v[144:147], v[16:19], v[64:67], v[144:147]
    v_mfma_f32_16x16x32_bf16 v[180:183], v[16:19], v[68:71], v[180:183]
    ds_read_b64_tr_b16 v[16:17], v8 offset:18688
    ds_read_b64_tr_b16 v[18:19], v8 offset:23296
    s_waitcnt lgkmcnt(6)
    v_mfma_f32_16x16x32_bf16 v[148:151], v[20:23], v[64:67], v[148:151]
    v_mfma_f32_16x16x32_bf16 v[184:187], v[20:23], v[68:71], v[184:187]
    ds_read_b64_tr_b16 v[20:21], v8 offset:27648
    ds_read_b64_tr_b16 v[22:23], v8 offset:32256
    s_waitcnt lgkmcnt(6)
    v_mfma_f32_16x16x32_bf16 v[152:155], v[24:27], v[64:67], v[152:155]
    v_mfma_f32_16x16x32_bf16 v[188:191], v[24:27], v[68:71], v[188:191]
    ds_read_b64_tr_b16 v[24:25], v8 offset:27680
    ds_read_b64_tr_b16 v[26:27], v8 offset:32288
    s_waitcnt lgkmcnt(6)
    v_mfma_f32_16x16x32_bf16 v[156:159], v[28:31], v[64:67], v[156:159]
    v_mfma_f32_16x16x32_bf16 v[192:195], v[28:31], v[68:71], v[192:195]
    ds_read_b64_tr_b16 v[28:29], v8 offset:27712
    ds_read_b64_tr_b16 v[30:31], v8 offset:32320
    s_waitcnt lgkmcnt(6)
    v_mfma_f32_16x16x32_bf16 v[160:163], v[16:19], v[64:67], v[160:163]
    v_mfma_f32_16x16x32_bf16 v[196:199], v[16:19], v[68:71], v[196:199]
    ds_read_b64_tr_b16 v[16:17], v8 offset:27744
    ds_read_b64_tr_b16 v[18:19], v8 offset:32352
    s_waitcnt lgkmcnt(6)
    v_mfma_f32_16x16x32_bf16 v[128:131], v[20:23], v[72:75], v[128:131]
    v_mfma_f32_16x16x32_bf16 v[164:167], v[20:23], v[76:79], v[164:167]
    buffer_load_dwordx4 v[96:99], v4, s[44:47], s53 offen offset:0 sc1
    buffer_load_dwordx4 v[100:103], v5, s[44:47], s53 offen offset:0 sc1
    ds_read_b64_tr_b16 v[20:21], v8 offset:27776
    ds_read_b64_tr_b16 v[22:23], v8 offset:32384
    s_waitcnt lgkmcnt(6)
    v_mfma_f32_16x16x32_bf16 v[132:135], v[24:27], v[72:75], v[132:135]
    v_mfma_f32_16x16x32_bf16 v[168:171], v[24:27], v[76:79], v[168:171]
    ds_read_b64_tr_b16 v[24:25], v8 offset:27808
    ds_read_b64_tr_b16 v[26:27], v8 offset:32416
    s_waitcnt lgkmcnt(6)
    v_mfma_f32_16x16x32_bf16 v[136:139], v[28:31], v[72:75], v[136:139]
    v_mfma_f32_16x16x32_bf16 v[172:175], v[28:31], v[76:79], v[172:175]
    buffer_load_dwordx4 v[104:107], v4, s[44:47], s53 offen offset:1024 sc1
    buffer_load_dwordx4 v[108:111], v5, s[44:47], s53 offen offset:1024 sc1
    s_add_u32 s53, s53, 2048
    s_sub_u32 s54, s53, 18432
    s_cmp_eq_u32 s53, s69
    s_cselect_b32 s53, s54, s53
    ds_read_b64_tr_b16 v[28:29], v8 offset:27840
    ds_read_b64_tr_b16 v[30:31], v8 offset:32448
    s_waitcnt lgkmcnt(6)
    v_mfma_f32_16x16x32_bf16 v[140:143], v[16:19], v[72:75], v[140:143]
    v_mfma_f32_16x16x32_bf16 v[176:179], v[16:19], v[76:79], v[176:179]
    ds_read_b64_tr_b16 v[16:17], v8 offset:27872
    ds_read_b64_tr_b16 v[18:19], v8 offset:32480
    s_waitcnt lgkmcnt(6)
    v_mfma_f32_16x16x32_bf16 v[144:147], v[20:23], v[72:75], v[144:147]
    v_mfma_f32_16x16x32_bf16 v[180:183], v[20:23], v[76:79], v[180:183]
    s_cmp_lg_u32 s65, 3
    s_cbranch_scc1 L_k2_nx7_1
    s_add_u32 m0, s64, 36864
    s_nop 0
    buffer_load_dwordx4 v6, s[28:31], s52 offen lds
L_k2_nx7_1:
    s_add_u32 m0, s59, 36864
    s_nop 0
    buffer_load_dwordx4 v2, s[28:31], s52 offen lds
    ds_read_b64_tr_b16 v[20:21], v8 offset:27904
    ds_read_b64_tr_b16 v[22:23], v8 offset:32512
    s_waitcnt lgkmcnt(6)
    v_mfma_f32_16x16x32_bf16 v[148:151], v[24:27], v[72:75], v[148:151]
    v_mfma_f32_16x16x32_bf16 v[184:187], v[24:27], v[76:79], v[184:187]
    ds_read_b64_tr_b16 v[24:25], v7 offset:0
    ds_read_b64_tr_b16 v[26:27], v7 offset:4608
    s_waitcnt lgkmcnt(6)
    v_mfma_f32_16x16x32_bf16 v[152:155], v[28:31], v[72:75], v[152:155]
    v_mfma_f32_16x16x32_bf16 v[188:191], v[28:31], v[76:79], v[188:191]
    s_add_u32 m0, s59, 37888
    s_nop 0
    buffer_load_dwordx4 v3, s[28:31], s52 offen lds
    s_add_u32 s52, s52, 73728
    s_sub_u32 s54, s52, 663552
    s_cmp_eq_u32 s52, s68
    s_cselect_b32 s52, s54, s52
    ds_read_b64_tr_b16 v[28:29], v7 offset:32
    ds_read_b64_tr_b16 v[30:31], v7 offset:4640
    s_waitcnt lgkmcnt(6)
    v_mfma_f32_16x16x32_bf16 v[156:159], v[16:19], v[72:75], v[156:159]
    v_mfma_f32_16x16x32_bf16 v[192:195], v[16:19], v[76:79], v[192:195]
    ds_read_b64_tr_b16 v[16:17], v7 offset:64
    ds_read_b64_tr_b16 v[18:19], v7 offset:4672
    s_waitcnt lgkmcnt(6)
    v_mfma_f32_16x16x32_bf16 v[160:163], v[20:23], v[72:75], v[160:163]
    v_mfma_f32_16x16x32_bf16 v[196:199], v[20:23], v[76:79], v[196:199]
    s_waitcnt vmcnt(6)
    s_mov_b32 s84, 0x40000
L_f_chk1:
    v_cmp_ne_u32 vcc, s3, v248
    s_sub_u32 s84, s84, 1
    s_cmp_eq_u32 s84, 0
    s_cbranch_scc1 L_f_ok1
    s_cbranch_vccz L_f_ok1
    s_sleep 2
    buffer_load_dword v248, v63, s[44:47], 0 offen sc1
    s_waitcnt vmcnt(0)
    s_branch L_f_chk1
L_f_ok1:
    s_barrier
    ds_read_b64_tr_b16 v[20:21], v7 offset:96
    ds_read_b64_tr_b16 v[22:23], v7 offset:4704
    s_waitcnt lgkmcnt(6)
    v_mfma_f32_16x16x32_bf16 v[128:131], v[24:27], v[80:83], v[128:131]
    v_mfma_f32_16x16x32_bf16 v[164:167], v[24:27], v[84:87], v[164:167]
    ds_read_b64_tr_b16 v[24:25], v7 offset:128
    ds_read_b64_tr_b16 v[26:27], v7 offset:4736
    s_waitcnt lgkmcnt(6)
    v_mfma_f32_16x16x32_bf16 v[132:135], v[28:31], v[80:83], v[132:135]
    v_mfma_f32_16x16x32_bf16 v[168:171], v[28:31], v[84:87], v[168:171]
    buffer_load_dwordx4 v[112:115], v4, s[44:47], s53 offen offset:0 sc1
    buffer_load_dwordx4 v[116:119], v5, s[44:47], s53 offen offset:0 sc1
    ds_read_b64_tr_b16 v[28:29], v7 offset:160
    ds_read_b64_tr_b16 v[30:31], v7 offset:4768
    s_waitcnt lgkmcnt(6)
    v_mfma_f32_16x16x32_bf16 v[136:139], v[16:19], v[80:83], v[136:139]
    v_mfma_f32_16x16x32_bf16 v[172:175], v[16:19], v[84:87], v[172:175]
    ds_read_b64_tr_b16 v[16:17], v7 offset:192
    ds_read_b64_tr_b16 v[18:19], v7 offset:4800
    s_waitcnt lgkmcnt(6)
    v_mfma_f32_16x16x32_bf16 v[140:143], v[20:23], v[80:83], v[140:143]
    v_mfma_f32_16x16x32_bf16 v[176:179], v[20:23], v[84:87], v[176:179]
    buffer_load_dwordx4 v[120:123], v4, s[44:47], s53 offen offset:1024 sc1
    buffer_load_dwordx4 v[124:127], v5, s[44:47], s53 offen offset:1024 sc1
    s_add_u32 s53, s53, 2048
    s_sub_u32 s54, s53, 18432
    s_cmp_eq_u32 s53, s69
    s_cselect_b32 s53, s54, s53
    ds_read_b64_tr_b16 v[20:21], v7 offset:224
    ds_read_b64_tr_b16 v[22:23], v7 offset:4832
    s_waitcnt lgkmcnt(6)
    v_mfma_f32_16x16x32_bf16 v[144:147], v[24:27], v[80:83], v[144:147]
    v_mfma_f32_16x16x32_bf16 v[180:183], v[24:27], v[84:87], v[180:183]
    ds_read_b64_tr_b16 v[24:25], v7 offset:256
    ds_read_b64_tr_b16 v[26:27], v7 offset:4864
    s_waitcnt lgkmcnt(6)
    v_mfma_f32_16x16x32_bf16 v[148:151], v[28:31], v[80:83], v[148:151]
    v_mfma_f32_16x16x32_bf16 v[184:187], v[28:31], v[84:87], v[184:187]
    s_cmp_lg_u32 s65, 0
    s_cbranch_scc1 L_k2_nx8_1
    s_add_u32 m0, s64, 55296
    s_nop 0
    buffer_load_dwordx4 v6, s[28:31], s52 offen lds
L_k2_nx8_1:
    s_add_u32 m0, s59, 55296
    s_nop 0
    buffer_load_dwordx4 v2, s[28:31], s52 offen lds
    ds_read_b64_tr_b16 v[28:29], v7 offset:9216
    ds_read_b64_tr_b16 v[30:31], v7 offset:13824
    s_waitcnt lgkmcnt(6)
    v_mfma_f32_16x16x32_bf16 v[152:155], v[16:19], v[80:83], v[152:155]
    v_mfma_f32_16x16x32_bf16 v[188:191], v[16:19], v[84:87], v[188:191]
    ds_read_b64_tr_b16 v[16:17], v7 offset:9248
    ds_read_b64_tr_b16 v[18:19], v7 offset:13856
    s_waitcnt lgkmcnt(6)
    v_mfma_f32_16x16x32_bf16 v[156:159], v[20:23], v[80:83], v[156:159]
    v_mfma_f32_16x16x32_bf16 v[192:195], v[20:23], v[84:87], v[192:195]
    s_add_u32 m0, s59, 56320
    s_nop 0
    buffer_load_dwordx4 v3, s[28:31], s52 offen lds
    s_add_u32 s52, s52, 73728
    s_sub_u32 s54, s52, 663552
    s_cmp_eq_u32 s52, s68
    s_cselect_b32 s52, s54, s52
    ds_read_b64_tr_b16 v[20:21], v7 offset:9280
    ds_read_b64_tr_b16 v[22:23], v7 offset:13888
    s_waitcnt lgkmcnt(6)
    v_mfma_f32_16x16x32_bf16 v[160:163], v[24:27], v[80:83], v[160:163]
    v_mfma_f32_16x16x32_bf16 v[196:199], v[24:27], v[84:87], v[196:199]
    ds_read_b64_tr_b16 v[24:25], v7 offset:9312
    ds_read_b64_tr_b16 v[26:27], v7 offset:13920
    s_waitcnt lgkmcnt(6)
    v_mfma_f32_16x16x32_bf16 v[128:131], v[28:31], v[88:91], v[128:131]
    v_mfma_f32_16x16x32_bf16 v[164:167], v[28:31], v[92:95], v[164:167]
    s_add_u32 m0, s59, 92160
    s_nop 0
    buffer_load_dwordx4 v2, s[32:35], s77 offen lds
    s_add_u32 m0, s59, 93184
    s_nop 0
    buffer_load_dwordx4 v3, s[32:35], s77 offen lds
    ds_read_b64_tr_b16 v[28:29], v7 offset:9344
    ds_read_b64_tr_b16 v[30:31], v7 offset:13952
    s_waitcnt lgkmcnt(6)
    v_mfma_f32_16x16x32_bf16 v[132:135], v[16:19], v[88:91], v[132:135]
    v_mfma_f32_16x16x32_bf16 v[168:171], v[16:19], v[92:95], v[168:171]
    ds_read_b64_tr_b16 v[16:17], v7 offset:9376
    ds_read_b64_tr_b16 v[18:19], v7 offset:13984
    s_waitcnt lgkmcnt(6)
    v_mfma_f32_16x16x32_bf16 v[136:139], v[20:23], v[88:91], v[136:139]
    v_mfma_f32_16x16x32_bf16 v[172:175], v[20:23], v[92:95], v[172:175]
    s_lshl_b32 s25, s67, 10
    s_add_u32 m0, s25, 92160
    s_nop 0
    buffer_load_dwordx4 v62, s[32:35], s77 offen lds
    s_lshl_b32 s25, s22, 10
    s_add_u32 m0, s25, 113664
    s_nop 0
    buffer_load_dwordx4 v4, s[44:47], s78 offen sc1 lds
    ds_read_b64_tr_b16 v[20:21], v7 offset:9408
    ds_read_b64_tr_b16 v[22:23], v7 offset:14016
    s_waitcnt lgkmcnt(6)
    v_mfma_f32_16x16x32_bf16 v[140:143], v[24:27], v[88:91], v[140:143]
    v_mfma_f32_16x16x32_bf16 v[176:179], v[24:27], v[92:95], v[176:179]
    ds_read_b64_tr_b16 v[24:25], v7 offset:9440
    ds_read_b64_tr_b16 v[26:27], v7 offset:14048
    s_waitcnt lgkmcnt(6)
    v_mfma_f32_16x16x32_bf16 v[144:147], v[28:31], v[88:91], v[144:147]
    v_mfma_f32_16x16x32_bf16 v[180:183], v[28:31], v[92:95], v[180:183]
    buffer_load_dwordx4 v[200:203], v4, s[44:47], s72 offen offset:0 sc1
    buffer_load_dwordx4 v[208:211], v4, s[44:47], s72 offen offset:1024 sc1
    buffer_load_dwordx4 v[216:219], v4, s[44:47], s72 offen offset:2048 sc1
    buffer_load_dwordx4 v[224:227], v4, s[44:47], s72 offen offset:3072 sc1
    ds_read_b64_tr_b16 v[28:29], v7 offset:9472
    ds_read_b64_tr_b16 v[30:31], v7 offset:14080
    s_waitcnt lgkmcnt(6)
    v_mfma_f32_16x16x32_bf16 v[148:151], v[16:19], v[88:91], v[148:151]
    v_mfma_f32_16x16x32_bf16 v[184:187], v[16:19], v[92:95], v[184:187]
    ds_read_b64_tr_b16 v[16:17], v7 offset:18432
    ds_read_b64_tr_b16 v[18:19], v7 offset:23040
    s_waitcnt lgkmcnt(6)
    v_mfma_f32_16x16x32_bf16 v[152:155], v[20:23], v[88:91], v[152:155]
    v_mfma_f32_16x16x32_bf16 v[188:191], v[20:23], v[92:95], v[188:191]
    s_mov_b32 m0, s75
    s_nop 0
    buffer_load_dwordx4 v4, s[44:47], s74 offen sc1 lds
    ds_read_b64_tr_b16 v[20:21], v7 offset:18464
    ds_read_b64_tr_b16 v[22:23], v7 offset:23072
    s_waitcnt lgkmcnt(6)
    v_mfma_f32_16x16x32_bf16 v[156:159], v[24:27], v[88:91], v[156:159]
    v_mfma_f32_16x16x32_bf16 v[192:195], v[24:27], v[92:95], v[192:195]
    ds_read_b64_tr_b16 v[24:25], v7 offset:18496
    ds_read_b64_tr_b16 v[26:27], v7 offset:23104
    s_waitcnt lgkmcnt(6)
    v_mfma_f32_16x16x32_bf16 v[160:163], v[28:31], v[88:91], v[160:163]
    v_mfma_f32_16x16x32_bf16 v[196:199], v[28:31], v[92:95], v[196:199]
    s_waitcnt vmcnt(15)
    s_barrier
    ds_read_b64_tr_b16 v[28:29], v7 offset:18528
    ds_read_b64_tr_b16 v[30:31], v7 offset:23136
    s_waitcnt lgkmcnt(6)
    v_mfma_f32_16x16x32_bf16 v[128:131], v[16:19], v[96:99], v[128:131]
    v_mfma_f32_16x16x32_bf16 v[164:167], v[16:19], v[100:103], v[164:167]
    ds_read_b64_tr_b16 v[16:17], v7 offset:18560
    ds_read_b64_tr_b16 v[18:19], v7 offset:23168
    s_waitcnt lgkmcnt(6)
    v_mfma_f32_16x16x32_bf16 v[132:135], v[20:23], v[96:99], v[132:135]
    v_mfma_f32_16x16x32_bf16 v[168:171], v[20:23], v[100:103], v[168:171]
    ds_read_b64_tr_b16 v[20:21], v7 offset:18592
    ds_read_b64_tr_b16 v[22:23], v7 offset:23200
    s_waitcnt lgkmcnt(6)
    v_mfma_f32_16x16x32_bf16 v[136:139], v[24:27], v[96:99], v[136:139]
    v_mfma_f32_16x16x32_bf16 v[172:175], v[24:27], v[100:103], v[172:175]
    ds_read_b64_tr_b16 v[24:25], v7 offset:18624
    ds_read_b64_tr_b16 v[26:27], v7 offset:23232
    s_waitcnt lgkmcnt(6)
    v_mfma_f32_16x16x32_bf16 v[140:143], v[28:31], v[96:99], v[140:143]
    v_mfma_f32_16x16x32_bf16 v[176:179], v[28:31], v[100:103], v[176:179]
    ds_read_b64_tr_b16 v[28:29], v7 offset:18656
    ds_read_b64_tr_b16 v[30:31], v7 offset:23264
    s_waitcnt lgkmcnt(6)
    v_mfma_f32_16x16x32_bf16 v[144:147], v[16:19], v[96:99], v[144:147]
    v_mfma_f32_16x16x32_bf16 v[180:183], v[16:19], v[100:103], v[180:183]
    ds_read_b64_tr_b16 v[16:17], v7 offset:18688
    ds_read_b64_tr_b16 v[18:19], v7 offset:23296
    s_waitcnt lgkmcnt(6)
    v_mfma_f32_16x16x32_bf16 v[148:151], v[20:23], v[96:99], v[148:151]
    v_mfma_f32_16x16x32_bf16 v[184:187], v[20:23], v[100:103], v[184:187]
    ds_read_b64_tr_b16 v[20:21], v7 offset:27648
    ds_read_b64_tr_b16 v[22:23], v7 offset:32256
    s_waitcnt lgkmcnt(6)
    v_mfma_f32_16x16x32_bf16 v[152:155], v[24:27], v[96:99], v[152:155]
    v_mfma_f32_16x16x32_bf16 v[188:191], v[24:27], v[100:103], v[188:191]
    ds_read_b64_tr_b16 v[24:25], v7 offset:27680
    ds_read_b64_tr_b16 v[26:27], v7 offset:32288
    s_waitcnt lgkmcnt(6)
    v_mfma_f32_16x16x32_bf16 v[156:159], v[28:31], v[96:99], v[156:159]
    v_mfma_f32_16x16x32_bf16 v[192:195], v[28:31], v[100:103], v[192:195]
    ds_read_b64_tr_b16 v[28:29], v7 offset:27712
    ds_read_b64_tr_b16 v[30:31], v7 offset:32320
    s_waitcnt lgkmcnt(6)
    v_mfma_f32_16x16x32_bf16 v[160:163], v[16:19], v[96:99], v[160:163]
    v_mfma_f32_16x16x32_bf16 v[196:199], v[16:19], v[100:103], v[196:199]
    ds_read_b64_tr_b16 v[16:17], v7 offset:27744
    ds_read_b64_tr_b16 v[18:19], v7 offset:32352
    s_waitcnt lgkmcnt(6)
    v_mfma_f32_16x16x32_bf16 v[128:131], v[20:23], v[104:107], v[128:131]
    v_mfma_f32_16x16x32_bf16 v[164:167], v[20:23], v[108:111], v[164:167]
    buffer_load_dwordx4 v[64:67], v4, s[44:47], s53 offen offset:0 sc1
    buffer_load_dwordx4 v[68:71], v5, s[44:47], s53 offen offset:0 sc1
    ds_read_b64_tr_b16 v[20:21], v7 offset:27776
    ds_read_b64_tr_b16 v[22:23], v7 offset:32384
    s_waitcnt lgkmcnt(6)
    v_mfma_f32_16x16x32_bf16 v[132:135], v[24:27], v[104:107], v[132:135]
    v_mfma_f32_16x16x32_bf16 v[168:171], v[24:27], v[108:111], v[168:171]
    ds_read_b64_tr_b16 v[24:25], v7 offset:27808
    ds_read_b64_tr_b16 v[26:27], v7 offset:32416
    s_waitcnt lgkmcnt(6)
    v_mfma_f32_16x16x32_bf16 v[136:139], v[28:31], v[104:107], v[136:139]
    v_mfma_f32_16x16x32_bf16 v[172:175], v[28:31], v[108:111], v[172:175]
    buffer_load_dwordx4 v[72:75], v4, s[44:47], s53 offen offset:1024 sc1
    buffer_load_dwordx4 v[76:79], v5, s[44:47], s53 offen offset:1024 sc1
    s_add_u32 s53, s53, 2048
    s_sub_u32 s54, s53, 18432
    s_cmp_eq_u32 s53, s69
    s_cselect_b32 s53, s54, s53
    ds_read_b64_tr_b16 v[28:29], v7 offset:27840
    ds_read_b64_tr_b16 v[30:31], v7 offset:32448
    s_waitcnt lgkmcnt(6)
    v_mfma_f32_16x16x32_bf16 v[140:143], v[16:19], v[104:107], v[140:143]
    v_mfma_f32_16x16x32_bf16 v[176:179], v[16:19], v[108:111], v[176:179]
    ds_read_b64_tr_b16 v[16:17], v7 offset:27872
    ds_read_b64_tr_b16 v[18:19], v7 offset:32480
    s_waitcnt lgkmcnt(6)
    v_mfma_f32_16x16x32_bf16 v[144:147], v[20:23], v[104:107], v[144:147]
    v_mfma_f32_16x16x32_bf16 v[180:183], v[20:23], v[108:111], v[180:183]
    ds_read_b64_tr_b16 v[20:21], v7 offset:27904
    ds_read_b64_tr_b16 v[22:23], v7 offset:32512
    s_waitcnt lgkmcnt(6)
    v_mfma_f32_16x16x32_bf16 v[148:151], v[24:27], v[104:107], v[148:151]
    v_mfma_f32_16x16x32_bf16 v[184:187], v[24:27], v[108:111], v[184:187]
    ds_read_b64_tr_b16 v[24:25], v7 offset:36864
    ds_read_b64_tr_b16 v[26:27], v7 offset:41472
    s_waitcnt lgkmcnt(6)
    v_mfma_f32_16x16x32_bf16 v[152:155], v[28:31], v[104:107], v[152:155]
    v_mfma_f32_16x16x32_bf16 v[188:191], v[28:31], v[108:111], v[188:191]
    ds_read_b64_tr_b16 v[28:29], v7 offset:36896
    ds_read_b64_tr_b16 v[30:31], v7 offset:41504
    s_waitcnt lgkmcnt(6)
    v_mfma_f32_16x16x32_bf16 v[156:159], v[16:19], v[104:107], v[156:159]
    v_mfma_f32_16x16x32_bf16 v[192:195], v[16:19], v[108:111], v[192:195]
    ds_read_b64_tr_b16 v[16:17], v7 offset:36928
    ds_read_b64_tr_b16 v[18:19], v7 offset:41536
    s_waitcnt lgkmcnt(6)
    v_mfma_f32_16x16x32_bf16 v[160:163], v[20:23], v[104:107], v[160:163]
    v_mfma_f32_16x16x32_bf16 v[196:199], v[20:23], v[108:111], v[196:199]
    s_waitcnt vmcnt(13)
    s_waitcnt vmcnt(4)
    s_barrier
    v_mov_b32 v204, v202
    v_mov_b32 v205, v203
    v_mov_b32 v212, v210
    v_mov_b32 v213, v211
    v_mov_b32 v220, v218
    v_mov_b32 v221, v219
    v_mov_b32 v228, v226
    v_mov_b32 v229, v227
    ds_read_b32 v202, v59 offset:0
    ds_read_b32 v206, v59 offset:64
    ds_read_b32 v210, v59 offset:1024
    ds_read_b32 v214, v59 offset:1088
    ds_read_b32 v218, v59 offset:2048
    ds_read_b32 v222, v59 offset:2112
    ds_read_b32 v226, v59 offset:3072
    ds_read_b32 v230, v59 offset:3136
    ds_read_b32 v60, v59 offset:4096
    ds_read_b32 v61, v59 offset:4160
    ds_read_b32 v9, v59 offset:5120
    ds_read_b32 v10, v59 offset:5184
    s_waitcnt lgkmcnt(0)
    v_cndmask_b32 v202, 0, v202, s[82:83]
    v_cndmask_b32 v206, 0, v206, s[82:83]
    v_mov_b32 v203, 0
    v_cndmask_b32 v210, 0, v210, s[82:83]
    v_cndmask_b32 v214, 0, v214, s[82:83]
    v_mov_b32 v211, 0
    v_cndmask_b32 v218, 0, v218, s[82:83]
    v_cndmask_b32 v222, 0, v222, s[82:83]
    v_mov_b32 v219, 0
    v_cndmask_b32 v226, 0, v226, s[82:83]
    v_cndmask_b32 v230, 0, v230, s[82:83]
    v_mov_b32 v227, 0
    ds_read_b128 v[32:35], v58 offset:0
    ds_read_b128 v[36:39], v58 offset:1024
    ds_read_b64_tr_b16 v[20:21], v7 offset:36960
    ds_read_b64_tr_b16 v[22:23], v7 offset:41568
    v_mfma_f32_16x16x32_bf16 v[128:131], v[24:27], v[112:115], v[128:131]
    v_mfma_f32_16x16x32_bf16 v[164:167], v[24:27], v[116:119], v[164:167]
    ds_read_b64_tr_b16 v[24:25], v7 offset:36992
    ds_read_b64_tr_b16 v[26:27], v7 offset:41600
    v_mfma_f32_16x16x32_bf16 v[132:135], v[28:31], v[112:115], v[132:135]
    v_mfma_f32_16x16x32_bf16 v[168:171], v[28:31], v[116:119], v[168:171]
    s_waitcnt lgkmcnt(4)
    ds_read_b64_tr_b16 v[28:29], v7 offset:37024
    ds_read_b64_tr_b16 v[30:31], v7 offset:41632
    v_mfma_f32_16x16x32_bf16 v[136:139], v[16:19], v[112:115], v[136:139]
    v_mfma_f32_16x16x32_bf16 v[48:51], v[32:35], v[200:203], 0
    v_mfma_f32_16x16x32_bf16 v[52:55], v[36:39], v[200:203], 0
    v_mfma_f32_16x16x32_bf16 v[240:243], v[32:35], v[204:207], 0
    v_mfma_f32_16x16x32_bf16 v[172:175], v[16:19], v[116:119], v[172:175]
    v_mfma_f32_16x16x32_bf16 v[244:247], v[36:39], v[204:207], 0
    s_nop 4
    v_add_f32 v54, s79, v54
    v_rcp_f32 v54, v54
    ds_read_b64_tr_b16 v[16:17], v7 offset:37056
    ds_read_b64_tr_b16 v[18:19], v7 offset:41664
    s_waitcnt lgkmcnt(6)
    v_mfma_f32_16x16x32_bf16 v[140:143], v[20:23], v[112:115], v[140:143]
    v_mul_f32 v54, v60, v54
    v_mul_f32 v48, v54, v48
    v_mul_f32 v49, v54, v49
    v_mfma_f32_16x16x32_bf16 v[176:179], v[20:23], v[116:119], v[176:179]
    v_mul_f32 v50, v54, v50
    v_mul_f32 v51, v54, v51
    v_mul_f32 v52, v54, v52
    ds_read_b64_tr_b16 v[20:21], v7 offset:37088
    ds_read_b64_tr_b16 v[22:23], v7 offset:41696
    s_waitcnt lgkmcnt(6)
    v_mfma_f32_16x16x32_bf16 v[144:147], v[24:27], v[112:115], v[144:147]
    v_mul_f32 v53, v54, v53
    v_cvt_pk_bf16_f32 v40, v48, v49
    v_cvt_pk_bf16_f32 v41, v50, v51
    v_mfma_f32_16x16x32_bf16 v[180:183], v[24:27], v[116:119], v[180:183]
    v_cvt_pk_bf16_f32 v42, v52, v53
    v_cndmask_b32 v42, 0, v42, s[80:81]
    v_mov_b32 v43, 0
    ds_read_b128 v[32:35], v58 offset:2048
    ds_read_b128 v[36:39], v58 offset:3072
    ds_read_b64_tr_b16 v[24:25], v7 offset:37120
    ds_read_b64_tr_b16 v[26:27], v7 offset:41728
    s_waitcnt lgkmcnt(8)
    v_mfma_f32_16x16x32_bf16 v[148:151], v[28:31], v[112:115], v[148:151]
    v_add_f32 v246, s79, v246
    v_rcp_f32 v246, v246
    s_nop 0
    v_mul_f32 v246, v61, v246
    v_mfma_f32_16x16x32_bf16 v[184:187], v[28:31], v[116:119], v[184:187]
    v_mul_f32 v240, v246, v240
    v_mul_f32 v241, v246, v241
    v_mul_f32 v242, v246, v242
    ds_read_b64_tr_b16 v[28:29], v7 offset:46080
    ds_read_b64_tr_b16 v[30:31], v7 offset:50688
    s_waitcnt lgkmcnt(8)
    v_mfma_f32_16x16x32_bf16 v[152:155], v[16:19], v[112:115], v[152:155]
    v_mul_f32 v243, v246, v243
    v_mul_f32 v244, v246, v244
    v_mul_f32 v245, v246, v245
    v_mfma_f32_16x16x32_bf16 v[188:191], v[16:19], v[116:119], v[188:191]
    v_cvt_pk_bf16_f32 v44, v240, v241
    v_cvt_pk_bf16_f32 v45, v242, v243
    v_cvt_pk_bf16_f32 v46, v244, v245
    ds_read_b64_tr_b16 v[16:17], v7 offset:46112
    ds_read_b64_tr_b16 v[18:19], v7 offset:50720
    s_waitcnt lgkmcnt(8)
    v_mfma_f32_16x16x32_bf16 v[156:159], v[20:23], v[112:115], v[156:159]
    v_cndmask_b32 v46, 0, v46, s[80:81]
    v_mov_b32 v47, 0
    v_mfma_f32_16x16x32_bf16 v[192:195], v[20:23], v[116:119], v[192:195]
    s_waitcnt lgkmcnt(6)
    ds_read_b64_tr_b16 v[20:21], v7 offset:46144
    ds_read_b64_tr_b16 v[22:23], v7 offset:50752
    s_waitcnt lgkmcnt(6)
    v_mfma_f32_16x16x32_bf16 v[160:163], v[24:27], v[112:115], v[160:163]
    v_mfma_f32_16x16x32_bf16 v[48:51], v[32:35], v[208:211], 0
    v_mfma_f32_16x16x32_bf16 v[52:55], v[36:39], v[208:211], 0
    v_mfma_f32_16x16x32_bf16 v[240:243], v[32:35], v[212:215], 0
    v_mfma_f32_16x16x32_bf16 v[196:199], v[24:27], v[116:119], v[196:199]
    v_mfma_f32_16x16x32_bf16 v[244:247], v[36:39], v[212:215], 0
    s_nop 4
    v_add_f32 v54, s79, v54
    v_rcp_f32 v54, v54
    ds_read_b64_tr_b16 v[24:25], v7 offset:46176
    ds_read_b64_tr_b16 v[26:27], v7 offset:50784
    s_waitcnt lgkmcnt(6)
    v_mfma_f32_16x16x32_bf16 v[128:131], v[28:31], v[120:123], v[128:131]
    v_mul_f32 v54, v60, v54
    v_mul_f32 v48, v54, v48
    v_mul_f32 v49, v54, v49
    v_mfma_f32_16x16x32_bf16 v[164:167], v[28:31], v[124:127], v[164:167]
    v_mul_f32 v50, v54, v50
    v_mul_f32 v51, v54, v51
    v_mul_f32 v52, v54, v52
    ds_read_b64_tr_b16 v[28:29], v7 offset:46208
    ds_read_b64_tr_b16 v[30:31], v7 offset:50816
    s_waitcnt lgkmcnt(6)
    v_mfma_f32_16x16x32_bf16 v[132:135], v[16:19], v[120:123], v[132:135]
    v_mul_f32 v53, v54, v53
    v_cvt_pk_bf16_f32 v232, v48, v49
    v_cvt_pk_bf16_f32 v233, v50, v51
    v_mfma_f32_16x16x32_bf16 v[168:171], v[16:19], v[124:127], v[168:171]
    v_cvt_pk_bf16_f32 v234, v52, v53
    v_cndmask_b32 v234, 0, v234, s[80:81]
    v_mov_b32 v235, 0
    ds_read_b128 v[32:35], v58 offset:4096
    ds_read_b128 v[36:39], v58 offset:5120
    ds_read_b64_tr_b16 v[16:17], v7 offset:46240
    ds_read_b64_tr_b16 v[18:19], v7 offset:50848
    s_waitcnt lgkmcnt(8)
    v_mfma_f32_16x16x32_bf16 v[136:139], v[20:23], v[120:123], v[136:139]
    v_add_f32 v246, s79, v246
    v_rcp_f32 v246, v246
    s_nop 0
    v_mul_f32 v246, v61, v246
    v_mfma_f32_16x16x32_bf16 v[172:175], v[20:23], v[124:127], v[172:175]
    v_mul_f32 v240, v246, v240
    v_mul_f32 v241, v246, v241
    v_mul_f32 v242, v246, v242
    ds_read_b64_tr_b16 v[20:21], v7 offset:46272
    ds_read_b64_tr_b16 v[22:23], v7 offset:50880
    s_waitcnt lgkmcnt(8)
    v_mfma_f32_16x16x32_bf16 v[140:143], v[24:27], v[120:123], v[140:143]
    v_mul_f32 v243, v246, v243
    v_mul_f32 v244, v246, v244
    v_mul_f32 v245, v246, v245
    v_mfma_f32_16x16x32_bf16 v[176:179], v[24:27], v[124:127], v[176:179]
    v_cvt_pk_bf16_f32 v236, v240, v241
    v_cvt_pk_bf16_f32 v237, v242, v243
    v_cvt_pk_bf16_f32 v238, v244, v245
    ds_read_b64_tr_b16 v[24:25], v7 offset:46304
    ds_read_b64_tr_b16 v[26:27], v7 offset:50912
    s_waitcnt lgkmcnt(8)
    v_mfma_f32_16x16x32_bf16 v[144:147], v[28:31], v[120:123], v[144:147]
    v_cndmask_b32 v238, 0, v238, s[80:81]
    v_mov_b32 v239, 0
    v_mfma_f32_16x16x32_bf16 v[180:183], v[28:31], v[124:127], v[180:183]
    s_waitcnt lgkmcnt(6)
    ds_read_b64_tr_b16 v[28:29], v7 offset:46336
    ds_read_b64_tr_b16 v[30:31], v7 offset:50944
    s_waitcnt lgkmcnt(6)
    v_mfma_f32_16x16x32_bf16 v[148:151], v[16:19], v[120:123], v[148:151]
    v_mfma_f32_16x16x32_bf16 v[48:51], v[32:35], v[216:219], 0
    v_mfma_f32_16x16x32_bf16 v[52:55], v[36:39], v[216:219], 0
    v_mfma_f32_16x16x32_bf16 v[240:243], v[32:35], v[220:223], 0
    v_mfma_f32_16x16x32_bf16 v[184:187], v[16:19], v[124:127], v[184:187]
    v_mfma_f32_16x16x32_bf16 v[244:247], v[36:39], v[220:223], 0
    s_nop 4
    v_add_f32 v54, s79, v54
    v_rcp_f32 v54, v54
    ds_read_b64_tr_b16 v[16:17], v8 offset:0
    ds_read_b64_tr_b16 v[18:19], v8 offset:4608
    s_waitcnt lgkmcnt(6)
    v_mfma_f32_16x16x32_bf16 v[152:155], v[20:23], v[120:123], v[152:155]
    v_mul_f32 v54, v60, v54
    v_mul_f32 v48, v54, v48
    v_mul_f32 v49, v54, v49
    v_mfma_f32_16x16x32_bf16 v[188:191], v[20:23], v[124:127], v[188:191]
    v_mul_f32 v50, v54, v50
    v_mul_f32 v51, v54, v51
    v_mul_f32 v52, v54, v52
    ds_read_b64_tr_b16 v[20:21], v8 offset:32
    ds_read_b64_tr_b16 v[22:23], v8 offset:4640
    s_waitcnt lgkmcnt(6)
    v_mfma_f32_16x16x32_bf16 v[156:159], v[24:27], v[120:123], v[156:159]
    v_mul_f32 v53, v54, v53
    v_cvt_pk_bf16_f32 v96, v48, v49
    v_cvt_pk_bf16_f32 v97, v50, v51
    v_mfma_f32_16x16x32_bf16 v[192:195], v[24:27], v[124:127], v[192:195]
    v_cvt_pk_bf16_f32 v98, v52, v53
    v_cndmask_b32 v98, 0, v98, s[80:81]
    v_mov_b32 v99, 0
    ds_read_b128 v[32:35], v58 offset:6144
    ds_read_b128 v[36:39], v58 offset:7168
    ds_read_b64_tr_b16 v[24:25], v8 offset:64
    ds_read_b64_tr_b16 v[26:27], v8 offset:4672
    s_waitcnt lgkmcnt(8)
    v_mfma_f32_16x16x32_bf16 v[160:163], v[28:31], v[120:123], v[160:163]
    v_add_f32 v246, s79, v246
    v_rcp_f32 v246, v246
    s_nop 0
    v_mul_f32 v246, v61, v246
    v_mfma_f32_16x16x32_bf16 v[196:199], v[28:31], v[124:127], v[196:199]
    v_mul_f32 v240, v246, v240
    v_mul_f32 v241, v246, v241
    v_mul_f32 v242, v246, v242
    s_waitcnt vmcnt(0)
    ds_read_b64_tr_b16 v[28:29], v8 offset:96
    ds_read_b64_tr_b16 v[30:31], v8 offset:4704
    s_waitcnt lgkmcnt(8)
    v_mfma_f32_16x16x32_bf16 v[128:131], v[16:19], v[64:67], v[128:131]
    v_mul_f32 v243, v246, v243
    v_mul_f32 v244, v246, v244
    v_mul_f32 v245, v246, v245
    v_mfma_f32_16x16x32_bf16 v[164:167], v[16:19], v[68:71], v[164:167]
    v_cvt_pk_bf16_f32 v100, v240, v241
    v_cvt_pk_bf16_f32 v101, v242, v243
    v_cvt_pk_bf16_f32 v102, v244, v245
    ds_read_b64_tr_b16 v[16:17], v8 offset:128
    ds_read_b64_tr_b16 v[18:19], v8 offset:4736
    s_waitcnt lgkmcnt(8)
    v_mfma_f32_16x16x32_bf16 v[132:135], v[20:23], v[64:67], v[132:135]
    v_cndmask_b32 v102, 0, v102, s[80:81]
    v_mov_b32 v103, 0
    v_mfma_f32_16x16x32_bf16 v[168:171], v[20:23], v[68:71], v[168:171]
    s_waitcnt lgkmcnt(6)
    ds_read_b64_tr_b16 v[20:21], v8 offset:160
    ds_read_b64_tr_b16 v[22:23], v8 offset:4768
    s_waitcnt lgkmcnt(6)
    v_mfma_f32_16x16x32_bf16 v[136:139], v[24:27], v[64:67], v[136:139]
    v_mfma_f32_16x16x32_bf16 v[48:51], v[32:35], v[224:227], 0
    v_mfma_f32_16x16x32_bf16 v[52:55], v[36:39], v[224:227], 0
    v_mfma_f32_16x16x32_bf16 v[240:243], v[32:35], v[228:231], 0
    v_mfma_f32_16x16x32_bf16 v[172:175], v[24:27], v[68:71], v[172:175]
    v_mfma_f32_16x16x32_bf16 v[244:247], v[36:39], v[228:231], 0
    s_nop 4
    v_add_f32 v54, s79, v54
    v_rcp_f32 v54, v54
    ds_read_b64_tr_b16 v[24:25], v8 offset:192
    ds_read_b64_tr_b16 v[26:27], v8 offset:4800
    s_waitcnt lgkmcnt(6)
    v_mfma_f32_16x16x32_bf16 v[140:143], v[28:31], v[64:67], v[140:143]
    v_mul_f32 v54, v60, v54
    v_mul_f32 v48, v54, v48
    v_mul_f32 v49, v54, v49
    v_mfma_f32_16x16x32_bf16 v[176:179], v[28:31], v[68:71], v[176:179]
    v_mul_f32 v50, v54, v50
    v_mul_f32 v51, v54, v51
    v_mul_f32 v52, v54, v52
    ds_read_b64_tr_b16 v[28:29], v8 offset:224
    ds_read_b64_tr_b16 v[30:31], v8 offset:4832
    s_waitcnt lgkmcnt(6)
    v_mfma_f32_16x16x32_bf16 v[144:147], v[16:19], v[64:67], v[144:147]
    v_mul_f32 v53, v54, v53
    v_cvt_pk_bf16_f32 v104, v48, v49
    v_cvt_pk_bf16_f32 v105, v50, v51
    v_mfma_f32_16x16x32_bf16 v[180:183], v[16:19], v[68:71], v[180:183]
    v_cvt_pk_bf16_f32 v106, v52, v53
    v_cndmask_b32 v106, 0, v106, s[80:81]
    v_mov_b32 v107, 0
    ds_read_b64_tr_b16 v[16:17], v8 offset:256
    ds_read_b64_tr_b16 v[18:19], v8 offset:4864
    s_waitcnt lgkmcnt(6)
    v_mfma_f32_16x16x32_bf16 v[148:151], v[20:23], v[64:67], v[148:151]
    v_add_f32 v246, s79, v246
    v_rcp_f32 v246, v246
    s_nop 0
    v_mul_f32 v246, v61, v246
    v_mfma_f32_16x16x32_bf16 v[184:187], v[20:23], v[68:71], v[184:187]
    v_mul_f32 v240, v246, v240
    v_mul_f32 v241, v246, v241
    v_mul_f32 v242, v246, v242
    ds_read_b64_tr_b16 v[20:21], v8 offset:9216
    ds_read_b64_tr_b16 v[22:23], v8 offset:13824
    s_waitcnt lgkmcnt(6)
    v_mfma_f32_16x16x32_bf16 v[152:155], v[24:27], v[64:67], v[152:155]
    v_mul_f32 v243, v246, v243
    v_mul_f32 v244, v246, v244
    v_mul_f32 v245, v246, v245
    v_mfma_f32_16x16x32_bf16 v[188:191], v[24:27], v[68:71], v[188:191]
    v_cvt_pk_bf16_f32 v108, v240, v241
    v_cvt_pk_bf16_f32 v109, v242, v243
    v_cvt_pk_bf16_f32 v110, v244, v245
    ds_read_b64_tr_b16 v[24:25], v8 offset:9248
    ds_read_b64_tr_b16 v[26:27], v8 offset:13856
    s_waitcnt lgkmcnt(6)
    v_mfma_f32_16x16x32_bf16 v[156:159], v[28:31], v[64:67], v[156:159]
    v_cndmask_b32 v110, 0, v110, s[80:81]
    v_mov_b32 v111, 0
    v_mfma_f32_16x16x32_bf16 v[192:195], v[28:31], v[68:71], v[192:195]
    ds_read_b64_tr_b16 v[28:29], v8 offset:9280
    ds_read_b64_tr_b16 v[30:31], v8 offset:13888
    s_waitcnt lgkmcnt(6)
    v_mfma_f32_16x16x32_bf16 v[160:163], v[16:19], v[64:67], v[160:163]
    v_mfma_f32_16x16x32_bf16 v[196:199], v[16:19], v[68:71], v[196:199]
    ds_read_b64_tr_b16 v[16:17], v8 offset:9312
    ds_read_b64_tr_b16 v[18:19], v8 offset:13920
    s_waitcnt lgkmcnt(6)
    v_mfma_f32_16x16x32_bf16 v[128:131], v[20:23], v[72:75], v[128:131]
    v_mfma_f32_16x16x32_bf16 v[164:167], v[20:23], v[76:79], v[164:167]
    ds_read_b64_tr_b16 v[20:21], v8 offset:9344
    ds_read_b64_tr_b16 v[22:23], v8 offset:13952
    s_waitcnt lgkmcnt(6)
    v_mfma_f32_16x16x32_bf16 v[132:135], v[24:27], v[72:75], v[132:135]
    v_mfma_f32_16x16x32_bf16 v[168:171], v[24:27], v[76:79], v[168:171]
    ds_read_b64_tr_b16 v[24:25], v8 offset:9376
    ds_read_b64_tr_b16 v[26:27], v8 offset:13984
    s_waitcnt lgkmcnt(6)
    v_mfma_f32_16x16x32_bf16 v[136:139], v[28:31], v[72:75], v[136:139]
    v_mfma_f32_16x16x32_bf16 v[172:175], v[28:31], v[76:79], v[172:175]
    v_mul_f32 v128, v9, v128
    v_mul_f32 v129, v9, v129
    v_mul_f32 v130, v9, v130
    v_mul_f32 v131, v9, v131
    v_mul_f32 v164, v10, v164
    v_mul_f32 v165, v10, v165
    v_mul_f32 v166, v10, v166
    v_mul_f32 v167, v10, v167
    ds_read_b64_tr_b16 v[28:29], v8 offset:9408
    ds_read_b64_tr_b16 v[30:31], v8 offset:14016
    s_waitcnt lgkmcnt(6)
    v_mfma_f32_16x16x32_bf16 v[140:143], v[16:19], v[72:75], v[140:143]
    v_mfma_f32_16x16x32_bf16 v[176:179], v[16:19], v[76:79], v[176:179]
    v_mul_f32 v132, v9, v132
    v_mul_f32 v133, v9, v133
    v_mul_f32 v134, v9, v134
    v_mul_f32 v135, v9, v135
    v_mul_f32 v168, v10, v168
    v_mul_f32 v169, v10, v169
    v_mul_f32 v170, v10, v170
    v_mul_f32 v171, v10, v171
    ds_read_b64_tr_b16 v[16:17], v8 offset:9440
    ds_read_b64_tr_b16 v[18:19], v8 offset:14048
    s_waitcnt lgkmcnt(6)
    v_mfma_f32_16x16x32_bf16 v[144:147], v[20:23], v[72:75], v[144:147]
    v_mfma_f32_16x16x32_bf16 v[180:183], v[20:23], v[76:79], v[180:183]
    v_mul_f32 v136, v9, v136
    v_mul_f32 v137, v9, v137
    v_mul_f32 v138, v9, v138
    v_mul_f32 v139, v9, v139
    v_mul_f32 v172, v10, v172
    v_mul_f32 v173, v10, v173
    v_mul_f32 v174, v10, v174
    v_mul_f32 v175, v10, v175
    ds_read_b64_tr_b16 v[20:21], v8 offset:9472
    ds_read_b64_tr_b16 v[22:23], v8 offset:14080
    s_waitcnt lgkmcnt(6)
    v_mfma_f32_16x16x32_bf16 v[148:151], v[24:27], v[72:75], v[148:151]
    v_mfma_f32_16x16x32_bf16 v[184:187], v[24:27], v[76:79], v[184:187]
    v_mul_f32 v140, v9, v140
    v_mul_f32 v141, v9, v141
    v_mul_f32 v142, v9, v142
    v_mul_f32 v143, v9, v143
    v_mul_f32 v176, v10, v176
    v_mul_f32 v177, v10, v177
    v_mul_f32 v178, v10, v178
    v_mul_f32 v179, v10, v179
    ds_read_b64_tr_b16 v[24:25], v56 offset:0
    ds_read_b64_tr_b16 v[26:27], v57 offset:0
    s_waitcnt lgkmcnt(6)
    v_mfma_f32_16x16x32_bf16 v[152:155], v[28:31], v[72:75], v[152:155]
    v_mfma_f32_16x16x32_bf16 v[188:191], v[28:31], v[76:79], v[188:191]
    v_mul_f32 v144, v9, v144
    v_mul_f32 v145, v9, v145
    v_mul_f32 v146, v9, v146
    v_mul_f32 v147, v9, v147
    v_mul_f32 v180, v10, v180
    v_mul_f32 v181, v10, v181
    v_mul_f32 v182, v10, v182
    v_mul_f32 v183, v10, v183
    ds_read_b64_tr_b16 v[28:29], v56 offset:5184
    ds_read_b64_tr_b16 v[30:31], v57 offset:5184
    s_waitcnt lgkmcnt(6)
    v_mfma_f32_16x16x32_bf16 v[156:159], v[16:19], v[72:75], v[156:159]
    v_mfma_f32_16x16x32_bf16 v[192:195], v[16:19], v[76:79], v[192:195]
    v_mul_f32 v148, v9, v148
    v_mul_f32 v149, v9, v149
    v_mul_f32 v150, v9, v150
    v_mul_f32 v151, v9, v151
    v_mul_f32 v184, v10, v184
    v_mul_f32 v185, v10, v185
    v_mul_f32 v186, v10, v186
    v_mul_f32 v187, v10, v187
    ds_read_b64_tr_b16 v[16:17], v56 offset:10368
    ds_read_b64_tr_b16 v[18:19], v57 offset:10368
    s_waitcnt lgkmcnt(6)
    v_mfma_f32_16x16x32_bf16 v[160:163], v[20:23], v[72:75], v[160:163]
    v_mfma_f32_16x16x32_bf16 v[196:199], v[20:23], v[76:79], v[196:199]
    v_mul_f32 v152, v9, v152
    v_mul_f32 v153, v9, v153
    v_mul_f32 v154, v9, v154
    v_mul_f32 v155, v9, v155
    v_mul_f32 v188, v10, v188
    v_mul_f32 v189, v10, v189
    v_mul_f32 v190, v10, v190
    v_mul_f32 v191, v10, v191
    s_lshl_b32 s25, s20, 6
    s_lshr_b32 s26, s24, 1
    s_add_u32 s25, s25, s26
    s_mul_i32 s25, s25, 36
    s_mul_i32 s26, s21, 9
    s_add_u32 s25, s25, s26
    s_lshl_b32 s25, s25, 10
    s_add_u32 s25, s25, 33554432
    v_mul_f32 v156, v9, v156
    v_mul_f32 v157, v9, v157
    v_mul_f32 v158, v9, v158
    v_mul_f32 v159, v9, v159
    v_mul_f32 v192, v10, v192
    v_mul_f32 v193, v10, v193
    v_mul_f32 v194, v10, v194
    v_mul_f32 v195, v10, v195
    v_mul_f32 v160, v9, v160
    v_mul_f32 v161, v9, v161
    v_mul_f32 v162, v9, v162
    v_mul_f32 v163, v9, v163
    v_mul_f32 v196, v10, v196
    v_mul_f32 v197, v10, v197
    v_mul_f32 v198, v10, v198
    v_mul_f32 v199, v10, v199
    ds_read_b64_tr_b16 v[20:21], v56 offset:15552
    ds_read_b64_tr_b16 v[22:23], v57 offset:15552
    s_waitcnt lgkmcnt(6)
    v_mfma_f32_16x16x32_bf16 v[128:131], v[24:27], v[40:43], v[128:131]
    v_mfma_f32_16x16x32_bf16 v[164:167], v[24:27], v[44:47], v[164:167]
    ds_read_b64_tr_b16 v[24:25], v56 offset:32
    ds_read_b64_tr_b16 v[26:27], v57 offset:32
    s_waitcnt lgkmcnt(6)
    v_mfma_f32_16x16x32_bf16 v[128:131], v[28:31], v[232:235], v[128:131]
    v_mfma_f32_16x16x32_bf16 v[164:167], v[28:31], v[236:239], v[164:167]
    ds_read_b64_tr_b16 v[28:29], v56 offset:5216
    ds_read_b64_tr_b16 v[30:31], v57 offset:5216
    s_waitcnt lgkmcnt(6)
    v_mfma_f32_16x16x32_bf16 v[128:131], v[16:19], v[96:99], v[128:131]
    v_mfma_f32_16x16x32_bf16 v[164:167], v[16:19], v[100:103], v[164:167]
    ds_read_b64_tr_b16 v[16:17], v56 offset:10400
    ds_read_b64_tr_b16 v[18:19], v57 offset:10400
    s_waitcnt lgkmcnt(6)
    v_mfma_f32_16x16x32_bf16 v[128:131], v[20:23], v[104:107], v[128:131]
    v_mfma_f32_16x16x32_bf16 v[164:167], v[20:23], v[108:111], v[164:167]
    ds_read_b64_tr_b16 v[20:21], v56 offset:15584
    ds_read_b64_tr_b16 v[22:23], v57 offset:15584
    s_waitcnt lgkmcnt(6)
    v_mfma_f32_16x16x32_bf16 v[132:135], v[24:27], v[40:43], v[132:135]
    v_mfma_f32_16x16x32_bf16 v[168:171], v[24:27], v[44:47], v[168:171]
    ds_read_b64_tr_b16 v[24:25], v56 offset:64
    ds_read_b64_tr_b16 v[26:27], v57 offset:64
    s_waitcnt lgkmcnt(6)
    v_mfma_f32_16x16x32_bf16 v[132:135], v[28:31], v[232:235], v[132:135]
    v_mfma_f32_16x16x32_bf16 v[168:171], v[28:31], v[236:239], v[168:171]
    ds_read_b64_tr_b16 v[28:29], v56 offset:5248
    ds_read_b64_tr_b16 v[30:31], v57 offset:5248
    s_waitcnt lgkmcnt(6)
    v_mfma_f32_16x16x32_bf16 v[132:135], v[16:19], v[96:99], v[132:135]
    v_mfma_f32_16x16x32_bf16 v[168:171], v[16:19], v[100:103], v[168:171]
    v_cvt_pk_bf16_f32 v80, v128, v129
    v_cvt_pk_bf16_f32 v81, v130, v131
    v_cvt_pk_bf16_f32 v82, v164, v165
    v_cvt_pk_bf16_f32 v83, v166, v167
    buffer_store_dwordx4 v[80:83], v4, s[44:47], s25 offen offset:0 sc1
    ds_read_b64_tr_b16 v[16:17], v56 offset:10432
    ds_read_b64_tr_b16 v[18:19], v57 offset:10432
    s_waitcnt lgkmcnt(6)
    v_mfma_f32_16x16x32_bf16 v[132:135], v[20:23], v[104:107], v[132:135]
    v_mfma_f32_16x16x32_bf16 v[168:171], v[20:23], v[108:111], v[168:171]
    ds_read_b64_tr_b16 v[20:21], v56 offset:15616
    ds_read_b64_tr_b16 v[22:23], v57 offset:15616
    s_waitcnt lgkmcnt(6)
    v_mfma_f32_16x16x32_bf16 v[136:139], v[24:27], v[40:43], v[136:139]
    v_mfma_f32_16x16x32_bf16 v[172:175], v[24:27], v[44:47], v[172:175]
    ds_read_b64_tr_b16 v[24:25], v56 offset:96
    ds_read_b64_tr_b16 v[26:27], v57 offset:96
    s_waitcnt lgkmcnt(6)
    v_mfma_f32_16x16x32_bf16 v[136:139], v[28:31], v[232:235], v[136:139]
    v_mfma_f32_16x16x32_bf16 v[172:175], v[28:31], v[236:239], v[172:175]
    ds_read_b64_tr_b16 v[28:29], v56 offset:5280
    ds_read_b64_tr_b16 v[30:31], v57 offset:5280
    s_waitcnt lgkmcnt(6)
    v_mfma_f32_16x16x32_bf16 v[136:139], v[16:19], v[96:99], v[136:139]
    v_mfma_f32_16x16x32_bf16 v[172:175], v[16:19], v[100:103], v[172:175]
    v_cvt_pk_bf16_f32 v84, v132, v133
    v_cvt_pk_bf16_f32 v85, v134, v135
    v_cvt_pk_bf16_f32 v86, v168, v169
    v_cvt_pk_bf16_f32 v87, v170, v171
    buffer_store_dwordx4 v[84:87], v4, s[44:47], s25 offen offset:1024 sc1
    ds_read_b64_tr_b16 v[16:17], v56 offset:10464
    ds_read_b64_tr_b16 v[18:19], v57 offset:10464
    s_waitcnt lgkmcnt(6)
    v_mfma_f32_16x16x32_bf16 v[136:139], v[20:23], v[104:107], v[136:139]
    v_mfma_f32_16x16x32_bf16 v[172:175], v[20:23], v[108:111], v[172:175]
    ds_read_b64_tr_b16 v[20:21], v56 offset:15648
    ds_read_b64_tr_b16 v[22:23], v57 offset:15648
    s_waitcnt lgkmcnt(6)
    v_mfma_f32_16x16x32_bf16 v[140:143], v[24:27], v[40:43], v[140:143]
    v_mfma_f32_16x16x32_bf16 v[176:179], v[24:27], v[44:47], v[176:179]
    ds_read_b64_tr_b16 v[24:25], v56 offset:128
    ds_read_b64_tr_b16 v[26:27], v57 offset:128
    s_waitcnt lgkmcnt(6)
    v_mfma_f32_16x16x32_bf16 v[140:143], v[28:31], v[232:235], v[140:143]
    v_mfma_f32_16x16x32_bf16 v[176:179], v[28:31], v[236:239], v[176:179]
    ds_read_b64_tr_b16 v[28:29], v56 offset:5312
    ds_read_b64_tr_b16 v[30:31], v57 offset:5312
    s_waitcnt lgkmcnt(6)
    v_mfma_f32_16x16x32_bf16 v[140:143], v[16:19], v[96:99], v[140:143]
    v_mfma_f32_16x16x32_bf16 v[176:179], v[16:19], v[100:103], v[176:179]
    v_cvt_pk_bf16_f32 v88, v136, v137
    v_cvt_pk_bf16_f32 v89, v138, v139
    v_cvt_pk_bf16_f32 v90, v172, v173
    v_cvt_pk_bf16_f32 v91, v174, v175
    buffer_store_dwordx4 v[88:91], v4, s[44:47], s25 offen offset:2048 sc1
    s_add_u32 s25, s25, 3072
    ds_read_b64_tr_b16 v[16:17], v56 offset:10496
    ds_read_b64_tr_b16 v[18:19], v57 offset:10496
    s_waitcnt lgkmcnt(6)
    v_mfma_f32_16x16x32_bf16 v[140:143], v[20:23], v[104:107], v[140:143]
    v_mfma_f32_16x16x32_bf16 v[176:179], v[20:23], v[108:111], v[176:179]
    ds_read_b64_tr_b16 v[20:21], v56 offset:15680
    ds_read_b64_tr_b16 v[22:23], v57 offset:15680
    s_waitcnt lgkmcnt(6)
    v_mfma_f32_16x16x32_bf16 v[144:147], v[24:27], v[40:43], v[144:147]
    v_mfma_f32_16x16x32_bf16 v[180:183], v[24:27], v[44:47], v[180:183]
    ds_read_b64_tr_b16 v[24:25], v56 offset:160
    ds_read_b64_tr_b16 v[26:27], v57 offset:160
    s_waitcnt lgkmcnt(6)
    v_mfma_f32_16x16x32_bf16 v[144:147], v[28:31], v[232:235], v[144:147]
    v_mfma_f32_16x16x32_bf16 v[180:183], v[28:31], v[236:239], v[180:183]
    ds_read_b64_tr_b16 v[28:29], v56 offset:5344
    ds_read_b64_tr_b16 v[30:31], v57 offset:5344
    s_waitcnt lgkmcnt(6)
    v_mfma_f32_16x16x32_bf16 v[144:147], v[16:19], v[96:99], v[144:147]
    v_mfma_f32_16x16x32_bf16 v[180:183], v[16:19], v[100:103], v[180:183]
    v_cvt_pk_bf16_f32 v92, v140, v141
    v_cvt_pk_bf16_f32 v93, v142, v143
    v_cvt_pk_bf16_f32 v94, v176, v177
    v_cvt_pk_bf16_f32 v95, v178, v179
    buffer_store_dwordx4 v[92:95], v4, s[44:47], s25 offen offset:0 sc1
    ds_read_b64_tr_b16 v[16:17], v56 offset:10528
    ds_read_b64_tr_b16 v[18:19], v57 offset:10528
    s_waitcnt lgkmcnt(6)
    v_mfma_f32_16x16x32_bf16 v[144:147], v[20:23], v[104:107], v[144:147]
    v_mfma_f32_16x16x32_bf16 v[180:183], v[20:23], v[108:111], v[180:183]
    ds_read_b64_tr_b16 v[20:21], v56 offset:15712
    ds_read_b64_tr_b16 v[22:23], v57 offset:15712
    s_waitcnt lgkmcnt(6)
    v_mfma_f32_16x16x32_bf16 v[148:151], v[24:27], v[40:43], v[148:151]
    v_mfma_f32_16x16x32_bf16 v[184:187], v[24:27], v[44:47], v[184:187]
    ds_read_b64_tr_b16 v[24:25], v56 offset:192
    ds_read_b64_tr_b16 v[26:27], v57 offset:192
    s_waitcnt lgkmcnt(6)
    v_mfma_f32_16x16x32_bf16 v[148:151], v[28:31], v[232:235], v[148:151]
    v_mfma_f32_16x16x32_bf16 v[184:187], v[28:31], v[236:239], v[184:187]
    ds_read_b64_tr_b16 v[28:29], v56 offset:5376
    ds_read_b64_tr_b16 v[30:31], v57 offset:5376
    s_waitcnt lgkmcnt(6)
    v_mfma_f32_16x16x32_bf16 v[148:151], v[16:19], v[96:99], v[148:151]
    v_mfma_f32_16x16x32_bf16 v[184:187], v[16:19], v[100:103], v[184:187]
    v_cvt_pk_bf16_f32 v80, v144, v145
    v_cvt_pk_bf16_f32 v81, v146, v147
    v_cvt_pk_bf16_f32 v82, v180, v181
    v_cvt_pk_bf16_f32 v83, v182, v183
    buffer_store_dwordx4 v[80:83], v4, s[44:47], s25 offen offset:1024 sc1
    ds_read_b64_tr_b16 v[16:17], v56 offset:10560
    ds_read_b64_tr_b16 v[18:19], v57 offset:10560
    s_waitcnt lgkmcnt(6)
    v_mfma_f32_16x16x32_bf16 v[148:151], v[20:23], v[104:107], v[148:151]
    v_mfma_f32_16x16x32_bf16 v[184:187], v[20:23], v[108:111], v[184:187]
    ds_read_b64_tr_b16 v[20:21], v56 offset:15744
    ds_read_b64_tr_b16 v[22:23], v57 offset:15744
    s_waitcnt lgkmcnt(6)
    v_mfma_f32_16x16x32_bf16 v[152:155], v[24:27], v[40:43], v[152:155]
    v_mfma_f32_16x16x32_bf16 v[188:191], v[24:27], v[44:47], v[188:191]
    ds_read_b64_tr_b16 v[24:25], v56 offset:224
    ds_read_b64_tr_b16 v[26:27], v57 offset:224
    s_waitcnt lgkmcnt(6)
    v_mfma_f32_16x16x32_bf16 v[152:155], v[28:31], v[232:235], v[152:155]
    v_mfma_f32_16x16x32_bf16 v[188:191], v[28:31], v[236:239], v[188:191]
    ds_read_b64_tr_b16 v[28:29], v56 offset:5408
    ds_read_b64_tr_b16 v[30:31], v57 offset:5408
    s_waitcnt lgkmcnt(6)
    v_mfma_f32_16x16x32_bf16 v[152:155], v[16:19], v[96:99], v[152:155]
    v_mfma_f32_16x16x32_bf16 v[188:191], v[16:19], v[100:103], v[188:191]
    v_cvt_pk_bf16_f32 v84, v148, v149
    v_cvt_pk_bf16_f32 v85, v150, v151
    v_cvt_pk_bf16_f32 v86, v184, v185
    v_cvt_pk_bf16_f32 v87, v186, v187
    buffer_store_dwordx4 v[84:87], v4, s[44:47], s25 offen offset:2048 sc1
    s_add_u32 s25, s25, 3072
    ds_read_b64_tr_b16 v[16:17], v56 offset:10592
    ds_read_b64_tr_b16 v[18:19], v57 offset:10592
    s_waitcnt lgkmcnt(6)
    v_mfma_f32_16x16x32_bf16 v[152:155], v[20:23], v[104:107], v[152:155]
    v_mfma_f32_16x16x32_bf16 v[188:191], v[20:23], v[108:111], v[188:191]
    ds_read_b64_tr_b16 v[20:21], v56 offset:15776
    ds_read_b64_tr_b16 v[22:23], v57 offset:15776
    s_waitcnt lgkmcnt(6)
    v_mfma_f32_16x16x32_bf16 v[156:159], v[24:27], v[40:43], v[156:159]
    v_mfma_f32_16x16x32_bf16 v[192:195], v[24:27], v[44:47], v[192:195]
    ds_read_b64_tr_b16 v[24:25], v56 offset:256
    ds_read_b64_tr_b16 v[26:27], v57 offset:256
    s_waitcnt lgkmcnt(6)
    v_mfma_f32_16x16x32_bf16 v[156:159], v[28:31], v[232:235], v[156:159]
    v_mfma_f32_16x16x32_bf16 v[192:195], v[28:31], v[236:239], v[192:195]
    ds_read_b64_tr_b16 v[28:29], v56 offset:5440
    ds_read_b64_tr_b16 v[30:31], v57 offset:5440
    s_waitcnt lgkmcnt(6)
    v_mfma_f32_16x16x32_bf16 v[156:159], v[16:19], v[96:99], v[156:159]
    v_mfma_f32_16x16x32_bf16 v[192:195], v[16:19], v[100:103], v[192:195]
    v_cvt_pk_bf16_f32 v88, v152, v153
    v_cvt_pk_bf16_f32 v89, v154, v155
    v_cvt_pk_bf16_f32 v90, v188, v189
    v_cvt_pk_bf16_f32 v91, v190, v191
    buffer_store_dwordx4 v[88:91], v4, s[44:47], s25 offen offset:0 sc1
    ds_read_b64_tr_b16 v[16:17], v56 offset:10624
    ds_read_b64_tr_b16 v[18:19], v57 offset:10624
    s_waitcnt lgkmcnt(6)
    v_mfma_f32_16x16x32_bf16 v[156:159], v[20:23], v[104:107], v[156:159]
    v_mfma_f32_16x16x32_bf16 v[192:195], v[20:23], v[108:111], v[192:195]
    ds_read_b64_tr_b16 v[20:21], v56 offset:15808
    ds_read_b64_tr_b16 v[22:23], v57 offset:15808
    s_waitcnt lgkmcnt(6)
    v_mfma_f32_16x16x32_bf16 v[160:163], v[24:27], v[40:43], v[160:163]
    v_mfma_f32_16x16x32_bf16 v[196:199], v[24:27], v[44:47], v[196:199]
    s_waitcnt lgkmcnt(4)
    v_mfma_f32_16x16x32_bf16 v[160:163], v[28:31], v[232:235], v[160:163]
    v_mfma_f32_16x16x32_bf16 v[196:199], v[28:31], v[236:239], v[196:199]
    s_waitcnt lgkmcnt(2)
    v_mfma_f32_16x16x32_bf16 v[160:163], v[16:19], v[96:99], v[160:163]
    v_mfma_f32_16x16x32_bf16 v[196:199], v[16:19], v[100:103], v[196:199]
    v_cvt_pk_bf16_f32 v92, v156, v157
    v_cvt_pk_bf16_f32 v93, v158, v159
    v_cvt_pk_bf16_f32 v94, v192, v193
    v_cvt_pk_bf16_f32 v95, v194, v195
    buffer_store_dwordx4 v[92:95], v4, s[44:47], s25 offen offset:1024 sc1
    s_waitcnt lgkmcnt(0)
    v_mfma_f32_16x16x32_bf16 v[160:163], v[20:23], v[104:107], v[160:163]
    v_mfma_f32_16x16x32_bf16 v[196:199], v[20:23], v[108:111], v[196:199]
    s_nop 6
    v_cvt_pk_bf16_f32 v80, v160, v161
    v_cvt_pk_bf16_f32 v81, v162, v163
    v_cvt_pk_bf16_f32 v82, v196, v197
    v_cvt_pk_bf16_f32 v83, v198, v199
    buffer_store_dwordx4 v[80:83], v4, s[44:47], s25 offen offset:2048 sc1
    s_add_u32 s25, s25, 3072
L_phase3:
    s_load_dwordx2 s[6:7], s[0:1], 64
    s_waitcnt vmcnt(0) lgkmcnt(0)
    s_barrier
    s_lshl_b32 s26, s23, 2
    s_add_u32 s26, s26, s21
    s_lshl_b32 s26, s26, 7
    s_add_u32 s26, s26, 22372352
    s_cmp_lg_u32 s22, 0
    s_cbranch_scc1 L_f3_nosig
    s_lshl_b32 s25, s20, 2
    s_add_u32 s25, s25, s26
    v_mov_b32 v11, s85
    v_mov_b32 v12, 0
    s_mov_b64 exec, 1
    buffer_store_dword v11, v12, s[44:47], s25 offen sc1
    s_mov_b64 exec, -1
L_f3_nosig:
    s_mov_b32 s32, s6
    s_mov_b32 s33, s7
    s_mov_b32 s34, 2359296
    s_mov_b32 s35, 0x20000
    s_lshl_b32 s27, s23, 3
    s_add_u32 s27, s27, s20
    s_mul_i32 s57, s27, 36
    s_mul_i32 s25, s21, 9
    s_add_u32 s57, s57, s25
    s_add_u32 s58, s57, 8
    s_add_u32 s57, s57, s22
    s_lshl_b32 s57, s57, 10
    s_add_u32 s57, s57, 33554432
    s_lshl_b32 s58, s58, 10
    s_add_u32 s58, s58, 33554432
    v_lshrrev_b32 v5, 3, v1
    v_mul_u32_u24 v5, 2304, v5
    v_lshlrev_b32 v5, 10, v5
    v_and_b32 v6, 7, v1
    s_lshl_b32 s25, s22, 3
    v_add_u32 v6, s25, v6
    v_lshl_add_u32 v5, v6, 4, v5
    v_and_b32 v12, 15, v1
    v_mul_u32_u24 v12, 1152, v12
    v_lshrrev_b32 v13, 4, v1
    v_lshl_add_u32 v7, v13, 3, v12
    v_and_b32 v12, 15, v6
    v_mul_u32_u24 v12, 1152, v12
    v_lshrrev_b32 v13, 4, v6
    v_lshl_add_u32 v8, v13, 3, v12
    s_mul_i32 s56, s27, 36864
    s_mul_i32 s25, s21, 288
    s_add_u32 s56, s56, s25
    s_add_u32 s55, s56, 256
    s_lshl_b32 s25, s22, 5
    s_add_u32 s56, s56, s25
    s_cmp_lg_u32 s22, 0
    s_cbranch_scc1 L_f_doner
    v_lshl_add_u32 v11, v1, 2, s26
    s_mov_b32 s84, 262144
    s_mov_b32 s86, 255
    s_mov_b32 s87, 0
    s_mov_b64 exec, s[86:87]
L_f_pollr:
    buffer_load_dword v13, v11, s[44:47], 0 offen sc1
    s_waitcnt vmcnt(0)
    v_cmp_ne_u32 vcc, s85, v13
    s_sub_u32 s84, s84, 1
    s_cmp_eq_u32 s84, 0
    s_cbranch_scc1 L_f_outr
    s_cbranch_vccz L_f_outr
    s_sleep 2
    s_branch L_f_pollr
L_f_outr:
    s_mov_b64 exec, -1
L_f_doner:
    s_barrier
    buffer_load_dwordx4 v[16:19], v4, s[44:47], s57 offen sc1
    s_add_u32 s57, s57, 2359296
    buffer_load_dwordx4 v[20:23], v4, s[44:47], s57 offen sc1
    s_add_u32 s57, s57, 2359296
    buffer_load_dwordx4 v[24:27], v4, s[44:47], s57 offen sc1
    s_add_u32 s57, s57, 2359296
    buffer_load_dwordx4 v[28:31], v4, s[44:47], s57 offen sc1
    s_add_u32 s57, s57, 2359296
    buffer_load_dwordx4 v[32:35], v4, s[44:47], s57 offen sc1
    s_add_u32 s57, s57, 2359296
    buffer_load_dwordx4 v[36:39], v4, s[44:47], s57 offen sc1
    s_add_u32 s57, s57, 2359296
    buffer_load_dwordx4 v[40:43], v4, s[44:47], s57 offen sc1
    s_add_u32 s57, s57, 2359296
    buffer_load_dwordx4 v[44:47], v4, s[44:47], s57 offen sc1
    s_add_u32 s57, s57, 2359296
    buffer_load_dwordx4 v[64:67], v5, s[44:47], s58 offen sc1
    s_waitcnt vmcnt(8)
    v_lshlrev_b32 v48, 16, v16
    v_and_b32 v49, 0xffff0000, v16
    v_lshlrev_b32 v50, 16, v17
    v_and_b32 v51, 0xffff0000, v17
    v_lshlrev_b32 v52, 16, v18
    v_and_b32 v53, 0xffff0000, v18
    v_lshlrev_b32 v54, 16, v19
    v_and_b32 v55, 0xffff0000, v19
    s_waitcnt vmcnt(7)
    v_lshlrev_b32 v56, 16, v20
    v_and_b32 v57, 0xffff0000, v20
    v_add_f32 v48, v48, v56
    v_add_f32 v49, v49, v57
    v_lshlrev_b32 v56, 16, v21
    v_and_b32 v57, 0xffff0000, v21
    v_add_f32 v50, v50, v56
    v_add_f32 v51, v51, v57
    v_lshlrev_b32 v56, 16, v22
    v_and_b32 v57, 0xffff0000, v22
    v_add_f32 v52, v52, v56
    v_add_f32 v53, v53, v57
    v_lshlrev_b32 v56, 16, v23
    v_and_b32 v57, 0xffff0000, v23
    v_add_f32 v54, v54, v56
    v_add_f32 v55, v55, v57
    s_waitcnt vmcnt(6)
    v_lshlrev_b32 v56, 16, v24
    v_and_b32 v57, 0xffff0000, v24
    v_add_f32 v48, v48, v56
    v_add_f32 v49, v49, v57
    v_lshlrev_b32 v56, 16, v25
    v_and_b32 v57, 0xffff0000, v25
    v_add_f32 v50, v50, v56
    v_add_f32 v51, v51, v57
    v_lshlrev_b32 v56, 16, v26
    v_and_b32 v57, 0xffff0000, v26
    v_add_f32 v52, v52, v56
    v_add_f32 v53, v53, v57
    v_lshlrev_b32 v56, 16, v27
    v_and_b32 v57, 0xffff0000, v27
    v_add_f32 v54, v54, v56
    v_add_f32 v55, v55, v57
    s_waitcnt vmcnt(5)
    v_lshlrev_b32 v56, 16, v28
    v_and_b32 v57, 0xffff0000, v28
    v_add_f32 v48, v48, v56
    v_add_f32 v49, v49, v57
    v_lshlrev_b32 v56, 16, v29
    v_and_b32 v57, 0xffff0000, v29
    v_add_f32 v50, v50, v56
    v_add_f32 v51, v51, v57
    v_lshlrev_b32 v56, 16, v30
    v_and_b32 v57, 0xffff0000, v30
    v_add_f32 v52, v52, v56
    v_add_f32 v53, v53, v57
    v_lshlrev_b32 v56, 16, v31
    v_and_b32 v57, 0xffff0000, v31
    v_add_f32 v54, v54, v56
    v_add_f32 v55, v55, v57
    s_waitcnt vmcnt(4)
    v_lshlrev_b32 v56, 16, v32
    v_and_b32 v57, 0xffff0000, v32
    v_add_f32 v48, v48, v56
    v_add_f32 v49, v49, v57
    v_lshlrev_b32 v56, 16, v33
    v_and_b32 v57, 0xffff0000, v33
    v_add_f32 v50, v50, v56
    v_add_f32 v51, v51, v57
    v_lshlrev_b32 v56, 16, v34
    v_and_b32 v57, 0xffff0000, v34
    v_add_f32 v52, v52, v56
    v_add_f32 v53, v53, v57
    v_lshlrev_b32 v56, 16, v35
    v_and_b32 v57, 0xffff0000, v35
    v_add_f32 v54, v54, v56
    v_add_f32 v55, v55, v57
    s_waitcnt vmcnt(3)
    v_lshlrev_b32 v56, 16, v36
    v_and_b32 v57, 0xffff0000, v36
    v_add_f32 v48, v48, v56
    v_add_f32 v49, v49, v57
    v_lshlrev_b32 v56, 16, v37
    v_and_b32 v57, 0xffff0000, v37
    v_add_f32 v50, v50, v56
    v_add_f32 v51, v51, v57
    v_lshlrev_b32 v56, 16, v38
    v_and_b32 v57, 0xffff0000, v38
    v_add_f32 v52, v52, v56
    v_add_f32 v53, v53, v57
    v_lshlrev_b32 v56, 16, v39
    v_and_b32 v57, 0xffff0000, v39
    v_add_f32 v54, v54, v56
    v_add_f32 v55, v55, v57
    s_waitcnt vmcnt(2)
    v_lshlrev_b32 v56, 16, v40
    v_and_b32 v57, 0xffff0000, v40
    v_add_f32 v48, v48, v56
    v_add_f32 v49, v49, v57
    v_lshlrev_b32 v56, 16, v41
    v_and_b32 v57, 0xffff0000, v41
    v_add_f32 v50, v50, v56
    v_add_f32 v51, v51, v57
    v_lshlrev_b32 v56, 16, v42
    v_and_b32 v57, 0xffff0000, v42
    v_add_f32 v52, v52, v56
    v_add_f32 v53, v53, v57
    v_lshlrev_b32 v56, 16, v43
    v_and_b32 v57, 0xffff0000, v43
    v_add_f32 v54, v54, v56
    v_add_f32 v55, v55, v57
    s_waitcnt vmcnt(1)
    v_lshlrev_b32 v56, 16, v44
    v_and_b32 v57, 0xffff0000, v44
    v_add_f32 v48, v48, v56
    v_add_f32 v49, v49, v57
    v_lshlrev_b32 v56, 16, v45
    v_and_b32 v57, 0xffff0000, v45
    v_add_f32 v50, v50, v56
    v_add_f32 v51, v51, v57
    v_lshlrev_b32 v56, 16, v46
    v_and_b32 v57, 0xffff0000, v46
    v_add_f32 v52, v52, v56
    v_add_f32 v53, v53, v57
    v_lshlrev_b32 v56, 16, v47
    v_and_b32 v57, 0xffff0000, v47
    v_add_f32 v54, v54, v56
    v_add_f32 v55, v55, v57
    v_cvt_pk_bf16_f32 v16, v48, v49
    v_cvt_pk_bf16_f32 v17, v50, v51
    v_cvt_pk_bf16_f32 v18, v52, v53
    v_cvt_pk_bf16_f32 v19, v54, v55
    buffer_store_dwordx2 v[16:17], v7, s[32:35], s56 offen
    s_add_u32 s56, s56, 18432
    buffer_store_dwordx2 v[18:19], v7, s[32:35], s56 offen
    s_waitcnt vmcnt(2)
    v_lshlrev_b32 v72, 16, v64
    v_and_b32 v73, 0xffff0000, v64
    v_lshlrev_b32 v74, 16, v65
    v_and_b32 v75, 0xffff0000, v65
    v_lshlrev_b32 v76, 16, v66
    v_and_b32 v77, 0xffff0000, v66
    v_lshlrev_b32 v78, 16, v67
    v_and_b32 v79, 0xffff0000, v67
    v_add_f32_dpp v72, v72, v72 row_ror:8 row_mask:0xf bank_mask:0xf
    v_add_f32_dpp v73, v73, v73 row_ror:8 row_mask:0xf bank_mask:0xf
    v_add_f32_dpp v74, v74, v74 row_ror:8 row_mask:0xf bank_mask:0xf
    v_add_f32_dpp v75, v75, v75 row_ror:8 row_mask:0xf bank_mask:0xf
    v_add_f32_dpp v76, v76, v76 row_ror:8 row_mask:0xf bank_mask:0xf
    v_add_f32_dpp v77, v77, v77 row_ror:8 row_mask:0xf bank_mask:0xf
    v_add_f32_dpp v78, v78, v78 row_ror:8 row_mask:0xf bank_mask:0xf
    v_add_f32_dpp v79, v79, v79 row_ror:8 row_mask:0xf bank_mask:0xf
    v_mov_b32 v80, v72
    v_mov_b32 v81, v73
    v_mov_b32 v82, v74
    v_mov_b32 v83, v75
    v_mov_b32 v84, v76
    v_mov_b32 v85, v77
    v_mov_b32 v86, v78
    v_mov_b32 v87, v79
    v_permlane16_swap_b32 v72, v80
    v_permlane16_swap_b32 v73, v81
    v_permlane16_swap_b32 v74, v82
    v_permlane16_swap_b32 v75, v83
    v_permlane16_swap_b32 v76, v84
    v_permlane16_swap_b32 v77, v85
    v_permlane16_swap_b32 v78, v86
    v_permlane16_swap_b32 v79, v87
    v_add_f32 v72, v72, v80
    v_mov_b32 v80, v72
    v_add_f32 v73, v73, v81
    v_mov_b32 v81, v73
    v_add_f32 v74, v74, v82
    v_mov_b32 v82, v74
    v_add_f32 v75, v75, v83
    v_mov_b32 v83, v75
    v_add_f32 v76, v76, v84
    v_mov_b32 v84, v76
    v_add_f32 v77, v77, v85
    v_mov_b32 v85, v77
    v_add_f32 v78, v78, v86
    v_mov_b32 v86, v78
    v_add_f32 v79, v79, v87
    v_mov_b32 v87, v79
    v_permlane32_swap_b32 v72, v80
    v_permlane32_swap_b32 v73, v81
    v_permlane32_swap_b32 v74, v82
    v_permlane32_swap_b32 v75, v83
    v_permlane32_swap_b32 v76, v84
    v_permlane32_swap_b32 v77, v85
    v_permlane32_swap_b32 v78, v86
    v_permlane32_swap_b32 v79, v87
    v_add_f32 v72, v72, v80
    v_add_f32 v73, v73, v81
    v_add_f32 v74, v74, v82
    v_add_f32 v75, v75, v83
    v_add_f32 v76, v76, v84
    v_add_f32 v77, v77, v85
    v_add_f32 v78, v78, v86
    v_add_f32 v79, v79, v87
    v_cvt_pk_bf16_f32 v20, v72, v73
    v_cvt_pk_bf16_f32 v21, v74, v75
    v_cvt_pk_bf16_f32 v22, v76, v77
    v_cvt_pk_bf16_f32 v23, v78, v79
    s_mov_b64 exec, 255
    buffer_store_dwordx2 v[20:21], v8, s[32:35], s55 offen
    s_add_u32 s55, s55, 18432
    buffer_store_dwordx2 v[22:23], v8, s[32:35], s55 offen
    s_mov_b64 exec, -1
L_k1_end:
    s_endpgm
.section .rodata,"a"
.p2align 6
.amdhsa_kernel gated_mix__linear_attn_block__geglu_ffn__prompt_kernel
  .amdhsa_next_free_vgpr 256
  .amdhsa_next_free_sgpr 102
  .amdhsa_accum_offset 256
  .amdhsa_group_segment_fixed_size 0
  .amdhsa_kernarg_size 88
  .amdhsa_user_sgpr_count 2
  .amdhsa_user_sgpr_kernarg_segment_ptr 1
  .amdhsa_system_sgpr_workgroup_id_x 1
.end_amdhsa_kernel
```
